```python
import torch

def _softmax(x, axis=-1):
    return torch.softmax(x, dim=axis)
def _gelu(x):
    return torch.nn.functional.gelu(x, approximate="tanh")
def _silu(x):
    return torch.nn.functional.silu(x)
def _sigmoid(x):
    return torch.sigmoid(x)
def _layernorm(x, axis=-1, eps=1e-5):
    m = x.mean(dim=axis, keepdim=True)
    v = x.var(dim=axis, keepdim=True, unbiased=False)
    return (x - m) / torch.sqrt(v + eps)
def _scatter_add(tgt, idx, src, axis=0):
    return tgt.clone().index_add_(axis, idx, src)
def _segment_sum(src, seg, n):
    out = torch.zeros((n,) + src.shape[1:], dtype=src.dtype)
    return out.index_add_(0, seg, src)
def _pad(x, pw):
    flat = tuple(v for pair in reversed(pw) for v in pair)
    return torch.nn.functional.pad(x, flat)

kernel_name = 'gated_mix__ssm_conv_s4d__geglu_ffn__prompt'

def setup_inputs():

    _w = (lambda a: (lambda t: t.to(torch.bfloat16) if t.is_floating_point() else t)(torch.as_tensor(a)))
    def _A_setup():
        Bsz, L, D, N = 1, 2048, 576, 128
        return {
            "u": _w((lambda *s: torch.randn(*s, dtype=torch.bfloat16) * 0.05)(Bsz, L, D)),
            "log_A_real": _w((lambda *s: torch.randn(*s, dtype=torch.bfloat16) * 6.4)(D, N) * 0.5),
            "A_imag": _w((lambda *s: torch.randn(*s, dtype=torch.bfloat16) * 0.05)(D, N) * 3.14),
            "C_real": _w((lambda *s: torch.randn(*s, dtype=torch.bfloat16) * 0.05)(D, N) / N ** 0.5),
            "C_imag": _w((lambda *s: torch.randn(*s, dtype=torch.bfloat16) * 0.05)(D, N) / N ** 0.5),
            "log_dt": _w((lambda *s: torch.randn(*s, dtype=torch.bfloat16) * 0.05)(D) * 0.5 - 4.0),
            "D_skip": _w((lambda *s: torch.randn(*s, dtype=torch.bfloat16) * 0.05)(D)),
        }
    _A_in = _A_setup()

    def _B_setup():
        B, S, D, F = 1, 2048, 576, 4608
        return {
            "x": _w((lambda *s: torch.randn(*s, dtype=torch.bfloat16) * 0.05)(B, S, D)),
            "w_gate": _w((lambda *s: torch.randn(*s, dtype=torch.bfloat16) * 0.05)(D, F)),
            "w_up": _w((lambda *s: torch.randn(*s, dtype=torch.bfloat16) * 0.05)(D, F)),
            "w_down": _w((lambda *s: torch.randn(*s, dtype=torch.bfloat16) * 0.05)(F, D)),
        }
    _B_in = _B_setup()

    return {
        "A_u": _A_in["u"],
        "A_log_A_real": _A_in["log_A_real"],
        "A_A_imag": _A_in["A_imag"],
        "A_C_real": _A_in["C_real"],
        "A_C_imag": _A_in["C_imag"],
        "A_log_dt": _A_in["log_dt"],
        "A_D_skip": _A_in["D_skip"],
        "B_x": _B_in["x"],
        "B_w_gate": _B_in["w_gate"],
        "B_w_up": _B_in["w_up"],
        "B_w_down": _B_in["w_down"],
        "gate_w": _w((lambda *s: torch.randn(*s, dtype=torch.bfloat16) * 0.05)(576) * 16.0),
    }

def reference(A_u, A_log_A_real, A_A_imag, A_C_real, A_C_imag, A_log_dt, A_D_skip, B_x, B_w_gate, B_w_up, B_w_down, gate_w):
    def _A_ref(u, log_A_real, A_imag, C_real, C_imag, log_dt, D_skip):
        L = u.shape[1]
        dt = torch.exp(log_dt)
        A = -torch.exp(log_A_real) + 1j * A_imag
        C = (C_real + 1j * C_imag) * dt[:, None]
        pos = (lambda x, dt: x.to(dt))(torch.arange(L), log_dt.dtype)
        P = torch.exp((A * dt[:, None])[:, :, None] * pos[None, None, :])
        K = 2.0 * torch.einsum("dn,dnl->dl", C, P).real
        L2 = 2 * L
        u_t = (lambda x, *d: x.permute(*d))(u, 0, 2, 1)
        Kf = (lambda x, *a, **k: torch.fft.rfft(x.float(), *a, **k))(K, L2)
        Uf = (lambda x, *a, **k: torch.fft.rfft(x.float(), *a, **k))(u_t, L2)
        y = (lambda x, *a, **k: torch.fft.irfft(x, *a, **k).to(torch.bfloat16))(Uf * Kf[None, :, :], L2)[:, :, :L]
        y = (lambda x, *d: x.permute(*d))(y, 0, 2, 1)
        return y + u * D_skip[None, None, :]

    def _B_ref(x, w_gate, w_up, w_down):
        return (_gelu(x @ w_gate) * (x @ w_up)) @ w_down

    x = A_u
    g = _sigmoid((x * gate_w).sum(-1, keepdims=True))
    a = _A_ref(x, A_log_A_real, A_A_imag, A_C_real, A_C_imag, A_log_dt, A_D_skip)
    b = _B_ref(x, B_w_gate, B_w_up, B_w_down)
    return g * a + (1 - g) * b
```

```asm
; @launch kernel=ffn_fused_kernel grid=(256,1,1) block=(256,1,1) lds=163840
; @launch kernel=ssm_mix_kernel grid=(144,1,1) block=(512,1,1) lds=163328
.amdgcn_target "amdgcn-amd-amdhsa--gfx950"
.text
.globl ffn_fused_kernel
.p2align 8
.type ffn_fused_kernel,@function
ffn_fused_kernel:
    s_cmp_ge_u32 s2, 256
    s_cbranch_scc1 ffn_fused_kernel_end1
    s_load_dwordx2 s[32:33], s[0:1], 0
    s_load_dwordx4 s[36:39], s[0:1], 64
    s_load_dwordx2 s[44:45], s[0:1], 80
    s_load_dwordx2 s[34:35], s[0:1], 112
    s_load_dwordx2 s[100:101], s[0:1], 88
    s_load_dwordx8 s[84:91], s[0:1], 8
    s_getpc_b64 s[40:41]
ffn_fused_kernel_pf2:
    v_min_u32 v1, 15, v0
    s_lshr_b32 s43, s2, 3
    s_lshl_b32 s43, s43, 4
    v_add_u32 v1, s43, v1
    v_lshlrev_b32 v1, 7, v1
    v_min_u32 v1, (ffn_fused_kernel_end1 - ffn_fused_kernel_pf2), v1
    global_load_dword v63, v1, s[40:41]
    v_lshrrev_b32 v1, 6, v0
    v_and_b32 v0, 63, v0
    v_readfirstlane_b32 s20, v1
    s_and_b32 s42, s2, 7
    s_lshr_b32 s43, s2, 3
    s_and_b32 s46, s42, 1
    s_lshl_b32 s46, s46, 3
    s_and_b32 s47, s43, 7
    s_add_u32 s46, s46, s47
    s_lshr_b32 s48, s42, 1
    s_lshl_b32 s48, s48, 2
    s_lshr_b32 s49, s43, 3
    s_add_u32 s48, s48, s49
    s_lshr_b32 s21, s20, 1
    s_and_b32 s22, s20, 1
    s_mul_i32 s50, s48, 576
    s_and_b32 s51, s48, 1
    s_lshl_b32 s52, s51, 6
    s_add_u32 s52, s52, s50
    s_xor_b32 s53, s51, 1
    s_lshl_b32 s53, s53, 9
    s_add_u32 s53, s53, s50
    s_lshl_b32 s24, s46, 2
    s_add_u32 s24, s24, s20
    s_mul_i32 s24, s24, 36864
    s_mul_i32 s23, s20, 147456
    s_mov_b32 s56, s24
    s_mov_b32 s65, s23
    s_lshl_b32 s54, s49, 1
    s_add_u32 s54, s54, s47
    s_bfe_u32 s55, s42, 0x10001
    s_add_u32 s54, s54, s55
    s_and_b32 s54, s54, 7
    s_add_u32 s55, s54, 1
    s_lshl_b32 s29, s55, 7
    s_add_u32 s57, s24, s29
    s_mul_i32 s29, s55, 589824
    s_add_u32 s66, s23, s29
    s_add_u32 s54, s54, 1
    s_and_b32 s54, s54, 7
    s_add_u32 s55, s54, 1
    s_lshl_b32 s29, s55, 7
    s_add_u32 s58, s24, s29
    s_mul_i32 s29, s55, 589824
    s_add_u32 s67, s23, s29
    s_add_u32 s54, s54, 1
    s_and_b32 s54, s54, 7
    s_add_u32 s55, s54, 1
    s_lshl_b32 s29, s55, 7
    s_add_u32 s59, s24, s29
    s_mul_i32 s29, s55, 589824
    s_add_u32 s68, s23, s29
    s_add_u32 s54, s54, 1
    s_and_b32 s54, s54, 7
    s_add_u32 s55, s54, 1
    s_lshl_b32 s29, s55, 7
    s_add_u32 s60, s24, s29
    s_mul_i32 s29, s55, 589824
    s_add_u32 s69, s23, s29
    s_add_u32 s54, s54, 1
    s_and_b32 s54, s54, 7
    s_add_u32 s55, s54, 1
    s_lshl_b32 s29, s55, 7
    s_add_u32 s61, s24, s29
    s_mul_i32 s29, s55, 589824
    s_add_u32 s70, s23, s29
    s_add_u32 s54, s54, 1
    s_and_b32 s54, s54, 7
    s_add_u32 s55, s54, 1
    s_lshl_b32 s29, s55, 7
    s_add_u32 s62, s24, s29
    s_mul_i32 s29, s55, 589824
    s_add_u32 s71, s23, s29
    s_add_u32 s54, s54, 1
    s_and_b32 s54, s54, 7
    s_add_u32 s55, s54, 1
    s_lshl_b32 s29, s55, 7
    s_add_u32 s63, s24, s29
    s_mul_i32 s29, s55, 589824
    s_add_u32 s72, s23, s29
    s_add_u32 s54, s54, 1
    s_and_b32 s54, s54, 7
    s_add_u32 s55, s54, 1
    s_lshl_b32 s29, s55, 7
    s_add_u32 s64, s24, s29
    s_mul_i32 s29, s55, 589824
    s_add_u32 s73, s23, s29
    s_lshl_b32 s30, s20, 12
    s_lshl_b32 s31, s20, 11
    s_mov_b32 s27, 0xbdd2d3e8
    v_mov_b32 v15, 0xc0135761
    v_lshrrev_b32 v1, 3, v0
    v_and_b32 v2, 7, v0
    v_bfe_u32 v3, v0, 4, 1
    s_movk_i32 s55, 9216
    v_mul_lo_u32 v1, v1, s55
    v_or_b32 v4, 0, v3
    v_lshlrev_b32 v4, 1, v4
    v_xor_b32 v4, v4, v2
    v_lshl_add_u32 v4, v4, 4, v1
    v_or_b32 v5, 0, v3
    v_lshlrev_b32 v5, 1, v5
    v_xor_b32 v5, v5, v2
    v_lshl_add_u32 v5, v5, 4, v1
    v_add_u32 v5, 72704, v5
    v_or_b32 v6, 2, v3
    v_lshlrev_b32 v6, 1, v6
    v_xor_b32 v6, v6, v2
    v_lshl_add_u32 v6, v6, 4, v1
    v_or_b32 v7, 2, v3
    v_lshlrev_b32 v7, 1, v7
    v_xor_b32 v7, v7, v2
    v_lshl_add_u32 v7, v7, 4, v1
    v_add_u32 v7, 72704, v7
    v_lshrrev_b32 v1, 3, v0
    s_movk_i32 s55, 1152
    v_mul_lo_u32 v1, v1, s55
    v_lshrrev_b32 v3, 4, v0
    v_add_u32 v21, 0, v3
    v_and_b32 v21, 7, v21
    v_xor_b32 v21, v21, v2
    v_lshl_add_u32 v21, v21, 4, v1
    v_add_u32 v22, 4, v3
    v_and_b32 v22, 7, v22
    v_xor_b32 v22, v22, v2
    v_lshl_add_u32 v22, v22, 4, v1
    v_add_u32 v22, 8192, v22
    v_add_u32 v23, 8, v3
    v_and_b32 v23, 7, v23
    v_xor_b32 v23, v23, v2
    v_lshl_add_u32 v23, v23, 4, v1
    v_add_u32 v23, 16384, v23
    v_add_u32 v24, 12, v3
    v_and_b32 v24, 7, v24
    v_xor_b32 v24, v24, v2
    v_lshl_add_u32 v24, v24, 4, v1
    v_add_u32 v24, 24576, v24
    s_waitcnt lgkmcnt(0)
    s_mov_b32 s4, s32
    s_and_b32 s5, s33, 0xffff
    s_mov_b32 s6, 2359296
    s_mov_b32 s7, 0x00020000
    s_sub_u32 s38, s38, 2048
    s_subb_u32 s39, s39, 0
    s_add_u32 s8, s36, s52
    s_addc_u32 s9, s37, 0
    s_and_b32 s9, s9, 0xffff
    s_mov_b32 s10, 5308416
    s_mov_b32 s11, 0x00020000
    s_add_u32 s12, s38, s52
    s_addc_u32 s13, s39, 0
    s_and_b32 s13, s13, 0xffff
    s_mov_b32 s14, 5310464
    s_mov_b32 s15, 0x00020000
    s_add_u32 s55, s47, s49
    s_and_b32 s55, s55, 1
    s_cmp_eq_u32 s55, 0
    s_cbranch_scc1 ffn_fused_kernel_ord3
    s_add_u32 m0, s30, 16384
    s_nop 0
    buffer_load_dwordx4 v4, s[8:11], s65 offen lds
    buffer_load_dwordx4 v5, s[8:11], s65 offen offset:1024 lds
    buffer_load_dwordx4 v6, s[12:15], s65 offen offset:2048 lds
    buffer_load_dwordx4 v7, s[12:15], s65 offen offset:3072 lds
    s_add_u32 m0, s30, 0
    s_nop 0
    buffer_load_dwordx4 v21, s[4:7], s56 offen lds
    buffer_load_dwordx4 v22, s[4:7], s56 offen offset:1024 lds
    buffer_load_dwordx4 v23, s[4:7], s56 offen offset:2048 lds
    buffer_load_dwordx4 v24, s[4:7], s56 offen offset:3072 lds
    s_branch ffn_fused_kernel_ordd4
ffn_fused_kernel_ord3:
    s_add_u32 m0, s30, 0
    s_nop 0
    buffer_load_dwordx4 v21, s[4:7], s56 offen lds
    buffer_load_dwordx4 v22, s[4:7], s56 offen offset:1024 lds
    buffer_load_dwordx4 v23, s[4:7], s56 offen offset:2048 lds
    buffer_load_dwordx4 v24, s[4:7], s56 offen offset:3072 lds
    s_add_u32 m0, s30, 16384
    s_nop 0
    buffer_load_dwordx4 v4, s[8:11], s65 offen lds
    buffer_load_dwordx4 v5, s[8:11], s65 offen offset:1024 lds
    buffer_load_dwordx4 v6, s[12:15], s65 offen offset:2048 lds
    buffer_load_dwordx4 v7, s[12:15], s65 offen offset:3072 lds
ffn_fused_kernel_ordd4:
    v_writelane_b32 v54, s84, 0
    v_writelane_b32 v54, s85, 1
    v_writelane_b32 v54, s86, 2
    v_writelane_b32 v54, s87, 3
    v_writelane_b32 v54, s88, 4
    v_writelane_b32 v54, s89, 5
    v_writelane_b32 v54, s90, 6
    v_writelane_b32 v54, s91, 7
    s_mov_b32 s16, s34
    s_and_b32 s17, s35, 0xffff
    s_mov_b32 s18, 50331648
    s_mov_b32 s19, 0x00020000
    s_mul_i32 s24, s48, 288
    s_lshl_b32 s55, s20, 3
    s_add_u32 s24, s24, s55
    s_mul_i32 s24, s24, 1152
    s_add_u32 s54, s47, 0
    s_and_b32 s54, s54, 7
    s_add_u32 s54, s54, s51
    s_lshl_b32 s83, s54, 13
    s_mul_i32 s55, s54, 36864
    s_add_u32 s74, s24, s55
    s_add_u32 s54, s47, 1
    s_and_b32 s54, s54, 7
    s_add_u32 s54, s54, s51
    s_lshl_b32 s84, s54, 13
    s_mul_i32 s55, s54, 36864
    s_add_u32 s75, s24, s55
    s_add_u32 s54, s47, 2
    s_and_b32 s54, s54, 7
    s_add_u32 s54, s54, s51
    s_lshl_b32 s85, s54, 13
    s_mul_i32 s55, s54, 36864
    s_add_u32 s76, s24, s55
    s_add_u32 s54, s47, 3
    s_and_b32 s54, s54, 7
    s_add_u32 s54, s54, s51
    s_lshl_b32 s86, s54, 13
    s_mul_i32 s55, s54, 36864
    s_add_u32 s77, s24, s55
    s_add_u32 s54, s47, 4
    s_and_b32 s54, s54, 7
    s_add_u32 s54, s54, s51
    s_lshl_b32 s87, s54, 13
    s_mul_i32 s55, s54, 36864
    s_add_u32 s78, s24, s55
    s_add_u32 s54, s47, 5
    s_and_b32 s54, s54, 7
    s_add_u32 s54, s54, s51
    s_lshl_b32 s88, s54, 13
    s_mul_i32 s55, s54, 36864
    s_add_u32 s79, s24, s55
    s_add_u32 s54, s47, 6
    s_and_b32 s54, s54, 7
    s_add_u32 s54, s54, s51
    s_lshl_b32 s89, s54, 13
    s_mul_i32 s55, s54, 36864
    s_add_u32 s80, s24, s55
    s_add_u32 s54, s47, 7
    s_and_b32 s54, s54, 7
    s_add_u32 s54, s54, s51
    s_lshl_b32 s90, s54, 13
    s_mul_i32 s55, s54, 36864
    s_add_u32 s81, s24, s55
    s_xor_b32 s54, s51, 1
    s_lshl_b32 s54, s54, 3
    s_lshl_b32 s91, s54, 13
    s_mul_i32 s55, s54, 36864
    s_add_u32 s82, s24, s55
    s_mul_i32 s28, s20, 3072
    s_mul_i32 s25, s22, 6291456
    s_lshl_b32 s55, s48, 14
    s_add_u32 s25, s25, s55
    s_lshl_b32 s55, s46, 1
    s_add_u32 s55, s55, s21
    s_lshl_b32 s55, s55, 9
    s_add_u32 s25, s25, s55
    v_lshrrev_b32 v1, 4, v0
    v_bfe_u32 v2, v0, 2, 2
    v_and_b32 v3, 3, v0
    v_lshrrev_b32 v56, 1, v3
    v_lshrrev_b32 v57, 1, v1
    v_lshl_add_u32 v57, v57, 3, v2
    v_lshrrev_b32 v58, 1, v2
    v_lshl_or_b32 v60, v56, 1, v58
    v_and_b32 v59, 1, v1
    v_lshlrev_b32 v61, 4, v59
    v_and_b32 v62, 1, v3
    v_lshl_add_u32 v61, v62, 3, v61
    v_lshlrev_b32 v62, 11, v56
    v_lshl_add_u32 v62, v57, 7, v62
    v_add_u32 v62, v62, v61
    s_lshl_b32 s55, s22, 1
    v_xor_b32 v9, s55, v60
    v_lshl_add_u32 v8, v9, 5, v62
    s_lshl_b32 s55, s22, 1
    s_add_u32 s55, s55, 1
    v_xor_b32 v9, s55, v60
    v_lshl_add_u32 v11, v9, 5, v62
    v_add_u32 v9, 0x10000, v8
    v_add_u32 v12, 0x10000, v11
    v_add_u32 v10, 0x20000, v8
    v_add_u32 v13, 0x20000, v11
    v_lshlrev_b32 v62, 10, v56
    v_lshl_add_u32 v62, v57, 6, v62
    v_add_u32 v62, v62, v61
    v_xor_b32 v60, s22, v56
    v_lshl_add_u32 v18, v60, 5, v62
    v_add_u32 v19, 0x10000, v18
    v_add_u32 v20, 0x20000, v18
    v_lshrrev_b32 v60, 1, v1
    v_lshl_add_u32 v60, v60, 2, v2
    s_movk_i32 s55, 384
    v_mul_lo_u32 v60, v60, s55
    v_lshl_add_u32 v60, v59, 5, v60
    v_lshl_add_u32 v60, v3, 3, v60
    s_mul_i32 s55, s22, 3
    s_add_u32 s55, s55, 0
    v_xor_b32 v61, s55, v58
    v_lshl_add_u32 v37, v61, 6, v60
    v_add_u32 v38, 0x10000, v37
    v_add_u32 v39, 0x20000, v37
    s_mul_i32 s55, s22, 3
    s_add_u32 s55, s55, 1
    v_xor_b32 v61, s55, v58
    v_lshl_add_u32 v40, v61, 6, v60
    v_add_u32 v41, 0x10000, v40
    v_add_u32 v42, 0x20000, v40
    s_mul_i32 s55, s22, 3
    s_add_u32 s55, s55, 2
    v_xor_b32 v61, s55, v58
    v_lshl_add_u32 v43, v61, 6, v60
    v_add_u32 v44, 0x10000, v43
    v_add_u32 v45, 0x20000, v43
    v_add_u32 v60, 0, v0
    v_mul_u32_u24 v61, 2731, v60
    v_lshrrev_b32 v61, 16, v61
    v_mul_u32_u24 v62, 24, v61
    v_sub_u32 v62, v60, v62
    v_bfe_u32 v60, v61, 1, 1
    v_lshlrev_b32 v60, 2, v60
    v_xor_b32 v62, v62, v60
    v_mul_u32_u24 v61, 1152, v61
    v_lshl_add_u32 v34, v62, 4, v61
    v_add_u32 v60, 64, v0
    v_mul_u32_u24 v61, 2731, v60
    v_lshrrev_b32 v61, 16, v61
    v_mul_u32_u24 v62, 24, v61
    v_sub_u32 v62, v60, v62
    v_bfe_u32 v60, v61, 1, 1
    v_lshlrev_b32 v60, 2, v60
    v_xor_b32 v62, v62, v60
    v_mul_u32_u24 v61, 1152, v61
    v_lshl_add_u32 v35, v62, 4, v61
    v_subrev_u32 v35, 1024, v35
    v_add_u32 v60, 128, v0
    v_mul_u32_u24 v61, 2731, v60
    v_lshrrev_b32 v61, 16, v61
    v_mul_u32_u24 v62, 24, v61
    v_sub_u32 v62, v60, v62
    v_bfe_u32 v60, v61, 1, 1
    v_lshlrev_b32 v60, 2, v60
    v_xor_b32 v62, v62, v60
    v_mul_u32_u24 v61, 1152, v61
    v_lshl_add_u32 v36, v62, 4, v61
    v_subrev_u32 v36, 2048, v36
    v_lshrrev_b32 v1, 2, v0
    s_movk_i32 s55, 9216
    v_mul_lo_u32 v1, v1, s55
    v_and_b32 v2, 3, v0
    v_lshl_add_u32 v16, v2, 4, v1
    v_xor_b32 v2, 2, v2
    v_lshl_add_u32 v17, v2, 4, v1
    v_add_u32 v17, 1024, v17
    v_and_b32 v1, 31, v0
    s_lshl_b32 s55, s21, 6
    v_add_u32 v1, s55, v1
    v_lshlrev_b32 v1, 7, v1
    v_lshrrev_b32 v2, 5, v0
    v_bfe_u32 v3, v0, 1, 3
    v_xor_b32 v3, v2, v3
    v_lshl_add_u32 v25, v3, 4, v1
    v_xor_b32 v26, 32, v25
    v_xor_b32 v27, 64, v25
    v_xor_b32 v28, 96, v25
    v_and_b32 v1, 31, v0
    v_lshlrev_b32 v1, 3, v1
    v_mul_u32_u24 v46, 262144, v2
    v_add_u32 v46, v46, v1
    v_lshlrev_b32 v1, 4, v0
    s_lshl_b32 s55, s21, 11
    s_add_u32 s55, s55, 81920
    v_add_u32 v47, s55, v1
    s_add_u32 s55, s51, s22
    s_lshl_b32 s55, s55, 13
    v_add_u32 v14, s55, v47
    s_xor_b32 s55, s51, 1
    s_lshl_b32 s55, s55, 4
    s_add_u32 s55, s55, s22
    s_lshl_b32 s55, s55, 12
    v_add_u32 v33, s55, v47
    s_add_u32 m0, s30, 32768
    s_nop 0
    buffer_load_dwordx4 v21, s[4:7], s57 offen lds
    buffer_load_dwordx4 v22, s[4:7], s57 offen offset:1024 lds
    buffer_load_dwordx4 v23, s[4:7], s57 offen offset:2048 lds
    buffer_load_dwordx4 v24, s[4:7], s57 offen offset:3072 lds
    s_add_u32 m0, s30, 49152
    s_nop 0
    buffer_load_dwordx4 v4, s[8:11], s66 offen lds
    buffer_load_dwordx4 v5, s[8:11], s66 offen offset:1024 lds
    buffer_load_dwordx4 v6, s[12:15], s66 offen offset:2048 lds
    buffer_load_dwordx4 v7, s[12:15], s66 offen offset:3072 lds
    v_lshrrev_b32 v156, 4, v0
    v_bfe_u32 v157, v0, 2, 2
    v_and_b32 v158, 3, v0
    v_lshl_add_u32 v159, v156, 3, v157
    v_bfe_u32 v160, v159, 1, 3
    v_lshrrev_b32 v161, 1, v158
    v_xor_b32 v160, v160, v161
    v_lshlrev_b32 v159, 7, v159
    v_lshl_add_u32 v159, v160, 4, v159
    v_and_b32 v161, 1, v158
    v_lshl_add_u32 v159, v161, 3, v159
    v_add_u32 v192, s30, v159
    v_xor_b32 v193, 32, v192
    v_xor_b32 v194, 64, v192
    v_xor_b32 v195, 96, v192
    v_lshl_add_u32 v159, v156, 3, v157
    v_add_u32 v159, 4, v159
    v_bfe_u32 v160, v159, 1, 3
    v_lshrrev_b32 v161, 1, v158
    v_xor_b32 v160, v160, v161
    v_lshlrev_b32 v159, 7, v159
    v_lshl_add_u32 v159, v160, 4, v159
    v_and_b32 v161, 1, v158
    v_lshl_add_u32 v159, v161, 3, v159
    v_add_u32 v196, s30, v159
    v_xor_b32 v197, 32, v196
    v_xor_b32 v198, 64, v196
    v_xor_b32 v199, 96, v196
    s_and_b32 s26, s48, 3
    s_lshl_b32 s26, s26, 5
    v_xor_b32 v201, s26, v192
    v_xor_b32 v202, s26, v196
    v_and_b32 v159, 15, v0
    v_lshlrev_b32 v159, 12, v159
    v_lshl_add_u32 v200, v156, 4, v159
    s_waitcnt vmcnt(8)
    s_barrier
    v_add_u32 v29, 0, v25
    v_add_u32 v30, 0, v26
    v_add_u32 v31, 0, v27
    v_add_u32 v32, 0, v28
    ds_read_b128 a[0:3], v29
    ds_read_b128 a[4:7], v29 offset:4096
    ds_read_b64_tr_b16 v[72:73], v8 offset:16384
    ds_read_b64_tr_b16 v[74:75], v8 offset:16896
    ds_read_b64_tr_b16 v[76:77], v11 offset:16384
    ds_read_b64_tr_b16 v[78:79], v11 offset:16896
    ds_read_b128 a[8:11], v30
    ds_read_b128 a[12:15], v30 offset:4096
    ds_read_b64_tr_b16 v[80:81], v8 offset:20480
    ds_read_b64_tr_b16 v[82:83], v8 offset:20992
    ds_read_b64_tr_b16 v[84:85], v11 offset:20480
    ds_read_b64_tr_b16 v[86:87], v11 offset:20992
    s_waitcnt lgkmcnt(6)
    v_mfma_f32_32x32x16_bf16 v[128:143], v[72:75], a[0:3], 0
    ds_read_b128 a[16:19], v31
    ds_read_b128 a[20:23], v31 offset:4096
    s_add_u32 m0, s30, 65536
    s_nop 0
    buffer_load_dwordx4 v21, s[4:7], s58 offen lds
    v_mfma_f32_32x32x16_bf16 v[144:159], v[72:75], a[4:7], 0
    ds_read_b64_tr_b16 v[220:221], v201 offset:0
    ds_read_b64_tr_b16 v[222:223], v202 offset:0
    ds_read_b64_tr_b16 v[88:89], v8 offset:24576
    ds_read_b64_tr_b16 v[90:91], v8 offset:25088
    v_mfma_f32_32x32x16_bf16 v[160:175], v[76:79], a[0:3], 0
    ds_read_b64_tr_b16 v[92:93], v11 offset:24576
    ds_read_b64_tr_b16 v[94:95], v11 offset:25088
    buffer_load_dwordx4 v22, s[4:7], s58 offen offset:1024 lds
    v_mfma_f32_32x32x16_bf16 v[176:191], v[76:79], a[4:7], 0
    buffer_load_dwordx4 v23, s[4:7], s58 offen offset:2048 lds
    s_waitcnt lgkmcnt(8)
    v_mfma_f32_32x32x16_bf16 v[128:143], v[80:83], a[8:11], v[128:143]
    ds_read_b128 a[24:27], v32
    ds_read_b128 a[28:31], v32 offset:4096
    buffer_load_dwordx4 v24, s[4:7], s58 offen offset:3072 lds
    v_mfma_f32_32x32x16_bf16 v[144:159], v[80:83], a[12:15], v[144:159]
    ds_read_b64_tr_b16 v[72:73], v8 offset:28672
    ds_read_b64_tr_b16 v[74:75], v8 offset:29184
    s_add_u32 m0, s30, 106496
    s_nop 0
    buffer_load_dwordx4 v4, s[8:11], s67 offen lds
    v_mfma_f32_32x32x16_bf16 v[160:175], v[84:87], a[8:11], v[160:175]
    ds_read_b64_tr_b16 v[76:77], v11 offset:28672
    ds_read_b64_tr_b16 v[78:79], v11 offset:29184
    buffer_load_dwordx4 v5, s[8:11], s67 offen offset:1024 lds
    v_mfma_f32_32x32x16_bf16 v[176:191], v[84:87], a[12:15], v[176:191]
    buffer_load_dwordx4 v6, s[12:15], s67 offen offset:2048 lds
    s_waitcnt lgkmcnt(6)
    v_mfma_f32_32x32x16_bf16 v[128:143], v[88:91], a[16:19], v[128:143]
    s_waitcnt vmcnt(7)
    s_waitcnt lgkmcnt(0)
    s_barrier
    v_mfma_f32_32x32x16_bf16 v[144:159], v[88:91], a[20:23], v[144:159]
    v_add_u32 v29, 32768, v25
    v_add_u32 v30, 32768, v26
    v_add_u32 v31, 32768, v27
    v_add_u32 v32, 32768, v28
    buffer_load_dwordx4 v7, s[12:15], s67 offen offset:3072 lds
    v_mfma_f32_32x32x16_bf16 v[160:175], v[92:95], a[16:19], v[160:175]
    ds_read_b128 a[32:35], v29
    ds_read_b128 a[36:39], v29 offset:4096
    ds_read_b64_tr_b16 v[80:81], v8 offset:49152
    s_add_u32 m0, s30, 122880
    s_nop 0
    buffer_load_dwordx4 v21, s[4:7], s59 offen lds
    v_mfma_f32_32x32x16_bf16 v[176:191], v[92:95], a[20:23], v[176:191]
    ds_read_b64_tr_b16 v[82:83], v8 offset:49664
    ds_read_b64_tr_b16 v[84:85], v11 offset:49152
    ds_read_b64_tr_b16 v[86:87], v11 offset:49664
    buffer_load_dwordx4 v22, s[4:7], s59 offen offset:1024 lds
    v_mfma_f32_32x32x16_bf16 v[128:143], v[72:75], a[24:27], v[128:143]
    ds_read_b128 a[40:43], v30
    ds_read_b128 a[44:47], v30 offset:4096
    buffer_load_dwordx4 v23, s[4:7], s59 offen offset:2048 lds
    v_mfma_f32_32x32x16_bf16 v[144:159], v[72:75], a[28:31], v[144:159]
    ds_read_b64_tr_b16 v[204:205], v192 offset:32768
    ds_read_b64_tr_b16 v[206:207], v196 offset:32768
    ds_read_b64_tr_b16 v[208:209], v193 offset:32768
    ds_read_b64_tr_b16 v[210:211], v197 offset:32768
    ds_read_b64_tr_b16 v[212:213], v194 offset:32768
    ds_read_b64_tr_b16 v[214:215], v198 offset:32768
    ds_read_b64_tr_b16 v[216:217], v195 offset:32768
    ds_read_b64_tr_b16 v[218:219], v199 offset:32768
    ds_read_b64_tr_b16 v[88:89], v8 offset:53248
    ds_read_b64_tr_b16 v[90:91], v8 offset:53760
    buffer_load_dwordx4 v24, s[4:7], s59 offen offset:3072 lds
    v_mfma_f32_32x32x16_bf16 v[160:175], v[76:79], a[24:27], v[160:175]
    ds_read_b64_tr_b16 v[92:93], v11 offset:53248
    ds_read_b64_tr_b16 v[94:95], v11 offset:53760
    s_add_u32 m0, s30, 139264
    s_nop 0
    buffer_load_dwordx4 v4, s[8:11], s68 offen lds
    v_mfma_f32_32x32x16_bf16 v[176:191], v[76:79], a[28:31], v[176:191]
    buffer_load_dwordx4 v5, s[8:11], s68 offen offset:1024 lds
    s_waitcnt lgkmcnt(14)
    v_mfma_f32_32x32x16_bf16 v[128:143], v[80:83], a[32:35], v[128:143]
    ds_read_b128 a[48:51], v31
    ds_read_b128 a[52:55], v31 offset:4096
    buffer_load_dwordx4 v6, s[12:15], s68 offen offset:2048 lds
    v_mfma_f32_32x32x16_bf16 v[144:159], v[80:83], a[36:39], v[144:159]
    ds_read_b64_tr_b16 v[72:73], v8 offset:57344
    ds_read_b64_tr_b16 v[74:75], v8 offset:57856
    buffer_load_dwordx4 v7, s[12:15], s68 offen offset:3072 lds
    v_mfma_f32_32x32x16_bf16 v[160:175], v[84:87], a[32:35], v[160:175]
    ds_read_b64_tr_b16 v[76:77], v11 offset:57344
    ds_read_b64_tr_b16 v[78:79], v11 offset:57856
    s_add_u32 m0, s30, 0
    s_nop 0
    buffer_load_dwordx4 v21, s[4:7], s60 offen lds
    v_mfma_f32_32x32x16_bf16 v[176:191], v[84:87], a[36:39], v[176:191]
    buffer_load_dwordx4 v22, s[4:7], s60 offen offset:1024 lds
    s_waitcnt lgkmcnt(6)
    v_mfma_f32_32x32x16_bf16 v[128:143], v[88:91], a[40:43], v[128:143]
    ds_read_b128 a[56:59], v32
    ds_read_b128 a[60:63], v32 offset:4096
    v_mfma_f32_32x32x16_bf16 v[144:159], v[88:91], a[44:47], v[144:159]
    ds_read_b64_tr_b16 v[80:81], v8 offset:61440
    ds_read_b64_tr_b16 v[82:83], v8 offset:61952
    buffer_load_dwordx4 v23, s[4:7], s60 offen offset:2048 lds
    v_mfma_f32_32x32x16_bf16 v[160:175], v[92:95], a[40:43], v[160:175]
    ds_read_b64_tr_b16 v[84:85], v11 offset:61440
    ds_read_b64_tr_b16 v[86:87], v11 offset:61952
    v_mfma_f32_32x32x16_bf16 v[176:191], v[92:95], a[44:47], v[176:191]
    buffer_load_dwordx4 v24, s[4:7], s60 offen offset:3072 lds
    s_waitcnt lgkmcnt(6)
    v_mfma_f32_32x32x16_bf16 v[128:143], v[72:75], a[48:51], v[128:143]
    s_waitcnt vmcnt(12)
    s_waitcnt lgkmcnt(0)
    s_barrier
    v_mfma_f32_32x32x16_bf16 v[144:159], v[72:75], a[52:55], v[144:159]
    v_add_u32 v29, 65536, v25
    v_add_u32 v30, 65536, v26
    v_add_u32 v31, 65536, v27
    v_add_u32 v32, 65536, v28
    v_mfma_f32_32x32x16_bf16 v[160:175], v[76:79], a[48:51], v[160:175]
    ds_read_b128 a[64:67], v29
    ds_read_b128 a[68:71], v29 offset:4096
    ds_read_b64_tr_b16 v[88:89], v9 offset:40960
    s_add_u32 m0, s30, 16384
    s_nop 0
    buffer_load_dwordx4 v4, s[8:11], s69 offen lds
    v_mfma_f32_32x32x16_bf16 v[176:191], v[76:79], a[52:55], v[176:191]
    ds_read_b64_tr_b16 v[90:91], v9 offset:41472
    ds_read_b64_tr_b16 v[92:93], v12 offset:40960
    ds_read_b64_tr_b16 v[94:95], v12 offset:41472
    buffer_load_dwordx4 v5, s[8:11], s69 offen offset:1024 lds
    v_mfma_f32_32x32x16_bf16 v[128:143], v[80:83], a[56:59], v[128:143]
    ds_read_b128 a[72:75], v30
    ds_read_b128 a[76:79], v30 offset:4096
    buffer_load_dwordx4 v6, s[12:15], s69 offen offset:2048 lds
    v_mfma_f32_32x32x16_bf16 v[144:159], v[80:83], a[60:63], v[144:159]
    ds_read_b64_tr_b16 v[72:73], v9 offset:45056
    ds_read_b64_tr_b16 v[74:75], v9 offset:45568
    buffer_load_dwordx4 v7, s[12:15], s69 offen offset:3072 lds
    v_mfma_f32_32x32x16_bf16 v[160:175], v[84:87], a[56:59], v[160:175]
    ds_read_b64_tr_b16 v[76:77], v12 offset:45056
    ds_read_b64_tr_b16 v[78:79], v12 offset:45568
    s_add_u32 m0, s30, 32768
    s_nop 0
    buffer_load_dwordx4 v21, s[4:7], s61 offen lds
    v_mfma_f32_32x32x16_bf16 v[176:191], v[84:87], a[60:63], v[176:191]
    buffer_load_dwordx4 v22, s[4:7], s61 offen offset:1024 lds
    s_waitcnt lgkmcnt(6)
    v_mfma_f32_32x32x16_bf16 v[128:143], v[88:91], a[64:67], v[128:143]
    ds_read_b128 a[80:83], v31
    ds_read_b128 a[84:87], v31 offset:4096
    v_mfma_f32_32x32x16_bf16 v[144:159], v[88:91], a[68:71], v[144:159]
    ds_read_b64_tr_b16 v[80:81], v9 offset:49152
    ds_read_b64_tr_b16 v[82:83], v9 offset:49664
    buffer_load_dwordx4 v23, s[4:7], s61 offen offset:2048 lds
    v_mfma_f32_32x32x16_bf16 v[160:175], v[92:95], a[64:67], v[160:175]
    ds_read_b64_tr_b16 v[84:85], v12 offset:49152
    ds_read_b64_tr_b16 v[86:87], v12 offset:49664
    v_mfma_f32_32x32x16_bf16 v[176:191], v[92:95], a[68:71], v[176:191]
    buffer_load_dwordx4 v24, s[4:7], s61 offen offset:3072 lds
    s_waitcnt lgkmcnt(6)
    v_mfma_f32_32x32x16_bf16 v[128:143], v[72:75], a[72:75], v[128:143]
    ds_read_b128 a[88:91], v32
    ds_read_b128 a[92:95], v32 offset:4096
    v_mfma_f32_32x32x16_bf16 v[144:159], v[72:75], a[76:79], v[144:159]
    ds_read_b64_tr_b16 v[88:89], v9 offset:53248
    ds_read_b64_tr_b16 v[90:91], v9 offset:53760
    s_add_u32 m0, s30, 49152
    s_nop 0
    buffer_load_dwordx4 v4, s[8:11], s70 offen lds
    v_mfma_f32_32x32x16_bf16 v[160:175], v[76:79], a[72:75], v[160:175]
    ds_read_b64_tr_b16 v[92:93], v12 offset:53248
    ds_read_b64_tr_b16 v[94:95], v12 offset:53760
    v_mfma_f32_32x32x16_bf16 v[176:191], v[76:79], a[76:79], v[176:191]
    buffer_load_dwordx4 v5, s[8:11], s70 offen offset:1024 lds
    s_waitcnt lgkmcnt(6)
    v_mfma_f32_32x32x16_bf16 v[128:143], v[80:83], a[80:83], v[128:143]
    s_waitcnt vmcnt(14)
    s_waitcnt lgkmcnt(0)
    s_barrier
    v_mfma_f32_32x32x16_bf16 v[144:159], v[80:83], a[84:87], v[144:159]
    v_add_u32 v29, 122880, v25
    v_add_u32 v30, 122880, v26
    v_add_u32 v31, 122880, v27
    v_add_u32 v32, 122880, v28
    v_mfma_f32_32x32x16_bf16 v[160:175], v[84:87], a[80:83], v[160:175]
    ds_read_b128 a[96:99], v29
    ds_read_b128 a[100:103], v29 offset:4096
    ds_read_b64_tr_b16 v[72:73], v10 offset:8192
    buffer_load_dwordx4 v6, s[12:15], s70 offen offset:2048 lds
    v_mfma_f32_32x32x16_bf16 v[176:191], v[84:87], a[84:87], v[176:191]
    ds_read_b64_tr_b16 v[74:75], v10 offset:8704
    ds_read_b64_tr_b16 v[76:77], v13 offset:8192
    ds_read_b64_tr_b16 v[78:79], v13 offset:8704
    buffer_load_dwordx4 v7, s[12:15], s70 offen offset:3072 lds
    v_mfma_f32_32x32x16_bf16 v[128:143], v[88:91], a[88:91], v[128:143]
    ds_read_b128 a[104:107], v30
    ds_read_b128 a[108:111], v30 offset:4096
    s_add_u32 m0, s30, 65536
    s_nop 0
    buffer_load_dwordx4 v21, s[4:7], s62 offen lds
    v_mfma_f32_32x32x16_bf16 v[144:159], v[88:91], a[92:95], v[144:159]
    ds_read_b64_tr_b16 v[80:81], v10 offset:12288
    ds_read_b64_tr_b16 v[82:83], v10 offset:12800
    buffer_load_dwordx4 v22, s[4:7], s62 offen offset:1024 lds
    v_mfma_f32_32x32x16_bf16 v[160:175], v[92:95], a[88:91], v[160:175]
    ds_read_b64_tr_b16 v[84:85], v13 offset:12288
    ds_read_b64_tr_b16 v[86:87], v13 offset:12800
    v_mfma_f32_32x32x16_bf16 v[176:191], v[92:95], a[92:95], v[176:191]
    buffer_load_dwordx4 v23, s[4:7], s62 offen offset:2048 lds
    s_waitcnt lgkmcnt(6)
    v_mfma_f32_32x32x16_bf16 v[128:143], v[72:75], a[96:99], v[128:143]
    ds_read_b128 a[112:115], v31
    ds_read_b128 a[116:119], v31 offset:4096
    v_mfma_f32_32x32x16_bf16 v[144:159], v[72:75], a[100:103], v[144:159]
    ds_read_b64_tr_b16 v[88:89], v10 offset:16384
    ds_read_b64_tr_b16 v[90:91], v10 offset:16896
    buffer_load_dwordx4 v24, s[4:7], s62 offen offset:3072 lds
    v_mfma_f32_32x32x16_bf16 v[160:175], v[76:79], a[96:99], v[160:175]
    ds_read_b64_tr_b16 v[92:93], v13 offset:16384
    ds_read_b64_tr_b16 v[94:95], v13 offset:16896
    v_mfma_f32_32x32x16_bf16 v[176:191], v[76:79], a[100:103], v[176:191]
    s_add_u32 m0, s30, 106496
    s_nop 0
    buffer_load_dwordx4 v4, s[8:11], s71 offen lds
    s_waitcnt lgkmcnt(6)
    v_mfma_f32_32x32x16_bf16 v[128:143], v[80:83], a[104:107], v[128:143]
    ds_read_b128 a[120:123], v32
    ds_read_b128 a[124:127], v32 offset:4096
    v_mfma_f32_32x32x16_bf16 v[144:159], v[80:83], a[108:111], v[144:159]
    ds_read_b64_tr_b16 v[72:73], v10 offset:20480
    ds_read_b64_tr_b16 v[74:75], v10 offset:20992
    buffer_load_dwordx4 v5, s[8:11], s71 offen offset:1024 lds
    v_mfma_f32_32x32x16_bf16 v[160:175], v[84:87], a[104:107], v[160:175]
    ds_read_b64_tr_b16 v[76:77], v13 offset:20480
    ds_read_b64_tr_b16 v[78:79], v13 offset:20992
    v_mfma_f32_32x32x16_bf16 v[176:191], v[84:87], a[108:111], v[176:191]
    buffer_load_dwordx4 v6, s[12:15], s71 offen offset:2048 lds
    s_waitcnt lgkmcnt(6)
    v_mfma_f32_32x32x16_bf16 v[128:143], v[88:91], a[112:115], v[128:143]
    s_waitcnt vmcnt(15)
    s_waitcnt lgkmcnt(0)
    s_barrier
    v_mfma_f32_32x32x16_bf16 v[144:159], v[88:91], a[116:119], v[144:159]
    v_add_u32 v29, 0, v25
    v_add_u32 v30, 0, v26
    v_add_u32 v31, 0, v27
    v_add_u32 v32, 0, v28
    v_mfma_f32_32x32x16_bf16 v[160:175], v[92:95], a[112:115], v[160:175]
    ds_read_b128 a[128:131], v29
    ds_read_b128 a[132:135], v29 offset:4096
    ds_read_b64_tr_b16 v[80:81], v8 offset:16384
    buffer_load_dwordx4 v7, s[12:15], s71 offen offset:3072 lds
    v_mfma_f32_32x32x16_bf16 v[176:191], v[92:95], a[116:119], v[176:191]
    ds_read_b64_tr_b16 v[82:83], v8 offset:16896
    ds_read_b64_tr_b16 v[84:85], v11 offset:16384
    ds_read_b64_tr_b16 v[86:87], v11 offset:16896
    v_mfma_f32_32x32x16_bf16 v[128:143], v[72:75], a[120:123], v[128:143]
    ds_read_b128 a[136:139], v30
    ds_read_b128 a[140:143], v30 offset:4096
    s_add_u32 m0, s30, 122880
    s_nop 0
    buffer_load_dwordx4 v21, s[4:7], s63 offen lds
    v_mfma_f32_32x32x16_bf16 v[144:159], v[72:75], a[124:127], v[144:159]
    ds_read_b64_tr_b16 v[88:89], v8 offset:20480
    ds_read_b64_tr_b16 v[90:91], v8 offset:20992
    buffer_load_dwordx4 v22, s[4:7], s63 offen offset:1024 lds
    v_mfma_f32_32x32x16_bf16 v[160:175], v[76:79], a[120:123], v[160:175]
    ds_read_b64_tr_b16 v[92:93], v11 offset:20480
    ds_read_b64_tr_b16 v[94:95], v11 offset:20992
    buffer_load_dwordx4 v23, s[4:7], s63 offen offset:2048 lds
    v_mfma_f32_32x32x16_bf16 v[176:191], v[76:79], a[124:127], v[176:191]
    s_waitcnt lgkmcnt(6)
    v_mfma_f32_32x32x16_bf16 v[128:143], v[80:83], a[128:131], v[128:143]
    ds_read_b128 a[144:147], v31
    ds_read_b128 a[148:151], v31 offset:4096
    buffer_load_dwordx4 v24, s[4:7], s63 offen offset:3072 lds
    v_mfma_f32_32x32x16_bf16 v[144:159], v[80:83], a[132:135], v[144:159]
    ds_read_b64_tr_b16 v[72:73], v8 offset:24576
    ds_read_b64_tr_b16 v[74:75], v8 offset:25088
    v_mfma_f32_32x32x16_bf16 v[160:175], v[84:87], a[128:131], v[160:175]
    ds_read_b64_tr_b16 v[76:77], v11 offset:24576
    ds_read_b64_tr_b16 v[78:79], v11 offset:25088
    s_add_u32 m0, s30, 139264
    s_nop 0
    buffer_load_dwordx4 v4, s[8:11], s72 offen lds
    v_mfma_f32_32x32x16_bf16 v[176:191], v[84:87], a[132:135], v[176:191]
    s_waitcnt lgkmcnt(6)
    v_mfma_f32_32x32x16_bf16 v[128:143], v[88:91], a[136:139], v[128:143]
    ds_read_b128 a[152:155], v32
    ds_read_b128 a[156:159], v32 offset:4096
    buffer_load_dwordx4 v5, s[8:11], s72 offen offset:1024 lds
    v_mfma_f32_32x32x16_bf16 v[144:159], v[88:91], a[140:143], v[144:159]
    ds_read_b64_tr_b16 v[80:81], v8 offset:28672
    ds_read_b64_tr_b16 v[82:83], v8 offset:29184
    v_mfma_f32_32x32x16_bf16 v[160:175], v[92:95], a[136:139], v[160:175]
    ds_read_b64_tr_b16 v[84:85], v11 offset:28672
    ds_read_b64_tr_b16 v[86:87], v11 offset:29184
    buffer_load_dwordx4 v6, s[12:15], s72 offen offset:2048 lds
    v_mfma_f32_32x32x16_bf16 v[176:191], v[92:95], a[140:143], v[176:191]
    s_waitcnt lgkmcnt(6)
    v_mfma_f32_32x32x16_bf16 v[128:143], v[72:75], a[144:147], v[128:143]
    s_waitcnt vmcnt(15)
    s_waitcnt lgkmcnt(0)
    s_barrier
    v_mfma_f32_32x32x16_bf16 v[144:159], v[72:75], a[148:151], v[144:159]
    v_add_u32 v29, 32768, v25
    v_add_u32 v30, 32768, v26
    v_add_u32 v31, 32768, v27
    v_add_u32 v32, 32768, v28
    v_mfma_f32_32x32x16_bf16 v[160:175], v[76:79], a[144:147], v[160:175]
    ds_read_b128 a[160:163], v29
    ds_read_b128 a[164:167], v29 offset:4096
    ds_read_b64_tr_b16 v[88:89], v8 offset:49152
    buffer_load_dwordx4 v7, s[12:15], s72 offen offset:3072 lds
    v_mfma_f32_32x32x16_bf16 v[176:191], v[76:79], a[148:151], v[176:191]
    ds_read_b64_tr_b16 v[90:91], v8 offset:49664
    ds_read_b64_tr_b16 v[92:93], v11 offset:49152
    ds_read_b64_tr_b16 v[94:95], v11 offset:49664
    s_add_u32 m0, s30, 0
    s_nop 0
    buffer_load_dwordx4 v21, s[4:7], s64 offen lds
    v_mfma_f32_32x32x16_bf16 v[128:143], v[80:83], a[152:155], v[128:143]
    ds_read_b128 a[168:171], v30
    ds_read_b128 a[172:175], v30 offset:4096
    buffer_load_dwordx4 v22, s[4:7], s64 offen offset:1024 lds
    v_mfma_f32_32x32x16_bf16 v[144:159], v[80:83], a[156:159], v[144:159]
    ds_read_b64_tr_b16 v[72:73], v8 offset:53248
    ds_read_b64_tr_b16 v[74:75], v8 offset:53760
    buffer_load_dwordx4 v23, s[4:7], s64 offen offset:2048 lds
    v_mfma_f32_32x32x16_bf16 v[160:175], v[84:87], a[152:155], v[160:175]
    ds_read_b64_tr_b16 v[76:77], v11 offset:53248
    ds_read_b64_tr_b16 v[78:79], v11 offset:53760
    v_mfma_f32_32x32x16_bf16 v[176:191], v[84:87], a[156:159], v[176:191]
    buffer_load_dwordx4 v24, s[4:7], s64 offen offset:3072 lds
    s_waitcnt lgkmcnt(6)
    v_mfma_f32_32x32x16_bf16 v[128:143], v[88:91], a[160:163], v[128:143]
    ds_read_b128 a[176:179], v31
    ds_read_b128 a[180:183], v31 offset:4096
    s_and_b32 s26, s48, 3
    s_lshl_b32 s26, s26, 16
    s_lshl_b32 s55, s46, 8
    v_mfma_f32_32x32x16_bf16 v[144:159], v[88:91], a[164:167], v[144:159]
    ds_read_b64_tr_b16 v[80:81], v8 offset:57344
    ds_read_b64_tr_b16 v[82:83], v8 offset:57856
    s_add_u32 m0, s30, 16384
    s_nop 0
    buffer_load_dwordx4 v4, s[8:11], s73 offen lds
    v_mfma_f32_32x32x16_bf16 v[160:175], v[92:95], a[160:163], v[160:175]
    ds_read_b64_tr_b16 v[84:85], v11 offset:57344
    ds_read_b64_tr_b16 v[86:87], v11 offset:57856
    v_mfma_f32_32x32x16_bf16 v[176:191], v[92:95], a[164:167], v[176:191]
    buffer_load_dwordx4 v5, s[8:11], s73 offen offset:1024 lds
    s_waitcnt lgkmcnt(6)
    v_mfma_f32_32x32x16_bf16 v[128:143], v[72:75], a[168:171], v[128:143]
    ds_read_b128 a[184:187], v32
    ds_read_b128 a[188:191], v32 offset:4096
    s_add_u32 s26, s26, s55
    s_lshl_b32 s55, s20, 6
    s_add_u32 s26, s26, s55
    v_mfma_f32_32x32x16_bf16 v[144:159], v[72:75], a[172:175], v[144:159]
    ds_read_b64_tr_b16 v[88:89], v8 offset:61440
    ds_read_b64_tr_b16 v[90:91], v8 offset:61952
    buffer_load_dwordx4 v6, s[12:15], s73 offen offset:2048 lds
    v_mfma_f32_32x32x16_bf16 v[160:175], v[76:79], a[168:171], v[160:175]
    ds_read_b64_tr_b16 v[92:93], v11 offset:61440
    ds_read_b64_tr_b16 v[94:95], v11 offset:61952
    v_mfma_f32_32x32x16_bf16 v[176:191], v[76:79], a[172:175], v[176:191]
    buffer_load_dwordx4 v7, s[12:15], s73 offen offset:3072 lds
    s_waitcnt lgkmcnt(6)
    v_mfma_f32_32x32x16_bf16 v[128:143], v[80:83], a[176:179], v[128:143]
    s_waitcnt vmcnt(16)
    s_waitcnt lgkmcnt(0)
    s_barrier
    v_mfma_f32_32x32x16_bf16 v[144:159], v[80:83], a[180:183], v[144:159]
    v_add_u32 v29, 65536, v25
    v_add_u32 v30, 65536, v26
    v_add_u32 v31, 65536, v27
    v_add_u32 v32, 65536, v28
    s_add_u32 s26, s26, 41943040
    v_mfma_f32_32x32x16_bf16 v[160:175], v[84:87], a[176:179], v[160:175]
    ds_read_b128 a[192:195], v29
    ds_read_b128 a[196:199], v29 offset:4096
    ds_read_b64_tr_b16 v[72:73], v9 offset:40960
    v_mfma_f32_32x32x16_bf16 v[176:191], v[84:87], a[180:183], v[176:191]
    ds_read_b64_tr_b16 v[74:75], v9 offset:41472
    ds_read_b64_tr_b16 v[76:77], v12 offset:40960
    ds_read_b64_tr_b16 v[78:79], v12 offset:41472
    buffer_store_dwordx4 v[220:223], v200, s[16:19], s26 offen
    v_mfma_f32_32x32x16_bf16 v[128:143], v[88:91], a[184:187], v[128:143]
    ds_read_b128 a[200:203], v30
    ds_read_b128 a[204:207], v30 offset:4096
    s_add_u32 s8, s8, 128
    s_addc_u32 s9, s9, 0
    s_add_u32 s12, s12, 128
    s_addc_u32 s13, s13, 0
    s_add_u32 m0, s30, 32768
    s_nop 0
    buffer_load_dwordx4 v4, s[8:11], s65 offen lds
    v_mfma_f32_32x32x16_bf16 v[144:159], v[88:91], a[188:191], v[144:159]
    ds_read_b64_tr_b16 v[80:81], v9 offset:45056
    ds_read_b64_tr_b16 v[82:83], v9 offset:45568
    buffer_load_dwordx4 v5, s[8:11], s65 offen offset:1024 lds
    s_sub_u32 s26, s57, s56
    v_mfma_f32_32x32x16_bf16 v[160:175], v[92:95], a[184:187], v[160:175]
    ds_read_b64_tr_b16 v[84:85], v12 offset:45056
    ds_read_b64_tr_b16 v[86:87], v12 offset:45568
    buffer_load_dwordx4 v6, s[12:15], s65 offen offset:2048 lds
    s_lshl_b32 s26, s26, 11
    v_mfma_f32_32x32x16_bf16 v[176:191], v[92:95], a[188:191], v[176:191]
    s_waitcnt lgkmcnt(6)
    v_mfma_f32_32x32x16_bf16 v[128:143], v[72:75], a[192:195], v[128:143]
    ds_read_b128 a[208:211], v31
    ds_read_b128 a[212:215], v31 offset:4096
    buffer_load_dwordx4 v7, s[12:15], s65 offen offset:3072 lds
    s_lshl_b32 s55, s46, 8
    v_mfma_f32_32x32x16_bf16 v[144:159], v[72:75], a[196:199], v[144:159]
    ds_read_b64_tr_b16 v[88:89], v9 offset:49152
    ds_read_b64_tr_b16 v[90:91], v9 offset:49664
    s_add_u32 s26, s26, s55
    v_mfma_f32_32x32x16_bf16 v[160:175], v[76:79], a[192:195], v[160:175]
    ds_read_b64_tr_b16 v[92:93], v12 offset:49152
    ds_read_b64_tr_b16 v[94:95], v12 offset:49664
    s_add_u32 m0, s30, 49152
    s_nop 0
    buffer_load_dwordx4 v4, s[8:11], s66 offen lds
    v_mfma_f32_32x32x16_bf16 v[176:191], v[76:79], a[196:199], v[176:191]
    s_waitcnt lgkmcnt(6)
    v_mfma_f32_32x32x16_bf16 v[128:143], v[80:83], a[200:203], v[128:143]
    ds_read_b128 a[216:219], v32
    ds_read_b128 a[220:223], v32 offset:4096
    buffer_load_dwordx4 v5, s[8:11], s66 offen offset:1024 lds
    s_lshl_b32 s55, s20, 6
    v_mfma_f32_32x32x16_bf16 v[144:159], v[80:83], a[204:207], v[144:159]
    ds_read_b64_tr_b16 v[72:73], v9 offset:53248
    ds_read_b64_tr_b16 v[74:75], v9 offset:53760
    s_add_u32 s26, s26, s55
    v_mfma_f32_32x32x16_bf16 v[160:175], v[84:87], a[200:203], v[160:175]
    ds_read_b64_tr_b16 v[76:77], v12 offset:53248
    ds_read_b64_tr_b16 v[78:79], v12 offset:53760
    buffer_load_dwordx4 v6, s[12:15], s66 offen offset:2048 lds
    v_mfma_f32_32x32x16_bf16 v[176:191], v[84:87], a[204:207], v[176:191]
    s_waitcnt lgkmcnt(6)
    v_mfma_f32_32x32x16_bf16 v[128:143], v[88:91], a[208:211], v[128:143]
    s_waitcnt vmcnt(16)
    s_waitcnt lgkmcnt(0)
    s_barrier
    v_mfma_f32_32x32x16_bf16 v[144:159], v[88:91], a[212:215], v[144:159]
    v_add_u32 v29, 122880, v25
    v_add_u32 v30, 122880, v26
    v_add_u32 v31, 122880, v27
    v_add_u32 v32, 122880, v28
    s_add_u32 s26, s26, 41943040
    v_mfma_f32_32x32x16_bf16 v[160:175], v[92:95], a[208:211], v[160:175]
    ds_read_b128 a[224:227], v29
    ds_read_b128 a[228:231], v29 offset:4096
    ds_read_b64_tr_b16 v[80:81], v10 offset:8192
    buffer_load_dwordx4 v7, s[12:15], s66 offen offset:3072 lds
    v_mfma_f32_32x32x16_bf16 v[176:191], v[92:95], a[212:215], v[176:191]
    ds_read_b64_tr_b16 v[82:83], v10 offset:8704
    ds_read_b64_tr_b16 v[84:85], v13 offset:8192
    ds_read_b64_tr_b16 v[86:87], v13 offset:8704
    s_add_u32 m0, s30, 65536
    s_nop 0
    buffer_load_dwordx4 v4, s[8:11], s67 offen lds
    v_mfma_f32_32x32x16_bf16 v[128:143], v[72:75], a[216:219], v[128:143]
    ds_read_b128 a[232:235], v30
    ds_read_b128 a[236:239], v30 offset:4096
    buffer_load_dwordx4 v5, s[8:11], s67 offen offset:1024 lds
    v_mfma_f32_32x32x16_bf16 v[144:159], v[72:75], a[220:223], v[144:159]
    ds_read_b64_tr_b16 v[88:89], v10 offset:12288
    ds_read_b64_tr_b16 v[90:91], v10 offset:12800
    buffer_load_dwordx4 v6, s[12:15], s67 offen offset:2048 lds
    v_mfma_f32_32x32x16_bf16 v[160:175], v[76:79], a[216:219], v[160:175]
    ds_read_b64_tr_b16 v[92:93], v13 offset:12288
    ds_read_b64_tr_b16 v[94:95], v13 offset:12800
    buffer_store_dwordx4 v[204:207], v200, s[16:19], s26 offen
    v_mfma_f32_32x32x16_bf16 v[176:191], v[76:79], a[220:223], v[176:191]
    buffer_load_dwordx4 v7, s[12:15], s67 offen offset:3072 lds
    s_waitcnt lgkmcnt(6)
    v_mfma_f32_32x32x16_bf16 v[128:143], v[80:83], a[224:227], v[128:143]
    ds_read_b128 a[240:243], v31
    ds_read_b128 a[244:247], v31 offset:4096
    s_add_u32 s26, s26, 65536
    buffer_store_dwordx4 v[208:211], v200, s[16:19], s26 offen
    v_mfma_f32_32x32x16_bf16 v[144:159], v[80:83], a[228:231], v[144:159]
    ds_read_b64_tr_b16 v[72:73], v10 offset:16384
    ds_read_b64_tr_b16 v[74:75], v10 offset:16896
    s_add_u32 m0, s30, 106496
    s_nop 0
    buffer_load_dwordx4 v4, s[8:11], s68 offen lds
    v_mfma_f32_32x32x16_bf16 v[160:175], v[84:87], a[224:227], v[160:175]
    ds_read_b64_tr_b16 v[76:77], v13 offset:16384
    ds_read_b64_tr_b16 v[78:79], v13 offset:16896
    v_mfma_f32_32x32x16_bf16 v[176:191], v[84:87], a[228:231], v[176:191]
    buffer_load_dwordx4 v5, s[8:11], s68 offen offset:1024 lds
    s_waitcnt lgkmcnt(6)
    v_mfma_f32_32x32x16_bf16 v[128:143], v[88:91], a[232:235], v[128:143]
    ds_read_b128 a[248:251], v32
    ds_read_b128 a[252:255], v32 offset:4096
    s_add_u32 s26, s26, 65536
    buffer_store_dwordx4 v[212:215], v200, s[16:19], s26 offen
    v_mfma_f32_32x32x16_bf16 v[144:159], v[88:91], a[236:239], v[144:159]
    ds_read_b64_tr_b16 v[80:81], v10 offset:20480
    ds_read_b64_tr_b16 v[82:83], v10 offset:20992
    buffer_load_dwordx4 v6, s[12:15], s68 offen offset:2048 lds
    v_mfma_f32_32x32x16_bf16 v[160:175], v[92:95], a[232:235], v[160:175]
    ds_read_b64_tr_b16 v[84:85], v13 offset:20480
    ds_read_b64_tr_b16 v[86:87], v13 offset:20992
    v_mfma_f32_32x32x16_bf16 v[176:191], v[92:95], a[236:239], v[176:191]
    buffer_load_dwordx4 v7, s[12:15], s68 offen offset:3072 lds
    s_waitcnt lgkmcnt(6)
    v_mfma_f32_32x32x16_bf16 v[128:143], v[72:75], a[240:243], v[128:143]
    s_waitcnt vmcnt(20)
    s_waitcnt lgkmcnt(0)
    s_barrier
    v_mfma_f32_32x32x16_bf16 v[144:159], v[72:75], a[244:247], v[144:159]
    v_add_u32 v29, 0, v25
    v_add_u32 v30, 0, v26
    v_add_u32 v31, 0, v27
    v_add_u32 v32, 0, v28
    s_add_u32 s26, s26, 65536
    v_mfma_f32_32x32x16_bf16 v[160:175], v[76:79], a[240:243], v[160:175]
    ds_read_b128 v[96:99], v29
    ds_read_b128 v[100:103], v29 offset:4096
    ds_read_b64_tr_b16 v[88:89], v8 offset:16384
    v_mfma_f32_32x32x16_bf16 v[176:191], v[76:79], a[244:247], v[176:191]
    ds_read_b64_tr_b16 v[90:91], v8 offset:16896
    ds_read_b64_tr_b16 v[92:93], v11 offset:16384
    ds_read_b64_tr_b16 v[94:95], v11 offset:16896
    v_mfma_f32_32x32x16_bf16 v[128:143], v[80:83], a[248:251], v[128:143]
    ds_read_b128 v[104:107], v30
    ds_read_b128 v[108:111], v30 offset:4096
    s_add_u32 m0, s30, 122880
    s_nop 0
    buffer_load_dwordx4 v4, s[8:11], s69 offen lds
    v_mfma_f32_32x32x16_bf16 v[144:159], v[80:83], a[252:255], v[144:159]
    ds_read_b64_tr_b16 v[72:73], v8 offset:20480
    ds_read_b64_tr_b16 v[74:75], v8 offset:20992
    buffer_load_dwordx4 v5, s[8:11], s69 offen offset:1024 lds
    v_mfma_f32_32x32x16_bf16 v[160:175], v[84:87], a[248:251], v[160:175]
    ds_read_b64_tr_b16 v[76:77], v11 offset:20480
    ds_read_b64_tr_b16 v[78:79], v11 offset:20992
    buffer_load_dwordx4 v6, s[12:15], s69 offen offset:2048 lds
    v_mfma_f32_32x32x16_bf16 v[176:191], v[84:87], a[252:255], v[176:191]
    buffer_store_dwordx4 v[216:219], v200, s[16:19], s26 offen
    s_waitcnt lgkmcnt(6)
    v_mfma_f32_32x32x16_bf16 v[128:143], v[88:91], v[96:99], v[128:143]
    ds_read_b128 v[112:115], v31
    ds_read_b128 v[116:119], v31 offset:4096
    buffer_load_dwordx4 v7, s[12:15], s69 offen offset:3072 lds
    v_mfma_f32_32x32x16_bf16 v[144:159], v[88:91], v[100:103], v[144:159]
    ds_read_b64_tr_b16 v[80:81], v8 offset:24576
    ds_read_b64_tr_b16 v[82:83], v8 offset:25088
    v_mfma_f32_32x32x16_bf16 v[160:175], v[92:95], v[96:99], v[160:175]
    ds_read_b64_tr_b16 v[84:85], v11 offset:24576
    ds_read_b64_tr_b16 v[86:87], v11 offset:25088
    s_add_u32 m0, s30, 139264
    s_nop 0
    buffer_load_dwordx4 v4, s[8:11], s70 offen lds
    v_mfma_f32_32x32x16_bf16 v[176:191], v[92:95], v[100:103], v[176:191]
    s_waitcnt lgkmcnt(6)
    v_mfma_f32_32x32x16_bf16 v[128:143], v[72:75], v[104:107], v[128:143]
    ds_read_b128 v[120:123], v32
    ds_read_b128 v[124:127], v32 offset:4096
    buffer_load_dwordx4 v5, s[8:11], s70 offen offset:1024 lds
    v_mfma_f32_32x32x16_bf16 v[144:159], v[72:75], v[108:111], v[144:159]
    ds_read_b64_tr_b16 v[88:89], v8 offset:28672
    ds_read_b64_tr_b16 v[90:91], v8 offset:29184
    v_mfma_f32_32x32x16_bf16 v[160:175], v[76:79], v[104:107], v[160:175]
    ds_read_b64_tr_b16 v[92:93], v11 offset:28672
    ds_read_b64_tr_b16 v[94:95], v11 offset:29184
    buffer_load_dwordx4 v6, s[12:15], s70 offen offset:2048 lds
    v_mfma_f32_32x32x16_bf16 v[176:191], v[76:79], v[108:111], v[176:191]
    s_waitcnt lgkmcnt(6)
    v_mfma_f32_32x32x16_bf16 v[128:143], v[80:83], v[112:115], v[128:143]
    s_waitcnt vmcnt(23)
    s_waitcnt lgkmcnt(0)
    s_barrier
    v_mfma_f32_32x32x16_bf16 v[144:159], v[80:83], v[116:119], v[144:159]
    ds_read_b64_tr_b16 v[72:73], v8 offset:32768
    ds_read_b64_tr_b16 v[74:75], v8 offset:33280
    buffer_load_dwordx4 v7, s[12:15], s70 offen offset:3072 lds
    v_mfma_f32_32x32x16_bf16 v[160:175], v[84:87], v[112:115], v[160:175]
    ds_read_b64_tr_b16 v[76:77], v11 offset:32768
    ds_read_b64_tr_b16 v[78:79], v11 offset:33280
    s_add_u32 m0, s30, 0
    s_nop 0
    buffer_load_dwordx4 v4, s[8:11], s71 offen lds
    v_mfma_f32_32x32x16_bf16 v[176:191], v[84:87], v[116:119], v[176:191]
    v_mfma_f32_32x32x16_bf16 v[128:143], v[88:91], v[120:123], v[128:143]
    ds_read_b64_tr_b16 v[80:81], v8 offset:36864
    ds_read_b64_tr_b16 v[82:83], v8 offset:37376
    buffer_load_dwordx4 v5, s[8:11], s71 offen offset:1024 lds
    v_mfma_f32_32x32x16_bf16 v[144:159], v[88:91], v[124:127], v[144:159]
    ds_read_b64_tr_b16 v[84:85], v11 offset:36864
    ds_read_b64_tr_b16 v[86:87], v11 offset:37376
    v_mfma_f32_32x32x16_bf16 v[160:175], v[92:95], v[120:123], v[160:175]
    buffer_load_dwordx4 v6, s[12:15], s71 offen offset:2048 lds
    v_mfma_f32_32x32x16_bf16 v[176:191], v[92:95], v[124:127], v[176:191]
    s_waitcnt lgkmcnt(4)
    v_mfma_f32_32x32x16_bf16 v[192:207], v[72:75], a[0:3], 0
    ds_read_b64_tr_b16 v[88:89], v8 offset:40960
    ds_read_b64_tr_b16 v[90:91], v8 offset:41472
    v_mul_f32 v56, v128, v128
    v_mul_f32 v57, v129, v129
    v_mul_f32 v58, v130, v130
    v_mfma_f32_32x32x16_bf16 v[208:223], v[72:75], a[4:7], 0
    ds_read_b64_tr_b16 v[92:93], v11 offset:40960
    ds_read_b64_tr_b16 v[94:95], v11 offset:41472
    buffer_load_dwordx4 v7, s[12:15], s71 offen offset:3072 lds
    v_mul_f32 v59, v131, v131
    v_mfma_f32_32x32x16_bf16 v[224:239], v[76:79], a[0:3], 0
    v_mul_f32 v132, v128, v132
    v_mul_f32 v133, v129, v133
    v_mul_f32 v134, v130, v134
    v_mul_f32 v135, v131, v135
    v_fma_f32 v56, v56, s27, v15
    v_mfma_f32_32x32x16_bf16 v[240:255], v[76:79], a[4:7], 0
    v_fma_f32 v57, v57, s27, v15
    v_fma_f32 v58, v58, s27, v15
    s_waitcnt lgkmcnt(4)
    v_mfma_f32_32x32x16_bf16 v[192:207], v[80:83], a[8:11], v[192:207]
    ds_read_b64_tr_b16 v[72:73], v8 offset:45056
    ds_read_b64_tr_b16 v[74:75], v8 offset:45568
    v_fma_f32 v59, v59, s27, v15
    v_mul_f32 v128, v56, v128
    v_mul_f32 v129, v57, v129
    v_mfma_f32_32x32x16_bf16 v[208:223], v[80:83], a[12:15], v[208:223]
    ds_read_b64_tr_b16 v[76:77], v11 offset:45056
    ds_read_b64_tr_b16 v[78:79], v11 offset:45568
    s_add_u32 m0, s30, 16384
    s_nop 0
    buffer_load_dwordx4 v4, s[8:11], s72 offen lds
    v_mfma_f32_32x32x16_bf16 v[224:239], v[84:87], a[8:11], v[224:239]
    v_mul_f32 v130, v58, v130
    v_mul_f32 v131, v59, v131
    v_exp_f32 v128, v128
    v_mfma_f32_32x32x16_bf16 v[240:255], v[84:87], a[12:15], v[240:255]
    v_exp_f32 v129, v129
    v_exp_f32 v130, v130
    s_waitcnt lgkmcnt(4)
    v_mfma_f32_32x32x16_bf16 v[192:207], v[88:91], a[16:19], v[192:207]
    s_waitcnt vmcnt(25)
    s_waitcnt lgkmcnt(0)
    s_barrier
    v_mfma_f32_32x32x16_bf16 v[208:223], v[88:91], a[20:23], v[208:223]
    ds_read_b64_tr_b16 v[80:81], v8 offset:49152
    ds_read_b64_tr_b16 v[82:83], v8 offset:49664
    v_exp_f32 v131, v131
    v_add_f32 v128, 1.0, v128
    v_mfma_f32_32x32x16_bf16 v[224:239], v[92:95], a[16:19], v[224:239]
    ds_read_b64_tr_b16 v[84:85], v11 offset:49152
    ds_read_b64_tr_b16 v[86:87], v11 offset:49664
    buffer_load_dwordx4 v5, s[8:11], s72 offen offset:1024 lds
    v_add_f32 v129, 1.0, v129
    v_mfma_f32_32x32x16_bf16 v[240:255], v[92:95], a[20:23], v[240:255]
    v_add_f32 v130, 1.0, v130
    v_add_f32 v131, 1.0, v131
    v_rcp_f32 v128, v128
    v_rcp_f32 v129, v129
    v_rcp_f32 v130, v130
    v_mfma_f32_32x32x16_bf16 v[192:207], v[72:75], a[24:27], v[192:207]
    ds_read_b64_tr_b16 v[88:89], v8 offset:53248
    ds_read_b64_tr_b16 v[90:91], v8 offset:53760
    v_rcp_f32 v131, v131
    v_mul_f32 v132, v132, v128
    v_mfma_f32_32x32x16_bf16 v[208:223], v[72:75], a[28:31], v[208:223]
    ds_read_b64_tr_b16 v[92:93], v11 offset:53248
    ds_read_b64_tr_b16 v[94:95], v11 offset:53760
    v_mul_f32 v133, v133, v129
    v_mul_f32 v134, v134, v130
    v_mul_f32 v135, v135, v131
    v_mfma_f32_32x32x16_bf16 v[224:239], v[76:79], a[24:27], v[224:239]
    buffer_load_dwordx4 v6, s[12:15], s72 offen offset:2048 lds
    v_cvt_pk_bf16_f32 v64, v132, v133
    v_cvt_pk_bf16_f32 v65, v134, v135
    v_mul_f32 v60, v136, v136
    v_mfma_f32_32x32x16_bf16 v[240:255], v[76:79], a[28:31], v[240:255]
    v_mul_f32 v61, v137, v137
    v_mul_f32 v62, v138, v138
    s_waitcnt lgkmcnt(4)
    v_mfma_f32_32x32x16_bf16 v[192:207], v[80:83], a[32:35], v[192:207]
    ds_read_b64_tr_b16 v[72:73], v8 offset:57344
    ds_read_b64_tr_b16 v[74:75], v8 offset:57856
    v_mul_f32 v63, v139, v139
    v_mul_f32 v140, v136, v140
    v_mul_f32 v141, v137, v141
    v_mfma_f32_32x32x16_bf16 v[208:223], v[80:83], a[36:39], v[208:223]
    ds_read_b64_tr_b16 v[76:77], v11 offset:57344
    ds_read_b64_tr_b16 v[78:79], v11 offset:57856
    v_mul_f32 v142, v138, v142
    v_mul_f32 v143, v139, v143
    v_fma_f32 v60, v60, s27, v15
    v_mfma_f32_32x32x16_bf16 v[224:239], v[84:87], a[32:35], v[224:239]
    buffer_load_dwordx4 v7, s[12:15], s72 offen offset:3072 lds
    v_fma_f32 v61, v61, s27, v15
    v_fma_f32 v62, v62, s27, v15
    v_fma_f32 v63, v63, s27, v15
    v_mfma_f32_32x32x16_bf16 v[240:255], v[84:87], a[36:39], v[240:255]
    v_mul_f32 v136, v60, v136
    v_mul_f32 v137, v61, v137
    s_waitcnt lgkmcnt(4)
    v_mfma_f32_32x32x16_bf16 v[192:207], v[88:91], a[40:43], v[192:207]
    ds_read_b64_tr_b16 v[80:81], v8 offset:61440
    ds_read_b64_tr_b16 v[82:83], v8 offset:61952
    v_mul_f32 v138, v62, v138
    v_mul_f32 v139, v63, v139
    v_mfma_f32_32x32x16_bf16 v[208:223], v[88:91], a[44:47], v[208:223]
    ds_read_b64_tr_b16 v[84:85], v11 offset:61440
    ds_read_b64_tr_b16 v[86:87], v11 offset:61952
    v_exp_f32 v136, v136
    v_mfma_f32_32x32x16_bf16 v[224:239], v[92:95], a[40:43], v[224:239]
    s_add_u32 m0, s30, 32768
    s_nop 0
    buffer_load_dwordx4 v4, s[8:11], s73 offen lds
    v_exp_f32 v137, v137
    v_mfma_f32_32x32x16_bf16 v[240:255], v[92:95], a[44:47], v[240:255]
    v_exp_f32 v138, v138
    v_exp_f32 v139, v139
    v_add_f32 v136, 1.0, v136
    s_waitcnt lgkmcnt(4)
    v_mfma_f32_32x32x16_bf16 v[192:207], v[72:75], a[48:51], v[192:207]
    s_waitcnt vmcnt(24)
    s_waitcnt lgkmcnt(0)
    s_barrier
    v_mfma_f32_32x32x16_bf16 v[208:223], v[72:75], a[52:55], v[208:223]
    ds_read_b64_tr_b16 v[88:89], v9 offset:0
    ds_read_b64_tr_b16 v[90:91], v9 offset:512
    v_add_f32 v137, 1.0, v137
    v_add_f32 v138, 1.0, v138
    v_add_f32 v139, 1.0, v139
    v_mfma_f32_32x32x16_bf16 v[224:239], v[76:79], a[48:51], v[224:239]
    ds_read_b64_tr_b16 v[92:93], v12 offset:0
    ds_read_b64_tr_b16 v[94:95], v12 offset:512
    v_rcp_f32 v136, v136
    v_mfma_f32_32x32x16_bf16 v[240:255], v[76:79], a[52:55], v[240:255]
    buffer_load_dwordx4 v5, s[8:11], s73 offen offset:1024 lds
    v_rcp_f32 v137, v137
    v_rcp_f32 v138, v138
    v_rcp_f32 v139, v139
    v_mfma_f32_32x32x16_bf16 v[192:207], v[80:83], a[56:59], v[192:207]
    ds_read_b64_tr_b16 v[72:73], v9 offset:4096
    ds_read_b64_tr_b16 v[74:75], v9 offset:4608
    v_mul_f32 v140, v140, v136
    v_mul_f32 v141, v141, v137
    v_mul_f32 v142, v142, v138
    v_mfma_f32_32x32x16_bf16 v[208:223], v[80:83], a[60:63], v[208:223]
    ds_read_b64_tr_b16 v[76:77], v12 offset:4096
    ds_read_b64_tr_b16 v[78:79], v12 offset:4608
    v_mul_f32 v143, v143, v139
    v_cvt_pk_bf16_f32 v66, v140, v141
    v_cvt_pk_bf16_f32 v67, v142, v143
    v_mfma_f32_32x32x16_bf16 v[224:239], v[84:87], a[56:59], v[224:239]
    ds_write_b128 v14, v[64:67] offset:0
    v_mul_f32 v56, v144, v144
    v_mul_f32 v57, v145, v145
    v_mul_f32 v58, v146, v146
    v_mfma_f32_32x32x16_bf16 v[240:255], v[84:87], a[60:63], v[240:255]
    buffer_load_dwordx4 v6, s[12:15], s73 offen offset:2048 lds
    s_waitcnt lgkmcnt(5)
    v_mfma_f32_32x32x16_bf16 v[192:207], v[88:91], a[64:67], v[192:207]
    ds_read_b64_tr_b16 v[80:81], v9 offset:8192
    ds_read_b64_tr_b16 v[82:83], v9 offset:8704
    v_mul_f32 v59, v147, v147
    v_mul_f32 v148, v144, v148
    v_mul_f32 v149, v145, v149
    v_mfma_f32_32x32x16_bf16 v[208:223], v[88:91], a[68:71], v[208:223]
    ds_read_b64_tr_b16 v[84:85], v12 offset:8192
    ds_read_b64_tr_b16 v[86:87], v12 offset:8704
    v_mul_f32 v150, v146, v150
    v_mul_f32 v151, v147, v151
    v_fma_f32 v56, v56, s27, v15
    v_mfma_f32_32x32x16_bf16 v[224:239], v[92:95], a[64:67], v[224:239]
    v_fma_f32 v57, v57, s27, v15
    v_fma_f32 v58, v58, s27, v15
    v_fma_f32 v59, v59, s27, v15
    v_mul_f32 v144, v56, v144
    v_mul_f32 v145, v57, v145
    v_mfma_f32_32x32x16_bf16 v[240:255], v[92:95], a[68:71], v[240:255]
    buffer_load_dwordx4 v7, s[12:15], s73 offen offset:3072 lds
    s_waitcnt lgkmcnt(5)
    v_mfma_f32_32x32x16_bf16 v[192:207], v[72:75], a[72:75], v[192:207]
    ds_read_b64_tr_b16 v[88:89], v9 offset:12288
    ds_read_b64_tr_b16 v[90:91], v9 offset:12800
    v_mul_f32 v146, v58, v146
    v_mul_f32 v147, v59, v147
    v_mfma_f32_32x32x16_bf16 v[208:223], v[72:75], a[76:79], v[208:223]
    ds_read_b64_tr_b16 v[92:93], v12 offset:12288
    ds_read_b64_tr_b16 v[94:95], v12 offset:12800
    v_exp_f32 v144, v144
    v_mfma_f32_32x32x16_bf16 v[224:239], v[76:79], a[72:75], v[224:239]
    v_exp_f32 v145, v145
    v_exp_f32 v146, v146
    v_mfma_f32_32x32x16_bf16 v[240:255], v[76:79], a[76:79], v[240:255]
    s_add_u32 s8, s8, 128
    s_addc_u32 s9, s9, 0
    s_add_u32 s12, s12, 128
    s_addc_u32 s13, s13, 0
    s_add_u32 m0, s30, 49152
    s_nop 0
    buffer_load_dwordx4 v4, s[8:11], s65 offen lds
    v_exp_f32 v147, v147
    v_add_f32 v144, 1.0, v144
    s_waitcnt lgkmcnt(4)
    v_mfma_f32_32x32x16_bf16 v[192:207], v[80:83], a[80:83], v[192:207]
    s_waitcnt vmcnt(22)
    s_waitcnt lgkmcnt(0)
    s_barrier
    v_mfma_f32_32x32x16_bf16 v[208:223], v[80:83], a[84:87], v[208:223]
    ds_read_b64_tr_b16 v[72:73], v9 offset:40960
    ds_read_b64_tr_b16 v[74:75], v9 offset:41472
    v_add_f32 v145, 1.0, v145
    v_add_f32 v146, 1.0, v146
    v_add_f32 v147, 1.0, v147
    v_mfma_f32_32x32x16_bf16 v[224:239], v[84:87], a[80:83], v[224:239]
    ds_read_b64_tr_b16 v[76:77], v12 offset:40960
    ds_read_b64_tr_b16 v[78:79], v12 offset:41472
    v_rcp_f32 v144, v144
    v_mfma_f32_32x32x16_bf16 v[240:255], v[84:87], a[84:87], v[240:255]
    v_rcp_f32 v145, v145
    v_rcp_f32 v146, v146
    v_rcp_f32 v147, v147
    v_mfma_f32_32x32x16_bf16 v[192:207], v[88:91], a[88:91], v[192:207]
    ds_read_b64_tr_b16 v[80:81], v9 offset:45056
    ds_read_b64_tr_b16 v[82:83], v9 offset:45568
    buffer_load_dwordx4 v5, s[8:11], s65 offen offset:1024 lds
    v_mul_f32 v148, v148, v144
    v_mfma_f32_32x32x16_bf16 v[208:223], v[88:91], a[92:95], v[208:223]
    ds_read_b64_tr_b16 v[84:85], v12 offset:45056
    ds_read_b64_tr_b16 v[86:87], v12 offset:45568
    v_mul_f32 v149, v149, v145
    v_mul_f32 v150, v150, v146
    v_mul_f32 v151, v151, v147
    v_mfma_f32_32x32x16_bf16 v[224:239], v[92:95], a[88:91], v[224:239]
    v_cvt_pk_bf16_f32 v68, v148, v149
    v_cvt_pk_bf16_f32 v69, v150, v151
    v_mul_f32 v60, v152, v152
    v_mul_f32 v61, v153, v153
    v_mul_f32 v62, v154, v154
    v_mfma_f32_32x32x16_bf16 v[240:255], v[92:95], a[92:95], v[240:255]
    v_mul_f32 v63, v155, v155
    v_mul_f32 v156, v152, v156
    s_waitcnt lgkmcnt(4)
    v_mfma_f32_32x32x16_bf16 v[192:207], v[72:75], a[96:99], v[192:207]
    ds_read_b64_tr_b16 v[88:89], v9 offset:49152
    ds_read_b64_tr_b16 v[90:91], v9 offset:49664
    buffer_load_dwordx4 v6, s[12:15], s65 offen offset:2048 lds
    v_mul_f32 v157, v153, v157
    v_mfma_f32_32x32x16_bf16 v[208:223], v[72:75], a[100:103], v[208:223]
    ds_read_b64_tr_b16 v[92:93], v12 offset:49152
    ds_read_b64_tr_b16 v[94:95], v12 offset:49664
    v_mul_f32 v158, v154, v158
    v_mul_f32 v159, v155, v159
    v_fma_f32 v60, v60, s27, v15
    v_mfma_f32_32x32x16_bf16 v[224:239], v[76:79], a[96:99], v[224:239]
    v_fma_f32 v61, v61, s27, v15
    v_fma_f32 v62, v62, s27, v15
    v_fma_f32 v63, v63, s27, v15
    v_mul_f32 v152, v60, v152
    v_mul_f32 v153, v61, v153
    v_mfma_f32_32x32x16_bf16 v[240:255], v[76:79], a[100:103], v[240:255]
    v_mul_f32 v154, v62, v154
    v_mul_f32 v155, v63, v155
    s_waitcnt lgkmcnt(4)
    v_mfma_f32_32x32x16_bf16 v[192:207], v[80:83], a[104:107], v[192:207]
    ds_read_b64_tr_b16 v[72:73], v9 offset:53248
    ds_read_b64_tr_b16 v[74:75], v9 offset:53760
    buffer_load_dwordx4 v7, s[12:15], s65 offen offset:3072 lds
    v_mfma_f32_32x32x16_bf16 v[208:223], v[80:83], a[108:111], v[208:223]
    ds_read_b64_tr_b16 v[76:77], v12 offset:53248
    ds_read_b64_tr_b16 v[78:79], v12 offset:53760
    v_exp_f32 v152, v152
    v_mfma_f32_32x32x16_bf16 v[224:239], v[84:87], a[104:107], v[224:239]
    v_exp_f32 v153, v153
    v_exp_f32 v154, v154
    v_mfma_f32_32x32x16_bf16 v[240:255], v[84:87], a[108:111], v[240:255]
    v_exp_f32 v155, v155
    v_add_f32 v152, 1.0, v152
    v_add_f32 v153, 1.0, v153
    s_waitcnt lgkmcnt(4)
    v_mfma_f32_32x32x16_bf16 v[192:207], v[88:91], a[112:115], v[192:207]
    s_waitcnt vmcnt(20)
    s_waitcnt lgkmcnt(0)
    s_barrier
    v_mfma_f32_32x32x16_bf16 v[208:223], v[88:91], a[116:119], v[208:223]
    ds_read_b64_tr_b16 v[80:81], v9 offset:57344
    ds_read_b64_tr_b16 v[82:83], v9 offset:57856
    s_add_u32 m0, s30, 65536
    s_nop 0
    buffer_load_dwordx4 v4, s[8:11], s66 offen lds
    v_mfma_f32_32x32x16_bf16 v[224:239], v[92:95], a[112:115], v[224:239]
    ds_read_b64_tr_b16 v[84:85], v12 offset:57344
    ds_read_b64_tr_b16 v[86:87], v12 offset:57856
    v_add_f32 v154, 1.0, v154
    v_add_f32 v155, 1.0, v155
    v_mfma_f32_32x32x16_bf16 v[240:255], v[92:95], a[116:119], v[240:255]
    v_rcp_f32 v152, v152
    v_rcp_f32 v153, v153
    v_rcp_f32 v154, v154
    v_rcp_f32 v155, v155
    v_mfma_f32_32x32x16_bf16 v[192:207], v[72:75], a[120:123], v[192:207]
    ds_read_b64_tr_b16 v[88:89], v9 offset:61440
    ds_read_b64_tr_b16 v[90:91], v9 offset:61952
    v_mul_f32 v156, v156, v152
    v_mul_f32 v157, v157, v153
    v_mul_f32 v158, v158, v154
    v_mfma_f32_32x32x16_bf16 v[208:223], v[72:75], a[124:127], v[208:223]
    ds_read_b64_tr_b16 v[92:93], v12 offset:61440
    ds_read_b64_tr_b16 v[94:95], v12 offset:61952
    buffer_load_dwordx4 v5, s[8:11], s66 offen offset:1024 lds
    v_mul_f32 v159, v159, v155
    v_mfma_f32_32x32x16_bf16 v[224:239], v[76:79], a[120:123], v[224:239]
    v_cvt_pk_bf16_f32 v70, v156, v157
    v_cvt_pk_bf16_f32 v71, v158, v159
    ds_write_b128 v14, v[68:71] offset:1024
    v_mul_f32 v56, v160, v160
    v_mfma_f32_32x32x16_bf16 v[240:255], v[76:79], a[124:127], v[240:255]
    v_mul_f32 v57, v161, v161
    s_waitcnt lgkmcnt(5)
    v_mfma_f32_32x32x16_bf16 v[192:207], v[80:83], a[128:131], v[192:207]
    ds_read_b64_tr_b16 v[72:73], v10 offset:0
    ds_read_b64_tr_b16 v[74:75], v10 offset:512
    v_mul_f32 v58, v162, v162
    v_mul_f32 v59, v163, v163
    v_mul_f32 v164, v160, v164
    v_mfma_f32_32x32x16_bf16 v[208:223], v[80:83], a[132:135], v[208:223]
    ds_read_b64_tr_b16 v[76:77], v13 offset:0
    ds_read_b64_tr_b16 v[78:79], v13 offset:512
    buffer_load_dwordx4 v6, s[12:15], s66 offen offset:2048 lds
    v_mul_f32 v165, v161, v165
    v_mfma_f32_32x32x16_bf16 v[224:239], v[84:87], a[128:131], v[224:239]
    v_mul_f32 v166, v162, v166
    v_mul_f32 v167, v163, v167
    v_fma_f32 v56, v56, s27, v15
    v_fma_f32 v57, v57, s27, v15
    v_fma_f32 v58, v58, s27, v15
    v_mfma_f32_32x32x16_bf16 v[240:255], v[84:87], a[132:135], v[240:255]
    v_fma_f32 v59, v59, s27, v15
    s_waitcnt lgkmcnt(5)
    v_mfma_f32_32x32x16_bf16 v[192:207], v[88:91], a[136:139], v[192:207]
    ds_read_b64_tr_b16 v[80:81], v10 offset:4096
    ds_read_b64_tr_b16 v[82:83], v10 offset:4608
    v_mul_f32 v160, v56, v160
    v_mul_f32 v161, v57, v161
    v_mul_f32 v162, v58, v162
    v_mfma_f32_32x32x16_bf16 v[208:223], v[88:91], a[140:143], v[208:223]
    ds_read_b64_tr_b16 v[84:85], v13 offset:4096
    ds_read_b64_tr_b16 v[86:87], v13 offset:4608
    buffer_load_dwordx4 v7, s[12:15], s66 offen offset:3072 lds
    v_mul_f32 v163, v59, v163
    v_mfma_f32_32x32x16_bf16 v[224:239], v[92:95], a[136:139], v[224:239]
    v_exp_f32 v160, v160
    v_exp_f32 v161, v161
    v_mfma_f32_32x32x16_bf16 v[240:255], v[92:95], a[140:143], v[240:255]
    v_exp_f32 v162, v162
    s_waitcnt lgkmcnt(4)
    v_mfma_f32_32x32x16_bf16 v[192:207], v[72:75], a[144:147], v[192:207]
    s_waitcnt vmcnt(20)
    s_waitcnt lgkmcnt(0)
    s_barrier
    v_mfma_f32_32x32x16_bf16 v[208:223], v[72:75], a[148:151], v[208:223]
    ds_read_b64_tr_b16 v[88:89], v10 offset:8192
    ds_read_b64_tr_b16 v[90:91], v10 offset:8704
    v_exp_f32 v163, v163
    v_add_f32 v160, 1.0, v160
    v_mfma_f32_32x32x16_bf16 v[224:239], v[76:79], a[144:147], v[224:239]
    ds_read_b64_tr_b16 v[92:93], v13 offset:8192
    ds_read_b64_tr_b16 v[94:95], v13 offset:8704
    s_add_u32 m0, s30, 122880
    s_nop 0
    buffer_load_dwordx4 v4, s[8:11], s67 offen lds
    v_mfma_f32_32x32x16_bf16 v[240:255], v[76:79], a[148:151], v[240:255]
    v_add_f32 v161, 1.0, v161
    v_add_f32 v162, 1.0, v162
    v_add_f32 v163, 1.0, v163
    v_rcp_f32 v160, v160
    v_rcp_f32 v161, v161
    v_mfma_f32_32x32x16_bf16 v[192:207], v[80:83], a[152:155], v[192:207]
    ds_read_b64_tr_b16 v[72:73], v10 offset:12288
    ds_read_b64_tr_b16 v[74:75], v10 offset:12800
    v_rcp_f32 v162, v162
    v_mfma_f32_32x32x16_bf16 v[208:223], v[80:83], a[156:159], v[208:223]
    ds_read_b64_tr_b16 v[76:77], v13 offset:12288
    ds_read_b64_tr_b16 v[78:79], v13 offset:12800
    v_rcp_f32 v163, v163
    v_mul_f32 v164, v164, v160
    v_mfma_f32_32x32x16_bf16 v[224:239], v[84:87], a[152:155], v[224:239]
    buffer_load_dwordx4 v5, s[8:11], s67 offen offset:1024 lds
    v_mul_f32 v165, v165, v161
    v_mul_f32 v166, v166, v162
    v_mul_f32 v167, v167, v163
    v_mfma_f32_32x32x16_bf16 v[240:255], v[84:87], a[156:159], v[240:255]
    v_cvt_pk_bf16_f32 v64, v164, v165
    v_cvt_pk_bf16_f32 v65, v166, v167
    s_waitcnt lgkmcnt(4)
    v_mfma_f32_32x32x16_bf16 v[192:207], v[88:91], a[160:163], v[192:207]
    ds_read_b64_tr_b16 v[80:81], v10 offset:16384
    ds_read_b64_tr_b16 v[82:83], v10 offset:16896
    v_mul_f32 v60, v168, v168
    v_mul_f32 v61, v169, v169
    v_mul_f32 v62, v170, v170
    v_mfma_f32_32x32x16_bf16 v[208:223], v[88:91], a[164:167], v[208:223]
    ds_read_b64_tr_b16 v[84:85], v13 offset:16384
    ds_read_b64_tr_b16 v[86:87], v13 offset:16896
    v_mul_f32 v63, v171, v171
    v_mul_f32 v172, v168, v172
    v_mul_f32 v173, v169, v173
    v_mfma_f32_32x32x16_bf16 v[224:239], v[92:95], a[160:163], v[224:239]
    buffer_load_dwordx4 v6, s[12:15], s67 offen offset:2048 lds
    v_mul_f32 v174, v170, v174
    v_mul_f32 v175, v171, v175
    v_fma_f32 v60, v60, s27, v15
    v_mfma_f32_32x32x16_bf16 v[240:255], v[92:95], a[164:167], v[240:255]
    v_fma_f32 v61, v61, s27, v15
    s_waitcnt lgkmcnt(4)
    v_mfma_f32_32x32x16_bf16 v[192:207], v[72:75], a[168:171], v[192:207]
    ds_read_b64_tr_b16 v[88:89], v10 offset:20480
    ds_read_b64_tr_b16 v[90:91], v10 offset:20992
    v_fma_f32 v62, v62, s27, v15
    v_fma_f32 v63, v63, s27, v15
    v_mul_f32 v168, v60, v168
    v_mfma_f32_32x32x16_bf16 v[208:223], v[72:75], a[172:175], v[208:223]
    ds_read_b64_tr_b16 v[92:93], v13 offset:20480
    ds_read_b64_tr_b16 v[94:95], v13 offset:20992
    v_mul_f32 v169, v61, v169
    v_mul_f32 v170, v62, v170
    v_mul_f32 v171, v63, v171
    v_mfma_f32_32x32x16_bf16 v[224:239], v[76:79], a[168:171], v[224:239]
    buffer_load_dwordx4 v7, s[12:15], s67 offen offset:3072 lds
    v_exp_f32 v168, v168
    v_mfma_f32_32x32x16_bf16 v[240:255], v[76:79], a[172:175], v[240:255]
    v_exp_f32 v169, v169
    s_waitcnt lgkmcnt(4)
    v_mfma_f32_32x32x16_bf16 v[192:207], v[80:83], a[176:179], v[192:207]
    s_waitcnt vmcnt(20)
    s_waitcnt lgkmcnt(0)
    s_barrier
    v_mfma_f32_32x32x16_bf16 v[208:223], v[80:83], a[180:183], v[208:223]
    ds_read_b64_tr_b16 v[72:73], v8 offset:0
    ds_read_b64_tr_b16 v[74:75], v8 offset:512
    v_exp_f32 v170, v170
    v_mfma_f32_32x32x16_bf16 v[224:239], v[84:87], a[176:179], v[224:239]
    ds_read_b64_tr_b16 v[76:77], v11 offset:0
    ds_read_b64_tr_b16 v[78:79], v11 offset:512
    v_exp_f32 v171, v171
    v_add_f32 v168, 1.0, v168
    v_mfma_f32_32x32x16_bf16 v[240:255], v[84:87], a[180:183], v[240:255]
    s_add_u32 m0, s30, 139264
    s_nop 0
    buffer_load_dwordx4 v4, s[8:11], s68 offen lds
    v_add_f32 v169, 1.0, v169
    v_add_f32 v170, 1.0, v170
    v_add_f32 v171, 1.0, v171
    v_rcp_f32 v168, v168
    v_mfma_f32_32x32x16_bf16 v[192:207], v[88:91], a[184:187], v[192:207]
    ds_read_b64_tr_b16 v[80:81], v8 offset:4096
    ds_read_b64_tr_b16 v[82:83], v8 offset:4608
    v_rcp_f32 v169, v169
    v_mfma_f32_32x32x16_bf16 v[208:223], v[88:91], a[188:191], v[208:223]
    ds_read_b64_tr_b16 v[84:85], v11 offset:4096
    ds_read_b64_tr_b16 v[86:87], v11 offset:4608
    v_rcp_f32 v170, v170
    v_mfma_f32_32x32x16_bf16 v[224:239], v[92:95], a[184:187], v[224:239]
    v_rcp_f32 v171, v171
    v_mul_f32 v172, v172, v168
    v_mul_f32 v173, v173, v169
    v_mul_f32 v174, v174, v170
    v_mfma_f32_32x32x16_bf16 v[240:255], v[92:95], a[188:191], v[240:255]
    buffer_load_dwordx4 v5, s[8:11], s68 offen offset:1024 lds
    v_mul_f32 v175, v175, v171
    s_waitcnt lgkmcnt(4)
    v_mfma_f32_32x32x16_bf16 v[192:207], v[72:75], a[192:195], v[192:207]
    ds_read_b64_tr_b16 v[88:89], v8 offset:8192
    ds_read_b64_tr_b16 v[90:91], v8 offset:8704
    v_cvt_pk_bf16_f32 v66, v172, v173
    v_cvt_pk_bf16_f32 v67, v174, v175
    v_mfma_f32_32x32x16_bf16 v[208:223], v[72:75], a[196:199], v[208:223]
    ds_read_b64_tr_b16 v[92:93], v11 offset:8192
    ds_read_b64_tr_b16 v[94:95], v11 offset:8704
    ds_write_b128 v14, v[64:67] offset:4096
    v_mul_f32 v56, v176, v176
    v_mfma_f32_32x32x16_bf16 v[224:239], v[76:79], a[192:195], v[224:239]
    v_mul_f32 v57, v177, v177
    v_mul_f32 v58, v178, v178
    v_mul_f32 v59, v179, v179
    v_mul_f32 v180, v176, v180
    v_mul_f32 v181, v177, v181
    v_mfma_f32_32x32x16_bf16 v[240:255], v[76:79], a[196:199], v[240:255]
    buffer_load_dwordx4 v6, s[12:15], s68 offen offset:2048 lds
    s_waitcnt lgkmcnt(5)
    v_mfma_f32_32x32x16_bf16 v[192:207], v[80:83], a[200:203], v[192:207]
    ds_read_b64_tr_b16 v[72:73], v8 offset:12288
    ds_read_b64_tr_b16 v[74:75], v8 offset:12800
    v_mul_f32 v182, v178, v182
    v_mul_f32 v183, v179, v183
    v_fma_f32 v56, v56, s27, v15
    v_mfma_f32_32x32x16_bf16 v[208:223], v[80:83], a[204:207], v[208:223]
    ds_read_b64_tr_b16 v[76:77], v11 offset:12288
    ds_read_b64_tr_b16 v[78:79], v11 offset:12800
    v_fma_f32 v57, v57, s27, v15
    v_fma_f32 v58, v58, s27, v15
    v_fma_f32 v59, v59, s27, v15
    v_mfma_f32_32x32x16_bf16 v[224:239], v[84:87], a[200:203], v[224:239]
    v_mul_f32 v176, v56, v176
    v_mul_f32 v177, v57, v177
    v_mul_f32 v178, v58, v178
    v_mul_f32 v179, v59, v179
    v_mfma_f32_32x32x16_bf16 v[240:255], v[84:87], a[204:207], v[240:255]
    buffer_load_dwordx4 v7, s[12:15], s68 offen offset:3072 lds
    s_waitcnt lgkmcnt(5)
    v_mfma_f32_32x32x16_bf16 v[192:207], v[88:91], a[208:211], v[192:207]
    s_waitcnt vmcnt(20)
    s_waitcnt lgkmcnt(0)
    s_barrier
    v_mfma_f32_32x32x16_bf16 v[208:223], v[88:91], a[212:215], v[208:223]
    ds_read_b64_tr_b16 v[80:81], v8 offset:16384
    ds_read_b64_tr_b16 v[82:83], v8 offset:16896
    v_exp_f32 v176, v176
    v_mfma_f32_32x32x16_bf16 v[224:239], v[92:95], a[208:211], v[224:239]
    ds_read_b64_tr_b16 v[84:85], v11 offset:16384
    ds_read_b64_tr_b16 v[86:87], v11 offset:16896
    v_exp_f32 v177, v177
    v_mfma_f32_32x32x16_bf16 v[240:255], v[92:95], a[212:215], v[240:255]
    v_exp_f32 v178, v178
    v_exp_f32 v179, v179
    v_add_f32 v176, 1.0, v176
    v_add_f32 v177, 1.0, v177
    v_mfma_f32_32x32x16_bf16 v[192:207], v[72:75], a[216:219], v[192:207]
    ds_read_b64_tr_b16 v[88:89], v8 offset:20480
    ds_read_b64_tr_b16 v[90:91], v8 offset:20992
    s_add_u32 m0, s30, 0
    s_nop 0
    buffer_load_dwordx4 v4, s[8:11], s69 offen lds
    v_mfma_f32_32x32x16_bf16 v[208:223], v[72:75], a[220:223], v[208:223]
    ds_read_b64_tr_b16 v[92:93], v11 offset:20480
    ds_read_b64_tr_b16 v[94:95], v11 offset:20992
    v_add_f32 v178, 1.0, v178
    v_add_f32 v179, 1.0, v179
    v_mfma_f32_32x32x16_bf16 v[224:239], v[76:79], a[216:219], v[224:239]
    v_rcp_f32 v176, v176
    v_rcp_f32 v177, v177
    v_mfma_f32_32x32x16_bf16 v[240:255], v[76:79], a[220:223], v[240:255]
    v_rcp_f32 v178, v178
    v_rcp_f32 v179, v179
    s_waitcnt lgkmcnt(4)
    v_mfma_f32_32x32x16_bf16 v[192:207], v[80:83], a[224:227], v[192:207]
    ds_read_b64_tr_b16 v[72:73], v8 offset:24576
    ds_read_b64_tr_b16 v[74:75], v8 offset:25088
    buffer_load_dwordx4 v5, s[8:11], s69 offen offset:1024 lds
    v_mul_f32 v180, v180, v176
    v_mfma_f32_32x32x16_bf16 v[208:223], v[80:83], a[228:231], v[208:223]
    ds_read_b64_tr_b16 v[76:77], v11 offset:24576
    ds_read_b64_tr_b16 v[78:79], v11 offset:25088
    v_mul_f32 v181, v181, v177
    v_mul_f32 v182, v182, v178
    v_mul_f32 v183, v183, v179
    v_mfma_f32_32x32x16_bf16 v[224:239], v[84:87], a[224:227], v[224:239]
    v_cvt_pk_bf16_f32 v68, v180, v181
    v_cvt_pk_bf16_f32 v69, v182, v183
    v_mul_f32 v60, v184, v184
    v_mul_f32 v61, v185, v185
    v_mul_f32 v62, v186, v186
    v_mfma_f32_32x32x16_bf16 v[240:255], v[84:87], a[228:231], v[240:255]
    v_mul_f32 v63, v187, v187
    s_waitcnt lgkmcnt(4)
    v_mfma_f32_32x32x16_bf16 v[192:207], v[88:91], a[232:235], v[192:207]
    ds_read_b64_tr_b16 v[80:81], v8 offset:28672
    ds_read_b64_tr_b16 v[82:83], v8 offset:29184
    buffer_load_dwordx4 v6, s[12:15], s69 offen offset:2048 lds
    v_mul_f32 v188, v184, v188
    v_mfma_f32_32x32x16_bf16 v[208:223], v[88:91], a[236:239], v[208:223]
    ds_read_b64_tr_b16 v[84:85], v11 offset:28672
    ds_read_b64_tr_b16 v[86:87], v11 offset:29184
    v_mul_f32 v189, v185, v189
    v_mul_f32 v190, v186, v190
    v_mul_f32 v191, v187, v191
    v_mfma_f32_32x32x16_bf16 v[224:239], v[92:95], a[232:235], v[224:239]
    v_fma_f32 v60, v60, s27, v15
    v_fma_f32 v61, v61, s27, v15
    v_fma_f32 v62, v62, s27, v15
    v_fma_f32 v63, v63, s27, v15
    v_mul_f32 v184, v60, v184
    v_mfma_f32_32x32x16_bf16 v[240:255], v[92:95], a[236:239], v[240:255]
    v_mul_f32 v185, v61, v185
    s_waitcnt lgkmcnt(4)
    v_mfma_f32_32x32x16_bf16 v[192:207], v[72:75], a[240:243], v[192:207]
    s_waitcnt vmcnt(19)
    s_waitcnt lgkmcnt(0)
    s_barrier
    v_mfma_f32_32x32x16_bf16 v[208:223], v[72:75], a[244:247], v[208:223]
    ds_read_b64_tr_b16 v[88:89], v8 offset:32768
    ds_read_b64_tr_b16 v[90:91], v8 offset:33280
    buffer_load_dwordx4 v7, s[12:15], s69 offen offset:3072 lds
    v_mul_f32 v186, v62, v186
    v_mfma_f32_32x32x16_bf16 v[224:239], v[76:79], a[240:243], v[224:239]
    ds_read_b64_tr_b16 v[92:93], v11 offset:32768
    ds_read_b64_tr_b16 v[94:95], v11 offset:33280
    v_mul_f32 v187, v63, v187
    v_exp_f32 v184, v184
    v_mfma_f32_32x32x16_bf16 v[240:255], v[76:79], a[244:247], v[240:255]
    v_exp_f32 v185, v185
    v_exp_f32 v186, v186
    v_exp_f32 v187, v187
    v_mfma_f32_32x32x16_bf16 v[192:207], v[80:83], a[248:251], v[192:207]
    ds_read_b64_tr_b16 v[72:73], v8 offset:36864
    ds_read_b64_tr_b16 v[74:75], v8 offset:37376
    v_add_f32 v184, 1.0, v184
    v_add_f32 v185, 1.0, v185
    v_add_f32 v186, 1.0, v186
    v_mfma_f32_32x32x16_bf16 v[208:223], v[80:83], a[252:255], v[208:223]
    ds_read_b64_tr_b16 v[76:77], v11 offset:36864
    ds_read_b64_tr_b16 v[78:79], v11 offset:37376
    s_add_u32 m0, s30, 16384
    s_nop 0
    buffer_load_dwordx4 v4, s[8:11], s70 offen lds
    v_mfma_f32_32x32x16_bf16 v[224:239], v[84:87], a[248:251], v[224:239]
    v_add_f32 v187, 1.0, v187
    v_rcp_f32 v184, v184
    v_rcp_f32 v185, v185
    v_mfma_f32_32x32x16_bf16 v[240:255], v[84:87], a[252:255], v[240:255]
    v_rcp_f32 v186, v186
    s_waitcnt lgkmcnt(4)
    v_mfma_f32_32x32x16_bf16 v[192:207], v[88:91], v[96:99], v[192:207]
    ds_read_b64_tr_b16 v[80:81], v8 offset:40960
    ds_read_b64_tr_b16 v[82:83], v8 offset:41472
    v_rcp_f32 v187, v187
    v_mul_f32 v188, v188, v184
    v_mfma_f32_32x32x16_bf16 v[208:223], v[88:91], v[100:103], v[208:223]
    ds_read_b64_tr_b16 v[84:85], v11 offset:40960
    ds_read_b64_tr_b16 v[86:87], v11 offset:41472
    buffer_load_dwordx4 v5, s[8:11], s70 offen offset:1024 lds
    v_mul_f32 v189, v189, v185
    v_mfma_f32_32x32x16_bf16 v[224:239], v[92:95], v[96:99], v[224:239]
    v_mul_f32 v190, v190, v186
    v_mul_f32 v191, v191, v187
    v_cvt_pk_bf16_f32 v70, v188, v189
    v_cvt_pk_bf16_f32 v71, v190, v191
    v_mfma_f32_32x32x16_bf16 v[240:255], v[92:95], v[100:103], v[240:255]
    ds_write_b128 v14, v[68:71] offset:5120
    s_waitcnt lgkmcnt(5)
    v_mfma_f32_32x32x16_bf16 v[192:207], v[72:75], v[104:107], v[192:207]
    ds_read_b64_tr_b16 v[88:89], v8 offset:45056
    ds_read_b64_tr_b16 v[90:91], v8 offset:45568
    v_mfma_f32_32x32x16_bf16 v[208:223], v[72:75], v[108:111], v[208:223]
    ds_read_b64_tr_b16 v[92:93], v11 offset:45056
    ds_read_b64_tr_b16 v[94:95], v11 offset:45568
    buffer_load_dwordx4 v6, s[12:15], s70 offen offset:2048 lds
    v_mfma_f32_32x32x16_bf16 v[224:239], v[76:79], v[104:107], v[224:239]
    v_mfma_f32_32x32x16_bf16 v[240:255], v[76:79], v[108:111], v[240:255]
    s_waitcnt lgkmcnt(5)
    v_mfma_f32_32x32x16_bf16 v[192:207], v[80:83], v[112:115], v[192:207]
    s_waitcnt vmcnt(19)
    s_waitcnt lgkmcnt(0)
    s_barrier
    v_mfma_f32_32x32x16_bf16 v[208:223], v[80:83], v[116:119], v[208:223]
    ds_read_b64_tr_b16 v[72:73], v8 offset:49152
    ds_read_b64_tr_b16 v[74:75], v8 offset:49664
    v_mfma_f32_32x32x16_bf16 v[224:239], v[84:87], v[112:115], v[224:239]
    ds_read_b64_tr_b16 v[76:77], v11 offset:49152
    ds_read_b64_tr_b16 v[78:79], v11 offset:49664
    buffer_load_dwordx4 v7, s[12:15], s70 offen offset:3072 lds
    v_mfma_f32_32x32x16_bf16 v[240:255], v[84:87], v[116:119], v[240:255]
    v_mfma_f32_32x32x16_bf16 v[192:207], v[88:91], v[120:123], v[192:207]
    ds_read_b64_tr_b16 v[80:81], v8 offset:53248
    ds_read_b64_tr_b16 v[82:83], v8 offset:53760
    v_mfma_f32_32x32x16_bf16 v[208:223], v[88:91], v[124:127], v[208:223]
    ds_read_b64_tr_b16 v[84:85], v11 offset:53248
    ds_read_b64_tr_b16 v[86:87], v11 offset:53760
    v_mfma_f32_32x32x16_bf16 v[224:239], v[92:95], v[120:123], v[224:239]
    s_add_u32 m0, s30, 32768
    s_nop 0
    buffer_load_dwordx4 v4, s[8:11], s71 offen lds
    v_mfma_f32_32x32x16_bf16 v[240:255], v[92:95], v[124:127], v[240:255]
    s_waitcnt lgkmcnt(4)
    v_mfma_f32_32x32x16_bf16 v[128:143], v[72:75], a[0:3], 0
    ds_read_b64_tr_b16 v[88:89], v8 offset:57344
    ds_read_b64_tr_b16 v[90:91], v8 offset:57856
    v_mul_f32 v56, v192, v192
    v_mul_f32 v57, v193, v193
    v_mul_f32 v58, v194, v194
    v_mfma_f32_32x32x16_bf16 v[144:159], v[72:75], a[4:7], 0
    ds_read_b64_tr_b16 v[92:93], v11 offset:57344
    ds_read_b64_tr_b16 v[94:95], v11 offset:57856
    v_mul_f32 v59, v195, v195
    v_mul_f32 v196, v192, v196
    v_mul_f32 v197, v193, v197
    v_mfma_f32_32x32x16_bf16 v[160:175], v[76:79], a[0:3], 0
    buffer_load_dwordx4 v5, s[8:11], s71 offen offset:1024 lds
    v_mul_f32 v198, v194, v198
    v_mul_f32 v199, v195, v199
    v_fma_f32 v56, v56, s27, v15
    v_mfma_f32_32x32x16_bf16 v[176:191], v[76:79], a[4:7], 0
    v_fma_f32 v57, v57, s27, v15
    v_fma_f32 v58, v58, s27, v15
    s_waitcnt lgkmcnt(4)
    v_mfma_f32_32x32x16_bf16 v[128:143], v[80:83], a[8:11], v[128:143]
    ds_read_b64_tr_b16 v[72:73], v8 offset:61440
    ds_read_b64_tr_b16 v[74:75], v8 offset:61952
    v_fma_f32 v59, v59, s27, v15
    v_mul_f32 v192, v56, v192
    v_mul_f32 v193, v57, v193
    v_mfma_f32_32x32x16_bf16 v[144:159], v[80:83], a[12:15], v[144:159]
    ds_read_b64_tr_b16 v[76:77], v11 offset:61440
    ds_read_b64_tr_b16 v[78:79], v11 offset:61952
    v_mul_f32 v194, v58, v194
    v_mul_f32 v195, v59, v195
    v_mfma_f32_32x32x16_bf16 v[160:175], v[84:87], a[8:11], v[160:175]
    buffer_load_dwordx4 v6, s[12:15], s71 offen offset:2048 lds
    v_exp_f32 v192, v192
    v_mfma_f32_32x32x16_bf16 v[176:191], v[84:87], a[12:15], v[176:191]
    v_exp_f32 v193, v193
    v_exp_f32 v194, v194
    s_waitcnt lgkmcnt(4)
    v_mfma_f32_32x32x16_bf16 v[128:143], v[88:91], a[16:19], v[128:143]
    s_waitcnt vmcnt(19)
    s_waitcnt lgkmcnt(0)
    s_barrier
    v_mfma_f32_32x32x16_bf16 v[144:159], v[88:91], a[20:23], v[144:159]
    ds_read_b64_tr_b16 v[80:81], v9 offset:0
    ds_read_b64_tr_b16 v[82:83], v9 offset:512
    v_exp_f32 v195, v195
    v_add_f32 v192, 1.0, v192
    v_mfma_f32_32x32x16_bf16 v[160:175], v[92:95], a[16:19], v[160:175]
    ds_read_b64_tr_b16 v[84:85], v12 offset:0
    ds_read_b64_tr_b16 v[86:87], v12 offset:512
    v_add_f32 v193, 1.0, v193
    v_add_f32 v194, 1.0, v194
    v_add_f32 v195, 1.0, v195
    v_mfma_f32_32x32x16_bf16 v[176:191], v[92:95], a[20:23], v[176:191]
    buffer_load_dwordx4 v7, s[12:15], s71 offen offset:3072 lds
    v_rcp_f32 v192, v192
    v_rcp_f32 v193, v193
    v_rcp_f32 v194, v194
    v_mfma_f32_32x32x16_bf16 v[128:143], v[72:75], a[24:27], v[128:143]
    ds_read_b64_tr_b16 v[88:89], v9 offset:4096
    ds_read_b64_tr_b16 v[90:91], v9 offset:4608
    v_rcp_f32 v195, v195
    v_mul_f32 v196, v196, v192
    v_mfma_f32_32x32x16_bf16 v[144:159], v[72:75], a[28:31], v[144:159]
    ds_read_b64_tr_b16 v[92:93], v12 offset:4096
    ds_read_b64_tr_b16 v[94:95], v12 offset:4608
    v_mul_f32 v197, v197, v193
    v_mul_f32 v198, v198, v194
    v_mul_f32 v199, v199, v195
    v_mfma_f32_32x32x16_bf16 v[160:175], v[76:79], a[24:27], v[160:175]
    v_cvt_pk_bf16_f32 v64, v196, v197
    v_cvt_pk_bf16_f32 v65, v198, v199
    v_mul_f32 v60, v200, v200
    v_mul_f32 v61, v201, v201
    v_mul_f32 v62, v202, v202
    v_mfma_f32_32x32x16_bf16 v[176:191], v[76:79], a[28:31], v[176:191]
    s_add_u32 m0, s30, 49152
    s_nop 0
    buffer_load_dwordx4 v4, s[8:11], s72 offen lds
    s_waitcnt lgkmcnt(4)
    v_mfma_f32_32x32x16_bf16 v[128:143], v[80:83], a[32:35], v[128:143]
    ds_read_b64_tr_b16 v[72:73], v9 offset:8192
    ds_read_b64_tr_b16 v[74:75], v9 offset:8704
    v_mul_f32 v63, v203, v203
    v_mul_f32 v204, v200, v204
    v_mul_f32 v205, v201, v205
    v_mfma_f32_32x32x16_bf16 v[144:159], v[80:83], a[36:39], v[144:159]
    ds_read_b64_tr_b16 v[76:77], v12 offset:8192
    ds_read_b64_tr_b16 v[78:79], v12 offset:8704
    v_mul_f32 v206, v202, v206
    v_mul_f32 v207, v203, v207
    v_fma_f32 v60, v60, s27, v15
    v_mfma_f32_32x32x16_bf16 v[160:175], v[84:87], a[32:35], v[160:175]
    v_fma_f32 v61, v61, s27, v15
    v_fma_f32 v62, v62, s27, v15
    v_fma_f32 v63, v63, s27, v15
    v_mul_f32 v200, v60, v200
    v_mul_f32 v201, v61, v201
    v_mfma_f32_32x32x16_bf16 v[176:191], v[84:87], a[36:39], v[176:191]
    buffer_load_dwordx4 v5, s[8:11], s72 offen offset:1024 lds
    s_waitcnt lgkmcnt(4)
    v_mfma_f32_32x32x16_bf16 v[128:143], v[88:91], a[40:43], v[128:143]
    ds_read_b64_tr_b16 v[80:81], v9 offset:12288
    ds_read_b64_tr_b16 v[82:83], v9 offset:12800
    v_mul_f32 v202, v62, v202
    v_mul_f32 v203, v63, v203
    v_mfma_f32_32x32x16_bf16 v[144:159], v[88:91], a[44:47], v[144:159]
    ds_read_b64_tr_b16 v[84:85], v12 offset:12288
    ds_read_b64_tr_b16 v[86:87], v12 offset:12800
    v_exp_f32 v200, v200
    v_mfma_f32_32x32x16_bf16 v[160:175], v[92:95], a[40:43], v[160:175]
    v_exp_f32 v201, v201
    v_exp_f32 v202, v202
    v_mfma_f32_32x32x16_bf16 v[176:191], v[92:95], a[44:47], v[176:191]
    buffer_load_dwordx4 v6, s[12:15], s72 offen offset:2048 lds
    v_exp_f32 v203, v203
    v_add_f32 v200, 1.0, v200
    s_waitcnt lgkmcnt(4)
    v_mfma_f32_32x32x16_bf16 v[128:143], v[72:75], a[48:51], v[128:143]
    s_waitcnt vmcnt(19)
    s_waitcnt lgkmcnt(0)
    s_barrier
    v_mfma_f32_32x32x16_bf16 v[144:159], v[72:75], a[52:55], v[144:159]
    ds_read_b64_tr_b16 v[88:89], v9 offset:57344
    ds_read_b64_tr_b16 v[90:91], v9 offset:57856
    v_add_f32 v201, 1.0, v201
    v_add_f32 v202, 1.0, v202
    v_add_f32 v203, 1.0, v203
    v_mfma_f32_32x32x16_bf16 v[160:175], v[76:79], a[48:51], v[160:175]
    ds_read_b64_tr_b16 v[92:93], v12 offset:57344
    ds_read_b64_tr_b16 v[94:95], v12 offset:57856
    v_rcp_f32 v200, v200
    v_mfma_f32_32x32x16_bf16 v[176:191], v[76:79], a[52:55], v[176:191]
    v_rcp_f32 v201, v201
    v_rcp_f32 v202, v202
    v_rcp_f32 v203, v203
    v_mfma_f32_32x32x16_bf16 v[128:143], v[80:83], a[56:59], v[128:143]
    ds_read_b64_tr_b16 v[72:73], v9 offset:61440
    ds_read_b64_tr_b16 v[74:75], v9 offset:61952
    buffer_load_dwordx4 v7, s[12:15], s72 offen offset:3072 lds
    v_mul_f32 v204, v204, v200
    v_mfma_f32_32x32x16_bf16 v[144:159], v[80:83], a[60:63], v[144:159]
    ds_read_b64_tr_b16 v[76:77], v12 offset:61440
    ds_read_b64_tr_b16 v[78:79], v12 offset:61952
    v_mul_f32 v205, v205, v201
    v_mul_f32 v206, v206, v202
    v_mul_f32 v207, v207, v203
    v_mfma_f32_32x32x16_bf16 v[160:175], v[84:87], a[56:59], v[160:175]
    v_cvt_pk_bf16_f32 v66, v204, v205
    v_cvt_pk_bf16_f32 v67, v206, v207
    ds_write_b128 v14, v[64:67] offset:16384
    v_mul_f32 v56, v208, v208
    v_mfma_f32_32x32x16_bf16 v[176:191], v[84:87], a[60:63], v[176:191]
    v_mul_f32 v57, v209, v209
    v_mul_f32 v58, v210, v210
    s_waitcnt lgkmcnt(5)
    v_mfma_f32_32x32x16_bf16 v[128:143], v[88:91], a[64:67], v[128:143]
    ds_read_b64_tr_b16 v[80:81], v10 offset:0
    ds_read_b64_tr_b16 v[82:83], v10 offset:512
    s_add_u32 m0, s30, 65536
    s_nop 0
    buffer_load_dwordx4 v4, s[8:11], s73 offen lds
    v_mfma_f32_32x32x16_bf16 v[144:159], v[88:91], a[68:71], v[144:159]
    ds_read_b64_tr_b16 v[84:85], v13 offset:0
    ds_read_b64_tr_b16 v[86:87], v13 offset:512
    v_mul_f32 v59, v211, v211
    v_mul_f32 v212, v208, v212
    v_mul_f32 v213, v209, v213
    v_mfma_f32_32x32x16_bf16 v[160:175], v[92:95], a[64:67], v[160:175]
    v_mul_f32 v214, v210, v214
    v_mul_f32 v215, v211, v215
    v_fma_f32 v56, v56, s27, v15
    v_fma_f32 v57, v57, s27, v15
    v_fma_f32 v58, v58, s27, v15
    v_mfma_f32_32x32x16_bf16 v[176:191], v[92:95], a[68:71], v[176:191]
    v_fma_f32 v59, v59, s27, v15
    v_mul_f32 v208, v56, v208
    v_mul_f32 v209, v57, v209
    s_waitcnt lgkmcnt(5)
    v_mfma_f32_32x32x16_bf16 v[128:143], v[72:75], a[72:75], v[128:143]
    ds_read_b64_tr_b16 v[88:89], v10 offset:4096
    ds_read_b64_tr_b16 v[90:91], v10 offset:4608
    buffer_load_dwordx4 v5, s[8:11], s73 offen offset:1024 lds
    v_mul_f32 v210, v58, v210
    v_mfma_f32_32x32x16_bf16 v[144:159], v[72:75], a[76:79], v[144:159]
    ds_read_b64_tr_b16 v[92:93], v13 offset:4096
    ds_read_b64_tr_b16 v[94:95], v13 offset:4608
    v_mul_f32 v211, v59, v211
    v_exp_f32 v208, v208
    v_mfma_f32_32x32x16_bf16 v[160:175], v[76:79], a[72:75], v[160:175]
    v_exp_f32 v209, v209
    v_exp_f32 v210, v210
    v_mfma_f32_32x32x16_bf16 v[176:191], v[76:79], a[76:79], v[176:191]
    v_exp_f32 v211, v211
    v_add_f32 v208, 1.0, v208
    s_waitcnt lgkmcnt(4)
    v_mfma_f32_32x32x16_bf16 v[128:143], v[80:83], a[80:83], v[128:143]
    s_waitcnt vmcnt(18)
    s_waitcnt lgkmcnt(0)
    s_barrier
    v_mfma_f32_32x32x16_bf16 v[144:159], v[80:83], a[84:87], v[144:159]
    ds_read_b64_tr_b16 v[72:73], v10 offset:8192
    ds_read_b64_tr_b16 v[74:75], v10 offset:8704
    buffer_load_dwordx4 v6, s[12:15], s73 offen offset:2048 lds
    v_add_f32 v209, 1.0, v209
    v_mfma_f32_32x32x16_bf16 v[160:175], v[84:87], a[80:83], v[160:175]
    ds_read_b64_tr_b16 v[76:77], v13 offset:8192
    ds_read_b64_tr_b16 v[78:79], v13 offset:8704
    v_add_f32 v210, 1.0, v210
    v_add_f32 v211, 1.0, v211
    v_mfma_f32_32x32x16_bf16 v[176:191], v[84:87], a[84:87], v[176:191]
    v_rcp_f32 v208, v208
    v_rcp_f32 v209, v209
    v_rcp_f32 v210, v210
    v_rcp_f32 v211, v211
    v_mfma_f32_32x32x16_bf16 v[128:143], v[88:91], a[88:91], v[128:143]
    ds_read_b64_tr_b16 v[80:81], v10 offset:12288
    ds_read_b64_tr_b16 v[82:83], v10 offset:12800
    v_mul_f32 v212, v212, v208
    v_mul_f32 v213, v213, v209
    v_mul_f32 v214, v214, v210
    v_mfma_f32_32x32x16_bf16 v[144:159], v[88:91], a[92:95], v[144:159]
    ds_read_b64_tr_b16 v[84:85], v13 offset:12288
    ds_read_b64_tr_b16 v[86:87], v13 offset:12800
    buffer_load_dwordx4 v7, s[12:15], s73 offen offset:3072 lds
    v_mul_f32 v215, v215, v211
    v_mfma_f32_32x32x16_bf16 v[160:175], v[92:95], a[88:91], v[160:175]
    v_cvt_pk_bf16_f32 v68, v212, v213
    v_cvt_pk_bf16_f32 v69, v214, v215
    v_mul_f32 v60, v216, v216
    v_mul_f32 v61, v217, v217
    v_mul_f32 v62, v218, v218
    v_mfma_f32_32x32x16_bf16 v[176:191], v[92:95], a[92:95], v[176:191]
    v_mul_f32 v63, v219, v219
    v_mul_f32 v220, v216, v220
    s_waitcnt lgkmcnt(4)
    v_mfma_f32_32x32x16_bf16 v[128:143], v[72:75], a[96:99], v[128:143]
    ds_read_b64_tr_b16 v[88:89], v10 offset:16384
    ds_read_b64_tr_b16 v[90:91], v10 offset:16896
    v_mul_f32 v221, v217, v221
    v_mul_f32 v222, v218, v222
    v_mul_f32 v223, v219, v223
    v_mfma_f32_32x32x16_bf16 v[144:159], v[72:75], a[100:103], v[144:159]
    ds_read_b64_tr_b16 v[92:93], v13 offset:16384
    ds_read_b64_tr_b16 v[94:95], v13 offset:16896
    v_fma_f32 v60, v60, s27, v15
    v_fma_f32 v61, v61, s27, v15
    v_fma_f32 v62, v62, s27, v15
    v_mfma_f32_32x32x16_bf16 v[160:175], v[76:79], a[96:99], v[160:175]
    v_fma_f32 v63, v63, s27, v15
    v_mul_f32 v216, v60, v216
    v_mul_f32 v217, v61, v217
    v_mul_f32 v218, v62, v218
    v_mul_f32 v219, v63, v219
    v_mfma_f32_32x32x16_bf16 v[176:191], v[76:79], a[100:103], v[176:191]
    s_waitcnt lgkmcnt(4)
    v_mfma_f32_32x32x16_bf16 v[128:143], v[80:83], a[104:107], v[128:143]
    ds_read_b64_tr_b16 v[72:73], v10 offset:20480
    ds_read_b64_tr_b16 v[74:75], v10 offset:20992
    v_exp_f32 v216, v216
    v_mfma_f32_32x32x16_bf16 v[144:159], v[80:83], a[108:111], v[144:159]
    ds_read_b64_tr_b16 v[76:77], v13 offset:20480
    ds_read_b64_tr_b16 v[78:79], v13 offset:20992
    v_exp_f32 v217, v217
    v_mfma_f32_32x32x16_bf16 v[160:175], v[84:87], a[104:107], v[160:175]
    v_exp_f32 v218, v218
    v_exp_f32 v219, v219
    v_add_f32 v216, 1.0, v216
    v_mfma_f32_32x32x16_bf16 v[176:191], v[84:87], a[108:111], v[176:191]
    v_add_f32 v217, 1.0, v217
    s_waitcnt lgkmcnt(4)
    v_mfma_f32_32x32x16_bf16 v[128:143], v[88:91], a[112:115], v[128:143]
    s_waitcnt vmcnt(16)
    s_waitcnt lgkmcnt(0)
    s_barrier
    v_mfma_f32_32x32x16_bf16 v[144:159], v[88:91], a[116:119], v[144:159]
    ds_read_b64_tr_b16 v[80:81], v8 offset:0
    ds_read_b64_tr_b16 v[82:83], v8 offset:512
    s_add_u32 s8, s8, 128
    s_addc_u32 s9, s9, 0
    s_add_u32 s12, s12, 128
    s_addc_u32 s13, s13, 0
    s_add_u32 m0, s30, 139264
    s_nop 0
    buffer_load_dwordx4 v4, s[8:11], s65 offen lds
    v_mfma_f32_32x32x16_bf16 v[160:175], v[92:95], a[112:115], v[160:175]
    ds_read_b64_tr_b16 v[84:85], v11 offset:0
    ds_read_b64_tr_b16 v[86:87], v11 offset:512
    v_add_f32 v218, 1.0, v218
    v_add_f32 v219, 1.0, v219
    v_mfma_f32_32x32x16_bf16 v[176:191], v[92:95], a[116:119], v[176:191]
    v_rcp_f32 v216, v216
    v_rcp_f32 v217, v217
    v_rcp_f32 v218, v218
    v_rcp_f32 v219, v219
    v_mfma_f32_32x32x16_bf16 v[128:143], v[72:75], a[120:123], v[128:143]
    ds_read_b64_tr_b16 v[88:89], v8 offset:4096
    ds_read_b64_tr_b16 v[90:91], v8 offset:4608
    buffer_load_dwordx4 v5, s[8:11], s65 offen offset:1024 lds
    v_mul_f32 v220, v220, v216
    v_mfma_f32_32x32x16_bf16 v[144:159], v[72:75], a[124:127], v[144:159]
    ds_read_b64_tr_b16 v[92:93], v11 offset:4096
    ds_read_b64_tr_b16 v[94:95], v11 offset:4608
    v_mul_f32 v221, v221, v217
    v_mul_f32 v222, v222, v218
    v_mul_f32 v223, v223, v219
    v_mfma_f32_32x32x16_bf16 v[160:175], v[76:79], a[120:123], v[160:175]
    v_cvt_pk_bf16_f32 v70, v220, v221
    v_cvt_pk_bf16_f32 v71, v222, v223
    ds_write_b128 v14, v[68:71] offset:17408
    v_mul_f32 v56, v224, v224
    v_mfma_f32_32x32x16_bf16 v[176:191], v[76:79], a[124:127], v[176:191]
    v_mul_f32 v57, v225, v225
    s_waitcnt lgkmcnt(5)
    v_mfma_f32_32x32x16_bf16 v[128:143], v[80:83], a[128:131], v[128:143]
    ds_read_b64_tr_b16 v[72:73], v8 offset:8192
    ds_read_b64_tr_b16 v[74:75], v8 offset:8704
    buffer_load_dwordx4 v6, s[12:15], s65 offen offset:2048 lds
    v_mul_f32 v58, v226, v226
    v_mfma_f32_32x32x16_bf16 v[144:159], v[80:83], a[132:135], v[144:159]
    ds_read_b64_tr_b16 v[76:77], v11 offset:8192
    ds_read_b64_tr_b16 v[78:79], v11 offset:8704
    v_mul_f32 v59, v227, v227
    v_mul_f32 v228, v224, v228
    v_mul_f32 v229, v225, v229
    v_mfma_f32_32x32x16_bf16 v[160:175], v[84:87], a[128:131], v[160:175]
    v_mul_f32 v230, v226, v230
    v_mul_f32 v231, v227, v231
    v_fma_f32 v56, v56, s27, v15
    v_fma_f32 v57, v57, s27, v15
    v_fma_f32 v58, v58, s27, v15
    v_mfma_f32_32x32x16_bf16 v[176:191], v[84:87], a[132:135], v[176:191]
    v_fma_f32 v59, v59, s27, v15
    s_waitcnt lgkmcnt(5)
    v_mfma_f32_32x32x16_bf16 v[128:143], v[88:91], a[136:139], v[128:143]
    ds_read_b64_tr_b16 v[80:81], v8 offset:12288
    ds_read_b64_tr_b16 v[82:83], v8 offset:12800
    buffer_load_dwordx4 v7, s[12:15], s65 offen offset:3072 lds
    v_mul_f32 v224, v56, v224
    v_mfma_f32_32x32x16_bf16 v[144:159], v[88:91], a[140:143], v[144:159]
    ds_read_b64_tr_b16 v[84:85], v11 offset:12288
    ds_read_b64_tr_b16 v[86:87], v11 offset:12800
    v_mul_f32 v225, v57, v225
    v_mul_f32 v226, v58, v226
    v_mul_f32 v227, v59, v227
    v_mfma_f32_32x32x16_bf16 v[160:175], v[92:95], a[136:139], v[160:175]
    v_exp_f32 v224, v224
    v_exp_f32 v225, v225
    v_mfma_f32_32x32x16_bf16 v[176:191], v[92:95], a[140:143], v[176:191]
    v_exp_f32 v226, v226
    s_waitcnt lgkmcnt(4)
    v_mfma_f32_32x32x16_bf16 v[128:143], v[72:75], a[144:147], v[128:143]
    s_waitcnt vmcnt(16)
    s_waitcnt lgkmcnt(0)
    s_barrier
    v_mfma_f32_32x32x16_bf16 v[144:159], v[72:75], a[148:151], v[144:159]
    ds_read_b64_tr_b16 v[88:89], v8 offset:16384
    ds_read_b64_tr_b16 v[90:91], v8 offset:16896
    s_add_u32 m0, s30, 0
    s_nop 0
    buffer_load_dwordx4 v4, s[8:11], s66 offen lds
    v_mfma_f32_32x32x16_bf16 v[160:175], v[76:79], a[144:147], v[160:175]
    ds_read_b64_tr_b16 v[92:93], v11 offset:16384
    ds_read_b64_tr_b16 v[94:95], v11 offset:16896
    v_exp_f32 v227, v227
    v_add_f32 v224, 1.0, v224
    v_mfma_f32_32x32x16_bf16 v[176:191], v[76:79], a[148:151], v[176:191]
    v_add_f32 v225, 1.0, v225
    v_add_f32 v226, 1.0, v226
    v_add_f32 v227, 1.0, v227
    v_rcp_f32 v224, v224
    v_rcp_f32 v225, v225
    v_mfma_f32_32x32x16_bf16 v[128:143], v[80:83], a[152:155], v[128:143]
    ds_read_b64_tr_b16 v[72:73], v8 offset:20480
    ds_read_b64_tr_b16 v[74:75], v8 offset:20992
    v_rcp_f32 v226, v226
    v_mfma_f32_32x32x16_bf16 v[144:159], v[80:83], a[156:159], v[144:159]
    ds_read_b64_tr_b16 v[76:77], v11 offset:20480
    ds_read_b64_tr_b16 v[78:79], v11 offset:20992
    buffer_load_dwordx4 v5, s[8:11], s66 offen offset:1024 lds
    v_mfma_f32_32x32x16_bf16 v[160:175], v[84:87], a[152:155], v[160:175]
    v_rcp_f32 v227, v227
    v_mul_f32 v228, v228, v224
    v_mul_f32 v229, v229, v225
    v_mul_f32 v230, v230, v226
    v_mfma_f32_32x32x16_bf16 v[176:191], v[84:87], a[156:159], v[176:191]
    v_mul_f32 v231, v231, v227
    v_cvt_pk_bf16_f32 v64, v228, v229
    v_cvt_pk_bf16_f32 v65, v230, v231
    s_waitcnt lgkmcnt(4)
    v_mfma_f32_32x32x16_bf16 v[128:143], v[88:91], a[160:163], v[128:143]
    ds_read_b64_tr_b16 v[80:81], v8 offset:24576
    ds_read_b64_tr_b16 v[82:83], v8 offset:25088
    v_mul_f32 v60, v232, v232
    v_mul_f32 v61, v233, v233
    v_mul_f32 v62, v234, v234
    v_mfma_f32_32x32x16_bf16 v[144:159], v[88:91], a[164:167], v[144:159]
    ds_read_b64_tr_b16 v[84:85], v11 offset:24576
    ds_read_b64_tr_b16 v[86:87], v11 offset:25088
    buffer_load_dwordx4 v6, s[12:15], s66 offen offset:2048 lds
    v_mul_f32 v63, v235, v235
    v_mfma_f32_32x32x16_bf16 v[160:175], v[92:95], a[160:163], v[160:175]
    v_mul_f32 v236, v232, v236
    v_mul_f32 v237, v233, v237
    v_mul_f32 v238, v234, v238
    v_mul_f32 v239, v235, v239
    v_fma_f32 v60, v60, s27, v15
    v_mfma_f32_32x32x16_bf16 v[176:191], v[92:95], a[164:167], v[176:191]
    v_fma_f32 v61, v61, s27, v15
    s_waitcnt lgkmcnt(4)
    v_mfma_f32_32x32x16_bf16 v[128:143], v[72:75], a[168:171], v[128:143]
    ds_read_b64_tr_b16 v[88:89], v8 offset:28672
    ds_read_b64_tr_b16 v[90:91], v8 offset:29184
    v_fma_f32 v62, v62, s27, v15
    v_fma_f32 v63, v63, s27, v15
    v_mul_f32 v232, v60, v232
    v_mfma_f32_32x32x16_bf16 v[144:159], v[72:75], a[172:175], v[144:159]
    ds_read_b64_tr_b16 v[92:93], v11 offset:28672
    ds_read_b64_tr_b16 v[94:95], v11 offset:29184
    buffer_load_dwordx4 v7, s[12:15], s66 offen offset:3072 lds
    v_mul_f32 v233, v61, v233
    v_mfma_f32_32x32x16_bf16 v[160:175], v[76:79], a[168:171], v[160:175]
    v_mul_f32 v234, v62, v234
    v_mul_f32 v235, v63, v235
    v_exp_f32 v232, v232
    v_mfma_f32_32x32x16_bf16 v[176:191], v[76:79], a[172:175], v[176:191]
    v_exp_f32 v233, v233
    s_waitcnt lgkmcnt(4)
    v_mfma_f32_32x32x16_bf16 v[128:143], v[80:83], a[176:179], v[128:143]
    s_waitcnt vmcnt(16)
    s_waitcnt lgkmcnt(0)
    s_barrier
    v_mfma_f32_32x32x16_bf16 v[144:159], v[80:83], a[180:183], v[144:159]
    ds_read_b64_tr_b16 v[72:73], v8 offset:32768
    ds_read_b64_tr_b16 v[74:75], v8 offset:33280
    v_exp_f32 v234, v234
    v_mfma_f32_32x32x16_bf16 v[160:175], v[84:87], a[176:179], v[160:175]
    ds_read_b64_tr_b16 v[76:77], v11 offset:32768
    ds_read_b64_tr_b16 v[78:79], v11 offset:33280
    s_add_u32 m0, s30, 16384
    s_nop 0
    buffer_load_dwordx4 v4, s[8:11], s67 offen lds
    v_mfma_f32_32x32x16_bf16 v[176:191], v[84:87], a[180:183], v[176:191]
    v_exp_f32 v235, v235
    v_add_f32 v232, 1.0, v232
    v_add_f32 v233, 1.0, v233
    v_add_f32 v234, 1.0, v234
    v_add_f32 v235, 1.0, v235
    v_rcp_f32 v232, v232
    v_mfma_f32_32x32x16_bf16 v[128:143], v[88:91], a[184:187], v[128:143]
    ds_read_b64_tr_b16 v[80:81], v8 offset:36864
    ds_read_b64_tr_b16 v[82:83], v8 offset:37376
    v_rcp_f32 v233, v233
    v_mfma_f32_32x32x16_bf16 v[144:159], v[88:91], a[188:191], v[144:159]
    ds_read_b64_tr_b16 v[84:85], v11 offset:36864
    ds_read_b64_tr_b16 v[86:87], v11 offset:37376
    v_rcp_f32 v234, v234
    v_mfma_f32_32x32x16_bf16 v[160:175], v[92:95], a[184:187], v[160:175]
    buffer_load_dwordx4 v5, s[8:11], s67 offen offset:1024 lds
    v_rcp_f32 v235, v235
    v_mul_f32 v236, v236, v232
    v_mfma_f32_32x32x16_bf16 v[176:191], v[92:95], a[188:191], v[176:191]
    v_mul_f32 v237, v237, v233
    v_mul_f32 v238, v238, v234
    v_mul_f32 v239, v239, v235
    s_waitcnt lgkmcnt(4)
    v_mfma_f32_32x32x16_bf16 v[128:143], v[72:75], a[192:195], v[128:143]
    ds_read_b64_tr_b16 v[88:89], v8 offset:40960
    ds_read_b64_tr_b16 v[90:91], v8 offset:41472
    v_cvt_pk_bf16_f32 v66, v236, v237
    v_cvt_pk_bf16_f32 v67, v238, v239
    v_mfma_f32_32x32x16_bf16 v[144:159], v[72:75], a[196:199], v[144:159]
    ds_read_b64_tr_b16 v[92:93], v11 offset:40960
    ds_read_b64_tr_b16 v[94:95], v11 offset:41472
    ds_write_b128 v14, v[64:67] offset:20480
    v_mul_f32 v56, v240, v240
    v_mfma_f32_32x32x16_bf16 v[160:175], v[76:79], a[192:195], v[160:175]
    buffer_load_dwordx4 v6, s[12:15], s67 offen offset:2048 lds
    v_mul_f32 v57, v241, v241
    v_mul_f32 v58, v242, v242
    v_mul_f32 v59, v243, v243
    v_mfma_f32_32x32x16_bf16 v[176:191], v[76:79], a[196:199], v[176:191]
    v_mul_f32 v244, v240, v244
    v_mul_f32 v245, v241, v245
    s_waitcnt lgkmcnt(5)
    v_mfma_f32_32x32x16_bf16 v[128:143], v[80:83], a[200:203], v[128:143]
    ds_read_b64_tr_b16 v[72:73], v8 offset:45056
    ds_read_b64_tr_b16 v[74:75], v8 offset:45568
    v_mul_f32 v246, v242, v246
    v_mul_f32 v247, v243, v247
    v_fma_f32 v56, v56, s27, v15
    v_mfma_f32_32x32x16_bf16 v[144:159], v[80:83], a[204:207], v[144:159]
    ds_read_b64_tr_b16 v[76:77], v11 offset:45056
    ds_read_b64_tr_b16 v[78:79], v11 offset:45568
    v_fma_f32 v57, v57, s27, v15
    v_fma_f32 v58, v58, s27, v15
    v_fma_f32 v59, v59, s27, v15
    v_mfma_f32_32x32x16_bf16 v[160:175], v[84:87], a[200:203], v[160:175]
    buffer_load_dwordx4 v7, s[12:15], s67 offen offset:3072 lds
    v_mul_f32 v240, v56, v240
    v_mul_f32 v241, v57, v241
    v_mul_f32 v242, v58, v242
    v_mfma_f32_32x32x16_bf16 v[176:191], v[84:87], a[204:207], v[176:191]
    v_mul_f32 v243, v59, v243
    s_waitcnt lgkmcnt(5)
    v_mfma_f32_32x32x16_bf16 v[128:143], v[88:91], a[208:211], v[128:143]
    s_waitcnt vmcnt(16)
    s_waitcnt lgkmcnt(0)
    s_barrier
    v_mfma_f32_32x32x16_bf16 v[144:159], v[88:91], a[212:215], v[144:159]
    ds_read_b64_tr_b16 v[80:81], v8 offset:49152
    ds_read_b64_tr_b16 v[82:83], v8 offset:49664
    v_exp_f32 v240, v240
    v_mfma_f32_32x32x16_bf16 v[160:175], v[92:95], a[208:211], v[160:175]
    ds_read_b64_tr_b16 v[84:85], v11 offset:49152
    ds_read_b64_tr_b16 v[86:87], v11 offset:49664
    v_exp_f32 v241, v241
    v_mfma_f32_32x32x16_bf16 v[176:191], v[92:95], a[212:215], v[176:191]
    s_add_u32 m0, s30, 32768
    s_nop 0
    buffer_load_dwordx4 v4, s[8:11], s68 offen lds
    v_exp_f32 v242, v242
    v_exp_f32 v243, v243
    v_add_f32 v240, 1.0, v240
    v_add_f32 v241, 1.0, v241
    v_mfma_f32_32x32x16_bf16 v[128:143], v[72:75], a[216:219], v[128:143]
    ds_read_b64_tr_b16 v[88:89], v8 offset:53248
    ds_read_b64_tr_b16 v[90:91], v8 offset:53760
    v_add_f32 v242, 1.0, v242
    v_add_f32 v243, 1.0, v243
    v_mfma_f32_32x32x16_bf16 v[144:159], v[72:75], a[220:223], v[144:159]
    ds_read_b64_tr_b16 v[92:93], v11 offset:53248
    ds_read_b64_tr_b16 v[94:95], v11 offset:53760
    v_rcp_f32 v240, v240
    v_mfma_f32_32x32x16_bf16 v[160:175], v[76:79], a[216:219], v[160:175]
    v_rcp_f32 v241, v241
    v_rcp_f32 v242, v242
    v_mfma_f32_32x32x16_bf16 v[176:191], v[76:79], a[220:223], v[176:191]
    buffer_load_dwordx4 v5, s[8:11], s68 offen offset:1024 lds
    v_rcp_f32 v243, v243
    s_waitcnt lgkmcnt(4)
    v_mfma_f32_32x32x16_bf16 v[128:143], v[80:83], a[224:227], v[128:143]
    ds_read_b64_tr_b16 v[72:73], v8 offset:57344
    ds_read_b64_tr_b16 v[74:75], v8 offset:57856
    v_mul_f32 v244, v244, v240
    v_mul_f32 v245, v245, v241
    v_mul_f32 v246, v246, v242
    v_mfma_f32_32x32x16_bf16 v[144:159], v[80:83], a[228:231], v[144:159]
    ds_read_b64_tr_b16 v[76:77], v11 offset:57344
    ds_read_b64_tr_b16 v[78:79], v11 offset:57856
    v_mul_f32 v247, v247, v243
    v_cvt_pk_bf16_f32 v68, v244, v245
    v_cvt_pk_bf16_f32 v69, v246, v247
    v_mfma_f32_32x32x16_bf16 v[160:175], v[84:87], a[224:227], v[160:175]
    v_mul_f32 v60, v248, v248
    v_mul_f32 v61, v249, v249
    v_mul_f32 v62, v250, v250
    v_mul_f32 v63, v251, v251
    v_mfma_f32_32x32x16_bf16 v[176:191], v[84:87], a[228:231], v[176:191]
    buffer_load_dwordx4 v6, s[12:15], s68 offen offset:2048 lds
    s_waitcnt lgkmcnt(4)
    v_mfma_f32_32x32x16_bf16 v[128:143], v[88:91], a[232:235], v[128:143]
    ds_read_b64_tr_b16 v[80:81], v8 offset:61440
    ds_read_b64_tr_b16 v[82:83], v8 offset:61952
    v_mul_f32 v252, v248, v252
    v_mul_f32 v253, v249, v253
    v_mul_f32 v254, v250, v254
    v_mfma_f32_32x32x16_bf16 v[144:159], v[88:91], a[236:239], v[144:159]
    ds_read_b64_tr_b16 v[84:85], v11 offset:61440
    ds_read_b64_tr_b16 v[86:87], v11 offset:61952
    v_mul_f32 v255, v251, v255
    v_fma_f32 v60, v60, s27, v15
    v_fma_f32 v61, v61, s27, v15
    v_mfma_f32_32x32x16_bf16 v[160:175], v[92:95], a[232:235], v[160:175]
    v_fma_f32 v62, v62, s27, v15
    v_fma_f32 v63, v63, s27, v15
    v_mul_f32 v248, v60, v248
    v_mul_f32 v249, v61, v249
    v_mfma_f32_32x32x16_bf16 v[176:191], v[92:95], a[236:239], v[176:191]
    buffer_load_dwordx4 v7, s[12:15], s68 offen offset:3072 lds
    s_waitcnt lgkmcnt(4)
    v_mfma_f32_32x32x16_bf16 v[128:143], v[72:75], a[240:243], v[128:143]
    s_waitcnt vmcnt(16)
    s_waitcnt lgkmcnt(0)
    s_barrier
    v_mfma_f32_32x32x16_bf16 v[144:159], v[72:75], a[244:247], v[144:159]
    ds_read_b64_tr_b16 v[88:89], v9 offset:0
    ds_read_b64_tr_b16 v[90:91], v9 offset:512
    v_mul_f32 v250, v62, v250
    v_mul_f32 v251, v63, v251
    v_mfma_f32_32x32x16_bf16 v[160:175], v[76:79], a[240:243], v[160:175]
    ds_read_b64_tr_b16 v[92:93], v12 offset:0
    ds_read_b64_tr_b16 v[94:95], v12 offset:512
    v_exp_f32 v248, v248
    v_mfma_f32_32x32x16_bf16 v[176:191], v[76:79], a[244:247], v[176:191]
    v_exp_f32 v249, v249
    v_exp_f32 v250, v250
    v_exp_f32 v251, v251
    v_mfma_f32_32x32x16_bf16 v[128:143], v[80:83], a[248:251], v[128:143]
    ds_read_b64_tr_b16 v[72:73], v9 offset:4096
    ds_read_b64_tr_b16 v[74:75], v9 offset:4608
    s_add_u32 m0, s30, 49152
    s_nop 0
    buffer_load_dwordx4 v4, s[8:11], s69 offen lds
    v_mfma_f32_32x32x16_bf16 v[144:159], v[80:83], a[252:255], v[144:159]
    ds_read_b64_tr_b16 v[76:77], v12 offset:4096
    ds_read_b64_tr_b16 v[78:79], v12 offset:4608
    v_add_f32 v248, 1.0, v248
    v_add_f32 v249, 1.0, v249
    v_add_f32 v250, 1.0, v250
    v_mfma_f32_32x32x16_bf16 v[160:175], v[84:87], a[248:251], v[160:175]
    v_add_f32 v251, 1.0, v251
    v_rcp_f32 v248, v248
    v_rcp_f32 v249, v249
    v_mfma_f32_32x32x16_bf16 v[176:191], v[84:87], a[252:255], v[176:191]
    v_rcp_f32 v250, v250
    s_waitcnt lgkmcnt(4)
    v_mfma_f32_32x32x16_bf16 v[128:143], v[88:91], v[96:99], v[128:143]
    ds_read_b64_tr_b16 v[80:81], v9 offset:8192
    ds_read_b64_tr_b16 v[82:83], v9 offset:8704
    buffer_load_dwordx4 v5, s[8:11], s69 offen offset:1024 lds
    v_mfma_f32_32x32x16_bf16 v[144:159], v[88:91], v[100:103], v[144:159]
    ds_read_b64_tr_b16 v[84:85], v12 offset:8192
    ds_read_b64_tr_b16 v[86:87], v12 offset:8704
    v_rcp_f32 v251, v251
    v_mul_f32 v252, v252, v248
    v_mfma_f32_32x32x16_bf16 v[160:175], v[92:95], v[96:99], v[160:175]
    v_mul_f32 v253, v253, v249
    v_mul_f32 v254, v254, v250
    v_mul_f32 v255, v255, v251
    v_cvt_pk_bf16_f32 v70, v252, v253
    v_cvt_pk_bf16_f32 v71, v254, v255
    v_mfma_f32_32x32x16_bf16 v[176:191], v[92:95], v[100:103], v[176:191]
    ds_write_b128 v14, v[68:71] offset:21504
    s_waitcnt lgkmcnt(5)
    v_mfma_f32_32x32x16_bf16 v[128:143], v[72:75], v[104:107], v[128:143]
    ds_read_b64_tr_b16 v[88:89], v9 offset:12288
    ds_read_b64_tr_b16 v[90:91], v9 offset:12800
    buffer_load_dwordx4 v6, s[12:15], s69 offen offset:2048 lds
    v_mfma_f32_32x32x16_bf16 v[144:159], v[72:75], v[108:111], v[144:159]
    ds_read_b64_tr_b16 v[92:93], v12 offset:12288
    ds_read_b64_tr_b16 v[94:95], v12 offset:12800
    v_mfma_f32_32x32x16_bf16 v[160:175], v[76:79], v[104:107], v[160:175]
    v_mfma_f32_32x32x16_bf16 v[176:191], v[76:79], v[108:111], v[176:191]
    s_waitcnt lgkmcnt(5)
    v_mfma_f32_32x32x16_bf16 v[128:143], v[80:83], v[112:115], v[128:143]
    s_waitcnt vmcnt(15)
    s_waitcnt lgkmcnt(0)
    s_barrier
    v_mfma_f32_32x32x16_bf16 v[144:159], v[80:83], v[116:119], v[144:159]
    ds_read_b64_tr_b16 v[72:73], v10 offset:8192
    ds_read_b64_tr_b16 v[74:75], v10 offset:8704
    buffer_load_dwordx4 v7, s[12:15], s69 offen offset:3072 lds
    v_mfma_f32_32x32x16_bf16 v[160:175], v[84:87], v[112:115], v[160:175]
    ds_read_b64_tr_b16 v[76:77], v13 offset:8192
    ds_read_b64_tr_b16 v[78:79], v13 offset:8704
    v_mfma_f32_32x32x16_bf16 v[176:191], v[84:87], v[116:119], v[176:191]
    v_mfma_f32_32x32x16_bf16 v[128:143], v[88:91], v[120:123], v[128:143]
    ds_read_b64_tr_b16 v[80:81], v10 offset:12288
    ds_read_b64_tr_b16 v[82:83], v10 offset:12800
    v_mfma_f32_32x32x16_bf16 v[144:159], v[88:91], v[124:127], v[144:159]
    ds_read_b64_tr_b16 v[84:85], v13 offset:12288
    ds_read_b64_tr_b16 v[86:87], v13 offset:12800
    s_add_u32 m0, s30, 65536
    s_nop 0
    buffer_load_dwordx4 v4, s[8:11], s70 offen lds
    v_mfma_f32_32x32x16_bf16 v[160:175], v[92:95], v[120:123], v[160:175]
    v_mfma_f32_32x32x16_bf16 v[176:191], v[92:95], v[124:127], v[176:191]
    s_waitcnt lgkmcnt(4)
    v_mfma_f32_32x32x16_bf16 v[192:207], v[72:75], a[0:3], 0
    ds_read_b64_tr_b16 v[88:89], v10 offset:16384
    ds_read_b64_tr_b16 v[90:91], v10 offset:16896
    v_mul_f32 v56, v128, v128
    v_mul_f32 v57, v129, v129
    v_mul_f32 v58, v130, v130
    v_mfma_f32_32x32x16_bf16 v[208:223], v[72:75], a[4:7], 0
    ds_read_b64_tr_b16 v[92:93], v13 offset:16384
    ds_read_b64_tr_b16 v[94:95], v13 offset:16896
    buffer_load_dwordx4 v5, s[8:11], s70 offen offset:1024 lds
    v_mul_f32 v59, v131, v131
    v_mfma_f32_32x32x16_bf16 v[224:239], v[76:79], a[0:3], 0
    v_mul_f32 v132, v128, v132
    v_mul_f32 v133, v129, v133
    v_mul_f32 v134, v130, v134
    v_mul_f32 v135, v131, v135
    v_fma_f32 v56, v56, s27, v15
    v_mfma_f32_32x32x16_bf16 v[240:255], v[76:79], a[4:7], 0
    v_fma_f32 v57, v57, s27, v15
    v_fma_f32 v58, v58, s27, v15
    s_waitcnt lgkmcnt(4)
    v_mfma_f32_32x32x16_bf16 v[192:207], v[80:83], a[8:11], v[192:207]
    ds_read_b64_tr_b16 v[72:73], v10 offset:20480
    ds_read_b64_tr_b16 v[74:75], v10 offset:20992
    v_fma_f32 v59, v59, s27, v15
    v_mul_f32 v128, v56, v128
    v_mul_f32 v129, v57, v129
    v_mfma_f32_32x32x16_bf16 v[208:223], v[80:83], a[12:15], v[208:223]
    ds_read_b64_tr_b16 v[76:77], v13 offset:20480
    ds_read_b64_tr_b16 v[78:79], v13 offset:20992
    buffer_load_dwordx4 v6, s[12:15], s70 offen offset:2048 lds
    v_mul_f32 v130, v58, v130
    v_mfma_f32_32x32x16_bf16 v[224:239], v[84:87], a[8:11], v[224:239]
    v_mul_f32 v131, v59, v131
    v_exp_f32 v128, v128
    v_exp_f32 v129, v129
    v_mfma_f32_32x32x16_bf16 v[240:255], v[84:87], a[12:15], v[240:255]
    v_exp_f32 v130, v130
    s_waitcnt lgkmcnt(4)
    v_mfma_f32_32x32x16_bf16 v[192:207], v[88:91], a[16:19], v[192:207]
    s_waitcnt vmcnt(15)
    s_waitcnt lgkmcnt(0)
    s_barrier
    v_mfma_f32_32x32x16_bf16 v[208:223], v[88:91], a[20:23], v[208:223]
    ds_read_b64_tr_b16 v[80:81], v8 offset:0
    ds_read_b64_tr_b16 v[82:83], v8 offset:512
    v_exp_f32 v131, v131
    v_add_f32 v128, 1.0, v128
    v_mfma_f32_32x32x16_bf16 v[224:239], v[92:95], a[16:19], v[224:239]
    ds_read_b64_tr_b16 v[84:85], v11 offset:0
    ds_read_b64_tr_b16 v[86:87], v11 offset:512
    buffer_load_dwordx4 v7, s[12:15], s70 offen offset:3072 lds
    v_add_f32 v129, 1.0, v129
    v_mfma_f32_32x32x16_bf16 v[240:255], v[92:95], a[20:23], v[240:255]
    v_add_f32 v130, 1.0, v130
    v_add_f32 v131, 1.0, v131
    v_rcp_f32 v128, v128
    v_rcp_f32 v129, v129
    v_rcp_f32 v130, v130
    v_mfma_f32_32x32x16_bf16 v[192:207], v[72:75], a[24:27], v[192:207]
    ds_read_b64_tr_b16 v[88:89], v8 offset:4096
    ds_read_b64_tr_b16 v[90:91], v8 offset:4608
    v_rcp_f32 v131, v131
    v_mul_f32 v132, v132, v128
    v_mfma_f32_32x32x16_bf16 v[208:223], v[72:75], a[28:31], v[208:223]
    ds_read_b64_tr_b16 v[92:93], v11 offset:4096
    ds_read_b64_tr_b16 v[94:95], v11 offset:4608
    v_mul_f32 v133, v133, v129
    v_mul_f32 v134, v134, v130
    v_mul_f32 v135, v135, v131
    v_mfma_f32_32x32x16_bf16 v[224:239], v[76:79], a[24:27], v[224:239]
    s_add_u32 m0, s30, 139264
    s_nop 0
    buffer_load_dwordx4 v4, s[8:11], s71 offen lds
    v_cvt_pk_bf16_f32 v64, v132, v133
    v_cvt_pk_bf16_f32 v65, v134, v135
    v_mfma_f32_32x32x16_bf16 v[240:255], v[76:79], a[28:31], v[240:255]
    v_mul_f32 v60, v136, v136
    v_mul_f32 v61, v137, v137
    v_mul_f32 v62, v138, v138
    s_waitcnt lgkmcnt(4)
    v_mfma_f32_32x32x16_bf16 v[192:207], v[80:83], a[32:35], v[192:207]
    ds_read_b64_tr_b16 v[72:73], v8 offset:8192
    ds_read_b64_tr_b16 v[74:75], v8 offset:8704
    v_mul_f32 v63, v139, v139
    v_mul_f32 v140, v136, v140
    v_mul_f32 v141, v137, v141
    v_mfma_f32_32x32x16_bf16 v[208:223], v[80:83], a[36:39], v[208:223]
    ds_read_b64_tr_b16 v[76:77], v11 offset:8192
    ds_read_b64_tr_b16 v[78:79], v11 offset:8704
    v_mul_f32 v142, v138, v142
    v_mul_f32 v143, v139, v143
    v_fma_f32 v60, v60, s27, v15
    v_mfma_f32_32x32x16_bf16 v[224:239], v[84:87], a[32:35], v[224:239]
    buffer_load_dwordx4 v5, s[8:11], s71 offen offset:1024 lds
    v_fma_f32 v61, v61, s27, v15
    v_fma_f32 v62, v62, s27, v15
    v_fma_f32 v63, v63, s27, v15
    v_mfma_f32_32x32x16_bf16 v[240:255], v[84:87], a[36:39], v[240:255]
    v_mul_f32 v136, v60, v136
    v_mul_f32 v137, v61, v137
    s_waitcnt lgkmcnt(4)
    v_mfma_f32_32x32x16_bf16 v[192:207], v[88:91], a[40:43], v[192:207]
    ds_read_b64_tr_b16 v[80:81], v8 offset:12288
    ds_read_b64_tr_b16 v[82:83], v8 offset:12800
    v_mul_f32 v138, v62, v138
    v_mul_f32 v139, v63, v139
    v_mfma_f32_32x32x16_bf16 v[208:223], v[88:91], a[44:47], v[208:223]
    ds_read_b64_tr_b16 v[84:85], v11 offset:12288
    ds_read_b64_tr_b16 v[86:87], v11 offset:12800
    v_exp_f32 v136, v136
    v_mfma_f32_32x32x16_bf16 v[224:239], v[92:95], a[40:43], v[224:239]
    buffer_load_dwordx4 v6, s[12:15], s71 offen offset:2048 lds
    v_exp_f32 v137, v137
    v_mfma_f32_32x32x16_bf16 v[240:255], v[92:95], a[44:47], v[240:255]
    v_exp_f32 v138, v138
    v_exp_f32 v139, v139
    v_add_f32 v136, 1.0, v136
    s_waitcnt lgkmcnt(4)
    v_mfma_f32_32x32x16_bf16 v[192:207], v[72:75], a[48:51], v[192:207]
    s_waitcnt vmcnt(15)
    s_waitcnt lgkmcnt(0)
    s_barrier
    v_mfma_f32_32x32x16_bf16 v[208:223], v[72:75], a[52:55], v[208:223]
    ds_read_b64_tr_b16 v[88:89], v8 offset:16384
    ds_read_b64_tr_b16 v[90:91], v8 offset:16896
    v_add_f32 v137, 1.0, v137
    v_add_f32 v138, 1.0, v138
    v_add_f32 v139, 1.0, v139
    v_mfma_f32_32x32x16_bf16 v[224:239], v[76:79], a[48:51], v[224:239]
    ds_read_b64_tr_b16 v[92:93], v11 offset:16384
    ds_read_b64_tr_b16 v[94:95], v11 offset:16896
    v_rcp_f32 v136, v136
    v_mfma_f32_32x32x16_bf16 v[240:255], v[76:79], a[52:55], v[240:255]
    buffer_load_dwordx4 v7, s[12:15], s71 offen offset:3072 lds
    v_rcp_f32 v137, v137
    v_rcp_f32 v138, v138
    v_rcp_f32 v139, v139
    v_mfma_f32_32x32x16_bf16 v[192:207], v[80:83], a[56:59], v[192:207]
    ds_read_b64_tr_b16 v[72:73], v8 offset:20480
    ds_read_b64_tr_b16 v[74:75], v8 offset:20992
    v_mul_f32 v140, v140, v136
    v_mul_f32 v141, v141, v137
    v_mul_f32 v142, v142, v138
    v_mfma_f32_32x32x16_bf16 v[208:223], v[80:83], a[60:63], v[208:223]
    ds_read_b64_tr_b16 v[76:77], v11 offset:20480
    ds_read_b64_tr_b16 v[78:79], v11 offset:20992
    v_mul_f32 v143, v143, v139
    v_cvt_pk_bf16_f32 v66, v140, v141
    v_cvt_pk_bf16_f32 v67, v142, v143
    v_mfma_f32_32x32x16_bf16 v[224:239], v[84:87], a[56:59], v[224:239]
    ds_write_b128 v14, v[64:67] offset:32768
    v_mul_f32 v56, v144, v144
    v_mul_f32 v57, v145, v145
    v_mul_f32 v58, v146, v146
    v_mfma_f32_32x32x16_bf16 v[240:255], v[84:87], a[60:63], v[240:255]
    s_add_u32 m0, s30, 0
    s_nop 0
    buffer_load_dwordx4 v4, s[8:11], s72 offen lds
    s_waitcnt lgkmcnt(5)
    v_mfma_f32_32x32x16_bf16 v[192:207], v[88:91], a[64:67], v[192:207]
    ds_read_b64_tr_b16 v[80:81], v8 offset:24576
    ds_read_b64_tr_b16 v[82:83], v8 offset:25088
    v_mul_f32 v59, v147, v147
    v_mul_f32 v148, v144, v148
    v_mul_f32 v149, v145, v149
    v_mfma_f32_32x32x16_bf16 v[208:223], v[88:91], a[68:71], v[208:223]
    ds_read_b64_tr_b16 v[84:85], v11 offset:24576
    ds_read_b64_tr_b16 v[86:87], v11 offset:25088
    v_mul_f32 v150, v146, v150
    v_mul_f32 v151, v147, v151
    v_fma_f32 v56, v56, s27, v15
    v_mfma_f32_32x32x16_bf16 v[224:239], v[92:95], a[64:67], v[224:239]
    v_fma_f32 v57, v57, s27, v15
    v_fma_f32 v58, v58, s27, v15
    v_fma_f32 v59, v59, s27, v15
    v_mul_f32 v144, v56, v144
    v_mul_f32 v145, v57, v145
    v_mfma_f32_32x32x16_bf16 v[240:255], v[92:95], a[68:71], v[240:255]
    buffer_load_dwordx4 v5, s[8:11], s72 offen offset:1024 lds
    s_waitcnt lgkmcnt(5)
    v_mfma_f32_32x32x16_bf16 v[192:207], v[72:75], a[72:75], v[192:207]
    ds_read_b64_tr_b16 v[88:89], v8 offset:28672
    ds_read_b64_tr_b16 v[90:91], v8 offset:29184
    v_mul_f32 v146, v58, v146
    v_mul_f32 v147, v59, v147
    v_mfma_f32_32x32x16_bf16 v[208:223], v[72:75], a[76:79], v[208:223]
    ds_read_b64_tr_b16 v[92:93], v11 offset:28672
    ds_read_b64_tr_b16 v[94:95], v11 offset:29184
    v_exp_f32 v144, v144
    v_mfma_f32_32x32x16_bf16 v[224:239], v[76:79], a[72:75], v[224:239]
    v_exp_f32 v145, v145
    v_exp_f32 v146, v146
    v_mfma_f32_32x32x16_bf16 v[240:255], v[76:79], a[76:79], v[240:255]
    buffer_load_dwordx4 v6, s[12:15], s72 offen offset:2048 lds
    v_exp_f32 v147, v147
    v_add_f32 v144, 1.0, v144
    s_waitcnt lgkmcnt(4)
    v_mfma_f32_32x32x16_bf16 v[192:207], v[80:83], a[80:83], v[192:207]
    s_waitcnt vmcnt(15)
    s_waitcnt lgkmcnt(0)
    s_barrier
    v_mfma_f32_32x32x16_bf16 v[208:223], v[80:83], a[84:87], v[208:223]
    ds_read_b64_tr_b16 v[72:73], v8 offset:32768
    ds_read_b64_tr_b16 v[74:75], v8 offset:33280
    v_add_f32 v145, 1.0, v145
    v_add_f32 v146, 1.0, v146
    v_add_f32 v147, 1.0, v147
    v_mfma_f32_32x32x16_bf16 v[224:239], v[84:87], a[80:83], v[224:239]
    ds_read_b64_tr_b16 v[76:77], v11 offset:32768
    ds_read_b64_tr_b16 v[78:79], v11 offset:33280
    v_rcp_f32 v144, v144
    v_mfma_f32_32x32x16_bf16 v[240:255], v[84:87], a[84:87], v[240:255]
    v_rcp_f32 v145, v145
    v_rcp_f32 v146, v146
    v_rcp_f32 v147, v147
    v_mfma_f32_32x32x16_bf16 v[192:207], v[88:91], a[88:91], v[192:207]
    ds_read_b64_tr_b16 v[80:81], v8 offset:36864
    ds_read_b64_tr_b16 v[82:83], v8 offset:37376
    buffer_load_dwordx4 v7, s[12:15], s72 offen offset:3072 lds
    v_mul_f32 v148, v148, v144
    v_mfma_f32_32x32x16_bf16 v[208:223], v[88:91], a[92:95], v[208:223]
    ds_read_b64_tr_b16 v[84:85], v11 offset:36864
    ds_read_b64_tr_b16 v[86:87], v11 offset:37376
    v_mul_f32 v149, v149, v145
    v_mul_f32 v150, v150, v146
    v_mul_f32 v151, v151, v147
    v_mfma_f32_32x32x16_bf16 v[224:239], v[92:95], a[88:91], v[224:239]
    v_cvt_pk_bf16_f32 v68, v148, v149
    v_cvt_pk_bf16_f32 v69, v150, v151
    v_mul_f32 v60, v152, v152
    v_mul_f32 v61, v153, v153
    v_mul_f32 v62, v154, v154
    v_mfma_f32_32x32x16_bf16 v[240:255], v[92:95], a[92:95], v[240:255]
    v_mul_f32 v63, v155, v155
    v_mul_f32 v156, v152, v156
    s_waitcnt lgkmcnt(4)
    v_mfma_f32_32x32x16_bf16 v[192:207], v[72:75], a[96:99], v[192:207]
    ds_read_b64_tr_b16 v[88:89], v8 offset:40960
    ds_read_b64_tr_b16 v[90:91], v8 offset:41472
    s_add_u32 m0, s30, 16384
    s_nop 0
    buffer_load_dwordx4 v4, s[8:11], s73 offen lds
    v_mfma_f32_32x32x16_bf16 v[208:223], v[72:75], a[100:103], v[208:223]
    ds_read_b64_tr_b16 v[92:93], v11 offset:40960
    ds_read_b64_tr_b16 v[94:95], v11 offset:41472
    v_mul_f32 v157, v153, v157
    v_mul_f32 v158, v154, v158
    v_mul_f32 v159, v155, v159
    v_mfma_f32_32x32x16_bf16 v[224:239], v[76:79], a[96:99], v[224:239]
    v_fma_f32 v60, v60, s27, v15
    v_fma_f32 v61, v61, s27, v15
    v_fma_f32 v62, v62, s27, v15
    v_fma_f32 v63, v63, s27, v15
    v_mul_f32 v152, v60, v152
    v_mfma_f32_32x32x16_bf16 v[240:255], v[76:79], a[100:103], v[240:255]
    v_mul_f32 v153, v61, v153
    v_mul_f32 v154, v62, v154
    v_mul_f32 v155, v63, v155
    s_waitcnt lgkmcnt(4)
    v_mfma_f32_32x32x16_bf16 v[192:207], v[80:83], a[104:107], v[192:207]
    ds_read_b64_tr_b16 v[72:73], v8 offset:45056
    ds_read_b64_tr_b16 v[74:75], v8 offset:45568
    buffer_load_dwordx4 v5, s[8:11], s73 offen offset:1024 lds
    v_mfma_f32_32x32x16_bf16 v[208:223], v[80:83], a[108:111], v[208:223]
    ds_read_b64_tr_b16 v[76:77], v11 offset:45056
    ds_read_b64_tr_b16 v[78:79], v11 offset:45568
    v_exp_f32 v152, v152
    v_mfma_f32_32x32x16_bf16 v[224:239], v[84:87], a[104:107], v[224:239]
    v_exp_f32 v153, v153
    v_exp_f32 v154, v154
    v_mfma_f32_32x32x16_bf16 v[240:255], v[84:87], a[108:111], v[240:255]
    v_exp_f32 v155, v155
    v_add_f32 v152, 1.0, v152
    v_add_f32 v153, 1.0, v153
    s_waitcnt lgkmcnt(4)
    v_mfma_f32_32x32x16_bf16 v[192:207], v[88:91], a[112:115], v[192:207]
    s_waitcnt vmcnt(14)
    s_waitcnt lgkmcnt(0)
    s_barrier
    v_mfma_f32_32x32x16_bf16 v[208:223], v[88:91], a[116:119], v[208:223]
    ds_read_b64_tr_b16 v[80:81], v8 offset:49152
    ds_read_b64_tr_b16 v[82:83], v8 offset:49664
    buffer_load_dwordx4 v6, s[12:15], s73 offen offset:2048 lds
    v_add_f32 v154, 1.0, v154
    v_mfma_f32_32x32x16_bf16 v[224:239], v[92:95], a[112:115], v[224:239]
    ds_read_b64_tr_b16 v[84:85], v11 offset:49152
    ds_read_b64_tr_b16 v[86:87], v11 offset:49664
    v_add_f32 v155, 1.0, v155
    v_rcp_f32 v152, v152
    v_mfma_f32_32x32x16_bf16 v[240:255], v[92:95], a[116:119], v[240:255]
    v_rcp_f32 v153, v153
    v_rcp_f32 v154, v154
    v_rcp_f32 v155, v155
    v_mfma_f32_32x32x16_bf16 v[192:207], v[72:75], a[120:123], v[192:207]
    ds_read_b64_tr_b16 v[88:89], v8 offset:53248
    ds_read_b64_tr_b16 v[90:91], v8 offset:53760
    v_mul_f32 v156, v156, v152
    v_mul_f32 v157, v157, v153
    v_mul_f32 v158, v158, v154
    v_mfma_f32_32x32x16_bf16 v[208:223], v[72:75], a[124:127], v[208:223]
    ds_read_b64_tr_b16 v[92:93], v11 offset:53248
    ds_read_b64_tr_b16 v[94:95], v11 offset:53760
    buffer_load_dwordx4 v7, s[12:15], s73 offen offset:3072 lds
    v_mul_f32 v159, v159, v155
    v_mfma_f32_32x32x16_bf16 v[224:239], v[76:79], a[120:123], v[224:239]
    v_cvt_pk_bf16_f32 v70, v156, v157
    v_cvt_pk_bf16_f32 v71, v158, v159
    ds_write_b128 v14, v[68:71] offset:33792
    v_mul_f32 v56, v160, v160
    v_mfma_f32_32x32x16_bf16 v[240:255], v[76:79], a[124:127], v[240:255]
    v_mul_f32 v57, v161, v161
    s_waitcnt lgkmcnt(5)
    v_mfma_f32_32x32x16_bf16 v[192:207], v[80:83], a[128:131], v[192:207]
    ds_read_b64_tr_b16 v[72:73], v8 offset:57344
    ds_read_b64_tr_b16 v[74:75], v8 offset:57856
    v_mul_f32 v58, v162, v162
    v_mul_f32 v59, v163, v163
    v_mul_f32 v164, v160, v164
    v_mfma_f32_32x32x16_bf16 v[208:223], v[80:83], a[132:135], v[208:223]
    ds_read_b64_tr_b16 v[76:77], v11 offset:57344
    ds_read_b64_tr_b16 v[78:79], v11 offset:57856
    s_add_u32 s8, s36, s53
    s_addc_u32 s9, s37, 0
    s_and_b32 s9, s9, 0xffff
    s_add_u32 s12, s38, s53
    s_addc_u32 s13, s39, 0
    s_and_b32 s13, s13, 0xffff
    s_add_u32 m0, s31, 32768
    s_nop 0
    buffer_load_dwordx4 v16, s[8:11], s65 offen lds
    v_mfma_f32_32x32x16_bf16 v[224:239], v[84:87], a[128:131], v[224:239]
    v_mul_f32 v165, v161, v165
    v_mul_f32 v166, v162, v166
    v_mul_f32 v167, v163, v167
    v_fma_f32 v56, v56, s27, v15
    v_fma_f32 v57, v57, s27, v15
    v_mfma_f32_32x32x16_bf16 v[240:255], v[84:87], a[132:135], v[240:255]
    v_fma_f32 v58, v58, s27, v15
    v_fma_f32 v59, v59, s27, v15
    s_waitcnt lgkmcnt(5)
    v_mfma_f32_32x32x16_bf16 v[192:207], v[88:91], a[136:139], v[192:207]
    ds_read_b64_tr_b16 v[80:81], v8 offset:61440
    ds_read_b64_tr_b16 v[82:83], v8 offset:61952
    v_mul_f32 v160, v56, v160
    v_mul_f32 v161, v57, v161
    v_mul_f32 v162, v58, v162
    v_mfma_f32_32x32x16_bf16 v[208:223], v[88:91], a[140:143], v[208:223]
    ds_read_b64_tr_b16 v[84:85], v11 offset:61440
    ds_read_b64_tr_b16 v[86:87], v11 offset:61952
    buffer_load_dwordx4 v17, s[12:15], s65 offen offset:1024 lds
    v_mul_f32 v163, v59, v163
    v_mfma_f32_32x32x16_bf16 v[224:239], v[92:95], a[136:139], v[224:239]
    v_exp_f32 v160, v160
    v_exp_f32 v161, v161
    v_mfma_f32_32x32x16_bf16 v[240:255], v[92:95], a[140:143], v[240:255]
    v_exp_f32 v162, v162
    s_waitcnt lgkmcnt(4)
    v_mfma_f32_32x32x16_bf16 v[192:207], v[72:75], a[144:147], v[192:207]
    s_waitcnt vmcnt(14)
    s_waitcnt lgkmcnt(0)
    s_barrier
    v_mfma_f32_32x32x16_bf16 v[208:223], v[72:75], a[148:151], v[208:223]
    ds_read_b64_tr_b16 v[88:89], v9 offset:0
    ds_read_b64_tr_b16 v[90:91], v9 offset:512
    v_exp_f32 v163, v163
    v_add_f32 v160, 1.0, v160
    v_mfma_f32_32x32x16_bf16 v[224:239], v[76:79], a[144:147], v[224:239]
    ds_read_b64_tr_b16 v[92:93], v12 offset:0
    ds_read_b64_tr_b16 v[94:95], v12 offset:512
    s_add_u32 m0, s31, 40960
    s_nop 0
    buffer_load_dwordx4 v16, s[8:11], s66 offen lds
    v_mfma_f32_32x32x16_bf16 v[240:255], v[76:79], a[148:151], v[240:255]
    v_add_f32 v161, 1.0, v161
    v_add_f32 v162, 1.0, v162
    v_add_f32 v163, 1.0, v163
    v_rcp_f32 v160, v160
    v_rcp_f32 v161, v161
    v_mfma_f32_32x32x16_bf16 v[192:207], v[80:83], a[152:155], v[192:207]
    ds_read_b64_tr_b16 v[72:73], v9 offset:4096
    ds_read_b64_tr_b16 v[74:75], v9 offset:4608
    v_rcp_f32 v162, v162
    v_mfma_f32_32x32x16_bf16 v[208:223], v[80:83], a[156:159], v[208:223]
    ds_read_b64_tr_b16 v[76:77], v12 offset:4096
    ds_read_b64_tr_b16 v[78:79], v12 offset:4608
    v_rcp_f32 v163, v163
    v_mul_f32 v164, v164, v160
    v_mfma_f32_32x32x16_bf16 v[224:239], v[84:87], a[152:155], v[224:239]
    buffer_load_dwordx4 v17, s[12:15], s66 offen offset:1024 lds
    v_mul_f32 v165, v165, v161
    v_mul_f32 v166, v166, v162
    v_mul_f32 v167, v167, v163
    v_mfma_f32_32x32x16_bf16 v[240:255], v[84:87], a[156:159], v[240:255]
    v_cvt_pk_bf16_f32 v64, v164, v165
    v_cvt_pk_bf16_f32 v65, v166, v167
    s_waitcnt lgkmcnt(4)
    v_mfma_f32_32x32x16_bf16 v[192:207], v[88:91], a[160:163], v[192:207]
    ds_read_b64_tr_b16 v[80:81], v9 offset:8192
    ds_read_b64_tr_b16 v[82:83], v9 offset:8704
    v_mul_f32 v60, v168, v168
    v_mul_f32 v61, v169, v169
    v_mul_f32 v62, v170, v170
    v_mfma_f32_32x32x16_bf16 v[208:223], v[88:91], a[164:167], v[208:223]
    ds_read_b64_tr_b16 v[84:85], v12 offset:8192
    ds_read_b64_tr_b16 v[86:87], v12 offset:8704
    v_mul_f32 v63, v171, v171
    v_mul_f32 v172, v168, v172
    v_mul_f32 v173, v169, v173
    v_mfma_f32_32x32x16_bf16 v[224:239], v[92:95], a[160:163], v[224:239]
    s_add_u32 m0, s31, 49152
    s_nop 0
    buffer_load_dwordx4 v16, s[8:11], s67 offen lds
    v_mul_f32 v174, v170, v174
    v_mul_f32 v175, v171, v175
    v_mfma_f32_32x32x16_bf16 v[240:255], v[92:95], a[164:167], v[240:255]
    v_fma_f32 v60, v60, s27, v15
    v_fma_f32 v61, v61, s27, v15
    s_waitcnt lgkmcnt(4)
    v_mfma_f32_32x32x16_bf16 v[192:207], v[72:75], a[168:171], v[192:207]
    ds_read_b64_tr_b16 v[88:89], v9 offset:12288
    ds_read_b64_tr_b16 v[90:91], v9 offset:12800
    v_fma_f32 v62, v62, s27, v15
    v_fma_f32 v63, v63, s27, v15
    v_mul_f32 v168, v60, v168
    v_mfma_f32_32x32x16_bf16 v[208:223], v[72:75], a[172:175], v[208:223]
    ds_read_b64_tr_b16 v[92:93], v12 offset:12288
    ds_read_b64_tr_b16 v[94:95], v12 offset:12800
    v_mul_f32 v169, v61, v169
    v_mul_f32 v170, v62, v170
    v_mul_f32 v171, v63, v171
    v_mfma_f32_32x32x16_bf16 v[224:239], v[76:79], a[168:171], v[224:239]
    buffer_load_dwordx4 v17, s[12:15], s67 offen offset:1024 lds
    v_exp_f32 v168, v168
    v_mfma_f32_32x32x16_bf16 v[240:255], v[76:79], a[172:175], v[240:255]
    v_exp_f32 v169, v169
    s_waitcnt lgkmcnt(4)
    v_mfma_f32_32x32x16_bf16 v[192:207], v[80:83], a[176:179], v[192:207]
    s_waitcnt vmcnt(14)
    s_waitcnt lgkmcnt(0)
    s_barrier
    v_mfma_f32_32x32x16_bf16 v[208:223], v[80:83], a[180:183], v[208:223]
    ds_read_b64_tr_b16 v[72:73], v10 offset:8192
    ds_read_b64_tr_b16 v[74:75], v10 offset:8704
    v_exp_f32 v170, v170
    v_mfma_f32_32x32x16_bf16 v[224:239], v[84:87], a[176:179], v[224:239]
    ds_read_b64_tr_b16 v[76:77], v13 offset:8192
    ds_read_b64_tr_b16 v[78:79], v13 offset:8704
    v_exp_f32 v171, v171
    v_add_f32 v168, 1.0, v168
    v_mfma_f32_32x32x16_bf16 v[240:255], v[84:87], a[180:183], v[240:255]
    s_add_u32 m0, s31, 57344
    s_nop 0
    buffer_load_dwordx4 v16, s[8:11], s68 offen lds
    v_add_f32 v169, 1.0, v169
    v_add_f32 v170, 1.0, v170
    v_add_f32 v171, 1.0, v171
    v_rcp_f32 v168, v168
    v_mfma_f32_32x32x16_bf16 v[192:207], v[88:91], a[184:187], v[192:207]
    ds_read_b64_tr_b16 v[80:81], v10 offset:12288
    ds_read_b64_tr_b16 v[82:83], v10 offset:12800
    v_rcp_f32 v169, v169
    v_mfma_f32_32x32x16_bf16 v[208:223], v[88:91], a[188:191], v[208:223]
    ds_read_b64_tr_b16 v[84:85], v13 offset:12288
    ds_read_b64_tr_b16 v[86:87], v13 offset:12800
    v_rcp_f32 v170, v170
    v_mfma_f32_32x32x16_bf16 v[224:239], v[92:95], a[184:187], v[224:239]
    v_rcp_f32 v171, v171
    v_mul_f32 v172, v172, v168
    v_mul_f32 v173, v173, v169
    v_mul_f32 v174, v174, v170
    v_mfma_f32_32x32x16_bf16 v[240:255], v[92:95], a[188:191], v[240:255]
    buffer_load_dwordx4 v17, s[12:15], s68 offen offset:1024 lds
    v_mul_f32 v175, v175, v171
    s_waitcnt lgkmcnt(4)
    v_mfma_f32_32x32x16_bf16 v[192:207], v[72:75], a[192:195], v[192:207]
    ds_read_b64_tr_b16 v[88:89], v10 offset:16384
    ds_read_b64_tr_b16 v[90:91], v10 offset:16896
    v_cvt_pk_bf16_f32 v66, v172, v173
    v_cvt_pk_bf16_f32 v67, v174, v175
    v_mfma_f32_32x32x16_bf16 v[208:223], v[72:75], a[196:199], v[208:223]
    ds_read_b64_tr_b16 v[92:93], v13 offset:16384
    ds_read_b64_tr_b16 v[94:95], v13 offset:16896
    ds_write_b128 v14, v[64:67] offset:36864
    v_mul_f32 v56, v176, v176
    v_mfma_f32_32x32x16_bf16 v[224:239], v[76:79], a[192:195], v[224:239]
    v_mul_f32 v57, v177, v177
    v_mul_f32 v58, v178, v178
    v_mul_f32 v59, v179, v179
    v_mul_f32 v180, v176, v180
    v_mul_f32 v181, v177, v181
    v_mfma_f32_32x32x16_bf16 v[240:255], v[76:79], a[196:199], v[240:255]
    s_add_u32 m0, s31, 65536
    s_nop 0
    buffer_load_dwordx4 v16, s[8:11], s69 offen lds
    s_waitcnt lgkmcnt(5)
    v_mfma_f32_32x32x16_bf16 v[192:207], v[80:83], a[200:203], v[192:207]
    ds_read_b64_tr_b16 v[72:73], v10 offset:20480
    ds_read_b64_tr_b16 v[74:75], v10 offset:20992
    v_mul_f32 v182, v178, v182
    v_mul_f32 v183, v179, v183
    v_fma_f32 v56, v56, s27, v15
    v_mfma_f32_32x32x16_bf16 v[208:223], v[80:83], a[204:207], v[208:223]
    ds_read_b64_tr_b16 v[76:77], v13 offset:20480
    ds_read_b64_tr_b16 v[78:79], v13 offset:20992
    v_fma_f32 v57, v57, s27, v15
    v_fma_f32 v58, v58, s27, v15
    v_fma_f32 v59, v59, s27, v15
    v_mfma_f32_32x32x16_bf16 v[224:239], v[84:87], a[200:203], v[224:239]
    v_mul_f32 v176, v56, v176
    v_mul_f32 v177, v57, v177
    v_mul_f32 v178, v58, v178
    v_mul_f32 v179, v59, v179
    v_mfma_f32_32x32x16_bf16 v[240:255], v[84:87], a[204:207], v[240:255]
    buffer_load_dwordx4 v17, s[12:15], s69 offen offset:1024 lds
    s_waitcnt lgkmcnt(5)
    v_mfma_f32_32x32x16_bf16 v[192:207], v[88:91], a[208:211], v[192:207]
    s_waitcnt vmcnt(14)
    s_waitcnt lgkmcnt(0)
    s_barrier
    v_mfma_f32_32x32x16_bf16 v[208:223], v[88:91], a[212:215], v[208:223]
    ds_read_b64_tr_b16 v[80:81], v8 offset:0
    ds_read_b64_tr_b16 v[82:83], v8 offset:512
    v_exp_f32 v176, v176
    v_mfma_f32_32x32x16_bf16 v[224:239], v[92:95], a[208:211], v[224:239]
    ds_read_b64_tr_b16 v[84:85], v11 offset:0
    ds_read_b64_tr_b16 v[86:87], v11 offset:512
    v_exp_f32 v177, v177
    v_mfma_f32_32x32x16_bf16 v[240:255], v[92:95], a[212:215], v[240:255]
    v_exp_f32 v178, v178
    v_exp_f32 v179, v179
    v_add_f32 v176, 1.0, v176
    v_add_f32 v177, 1.0, v177
    v_mfma_f32_32x32x16_bf16 v[192:207], v[72:75], a[216:219], v[192:207]
    ds_read_b64_tr_b16 v[88:89], v8 offset:4096
    ds_read_b64_tr_b16 v[90:91], v8 offset:4608
    s_add_u32 m0, s31, 73728
    s_nop 0
    buffer_load_dwordx4 v16, s[8:11], s70 offen lds
    v_mfma_f32_32x32x16_bf16 v[208:223], v[72:75], a[220:223], v[208:223]
    ds_read_b64_tr_b16 v[92:93], v11 offset:4096
    ds_read_b64_tr_b16 v[94:95], v11 offset:4608
    v_add_f32 v178, 1.0, v178
    v_add_f32 v179, 1.0, v179
    v_mfma_f32_32x32x16_bf16 v[224:239], v[76:79], a[216:219], v[224:239]
    v_rcp_f32 v176, v176
    v_rcp_f32 v177, v177
    v_mfma_f32_32x32x16_bf16 v[240:255], v[76:79], a[220:223], v[240:255]
    v_rcp_f32 v178, v178
    v_rcp_f32 v179, v179
    s_waitcnt lgkmcnt(4)
    v_mfma_f32_32x32x16_bf16 v[192:207], v[80:83], a[224:227], v[192:207]
    ds_read_b64_tr_b16 v[72:73], v8 offset:8192
    ds_read_b64_tr_b16 v[74:75], v8 offset:8704
    buffer_load_dwordx4 v17, s[12:15], s70 offen offset:1024 lds
    v_mul_f32 v180, v180, v176
    v_mfma_f32_32x32x16_bf16 v[208:223], v[80:83], a[228:231], v[208:223]
    ds_read_b64_tr_b16 v[76:77], v11 offset:8192
    ds_read_b64_tr_b16 v[78:79], v11 offset:8704
    v_mul_f32 v181, v181, v177
    v_mul_f32 v182, v182, v178
    v_mul_f32 v183, v183, v179
    v_mfma_f32_32x32x16_bf16 v[224:239], v[84:87], a[224:227], v[224:239]
    v_cvt_pk_bf16_f32 v68, v180, v181
    v_cvt_pk_bf16_f32 v69, v182, v183
    v_mul_f32 v60, v184, v184
    v_mul_f32 v61, v185, v185
    v_mul_f32 v62, v186, v186
    v_mfma_f32_32x32x16_bf16 v[240:255], v[84:87], a[228:231], v[240:255]
    v_mul_f32 v63, v187, v187
    s_waitcnt lgkmcnt(4)
    v_mfma_f32_32x32x16_bf16 v[192:207], v[88:91], a[232:235], v[192:207]
    ds_read_b64_tr_b16 v[80:81], v8 offset:12288
    ds_read_b64_tr_b16 v[82:83], v8 offset:12800
    v_mul_f32 v188, v184, v188
    v_mul_f32 v189, v185, v189
    v_mul_f32 v190, v186, v190
    v_mfma_f32_32x32x16_bf16 v[208:223], v[88:91], a[236:239], v[208:223]
    ds_read_b64_tr_b16 v[84:85], v11 offset:12288
    ds_read_b64_tr_b16 v[86:87], v11 offset:12800
    v_mul_f32 v191, v187, v191
    v_fma_f32 v60, v60, s27, v15
    v_fma_f32 v61, v61, s27, v15
    v_mfma_f32_32x32x16_bf16 v[224:239], v[92:95], a[232:235], v[224:239]
    v_fma_f32 v62, v62, s27, v15
    v_fma_f32 v63, v63, s27, v15
    v_mul_f32 v184, v60, v184
    v_mul_f32 v185, v61, v185
    v_mfma_f32_32x32x16_bf16 v[240:255], v[92:95], a[236:239], v[240:255]
    s_waitcnt lgkmcnt(4)
    v_mfma_f32_32x32x16_bf16 v[192:207], v[72:75], a[240:243], v[192:207]
    s_waitcnt vmcnt(12)
    s_waitcnt lgkmcnt(0)
    s_barrier
    v_mfma_f32_32x32x16_bf16 v[208:223], v[72:75], a[244:247], v[208:223]
    ds_read_b64_tr_b16 v[88:89], v8 offset:16384
    ds_read_b64_tr_b16 v[90:91], v8 offset:16896
    s_add_u32 m0, s31, 0
    s_nop 0
    buffer_load_dwordx4 v16, s[8:11], s71 offen lds
    v_mfma_f32_32x32x16_bf16 v[224:239], v[76:79], a[240:243], v[224:239]
    ds_read_b64_tr_b16 v[92:93], v11 offset:16384
    ds_read_b64_tr_b16 v[94:95], v11 offset:16896
    v_mul_f32 v186, v62, v186
    v_mul_f32 v187, v63, v187
    v_mfma_f32_32x32x16_bf16 v[240:255], v[76:79], a[244:247], v[240:255]
    v_exp_f32 v184, v184
    v_exp_f32 v185, v185
    v_exp_f32 v186, v186
    v_exp_f32 v187, v187
    v_mfma_f32_32x32x16_bf16 v[192:207], v[80:83], a[248:251], v[192:207]
    ds_read_b64_tr_b16 v[72:73], v8 offset:20480
    ds_read_b64_tr_b16 v[74:75], v8 offset:20992
    buffer_load_dwordx4 v17, s[12:15], s71 offen offset:1024 lds
    v_add_f32 v184, 1.0, v184
    v_mfma_f32_32x32x16_bf16 v[208:223], v[80:83], a[252:255], v[208:223]
    ds_read_b64_tr_b16 v[76:77], v11 offset:20480
    ds_read_b64_tr_b16 v[78:79], v11 offset:20992
    v_add_f32 v185, 1.0, v185
    v_add_f32 v186, 1.0, v186
    v_add_f32 v187, 1.0, v187
    v_mfma_f32_32x32x16_bf16 v[224:239], v[84:87], a[248:251], v[224:239]
    v_rcp_f32 v184, v184
    v_rcp_f32 v185, v185
    v_mfma_f32_32x32x16_bf16 v[240:255], v[84:87], a[252:255], v[240:255]
    v_rcp_f32 v186, v186
    s_waitcnt lgkmcnt(4)
    v_mfma_f32_32x32x16_bf16 v[192:207], v[88:91], v[96:99], v[192:207]
    ds_read_b64_tr_b16 v[80:81], v8 offset:24576
    ds_read_b64_tr_b16 v[82:83], v8 offset:25088
    s_add_u32 m0, s31, 8192
    s_nop 0
    buffer_load_dwordx4 v16, s[8:11], s72 offen lds
    v_mfma_f32_32x32x16_bf16 v[208:223], v[88:91], v[100:103], v[208:223]
    ds_read_b64_tr_b16 v[84:85], v11 offset:24576
    ds_read_b64_tr_b16 v[86:87], v11 offset:25088
    v_rcp_f32 v187, v187
    v_mul_f32 v188, v188, v184
    v_mfma_f32_32x32x16_bf16 v[224:239], v[92:95], v[96:99], v[224:239]
    v_mul_f32 v189, v189, v185
    v_mul_f32 v190, v190, v186
    v_mul_f32 v191, v191, v187
    v_cvt_pk_bf16_f32 v70, v188, v189
    v_cvt_pk_bf16_f32 v71, v190, v191
    v_mfma_f32_32x32x16_bf16 v[240:255], v[92:95], v[100:103], v[240:255]
    ds_write_b128 v14, v[68:71] offset:37888
    s_waitcnt lgkmcnt(5)
    v_mfma_f32_32x32x16_bf16 v[192:207], v[72:75], v[104:107], v[192:207]
    ds_read_b64_tr_b16 v[88:89], v8 offset:28672
    ds_read_b64_tr_b16 v[90:91], v8 offset:29184
    buffer_load_dwordx4 v17, s[12:15], s72 offen offset:1024 lds
    v_mfma_f32_32x32x16_bf16 v[208:223], v[72:75], v[108:111], v[208:223]
    ds_read_b64_tr_b16 v[92:93], v11 offset:28672
    ds_read_b64_tr_b16 v[94:95], v11 offset:29184
    v_mfma_f32_32x32x16_bf16 v[224:239], v[76:79], v[104:107], v[224:239]
    v_mfma_f32_32x32x16_bf16 v[240:255], v[76:79], v[108:111], v[240:255]
    s_waitcnt lgkmcnt(5)
    v_mfma_f32_32x32x16_bf16 v[192:207], v[80:83], v[112:115], v[192:207]
    s_waitcnt vmcnt(12)
    s_waitcnt lgkmcnt(0)
    s_barrier
    v_mfma_f32_32x32x16_bf16 v[208:223], v[80:83], v[116:119], v[208:223]
    ds_read_b64_tr_b16 v[72:73], v18 offset:32768
    ds_read_b64_tr_b16 v[74:75], v18 offset:33024
    s_add_u32 m0, s31, 16384
    s_nop 0
    buffer_load_dwordx4 v16, s[8:11], s73 offen lds
    v_mfma_f32_32x32x16_bf16 v[224:239], v[84:87], v[112:115], v[224:239]
    v_mfma_f32_32x32x16_bf16 v[240:255], v[84:87], v[116:119], v[240:255]
    v_mfma_f32_32x32x16_bf16 v[192:207], v[88:91], v[120:123], v[192:207]
    ds_read_b64_tr_b16 v[80:81], v18 offset:34816
    ds_read_b64_tr_b16 v[82:83], v18 offset:35072
    v_mfma_f32_32x32x16_bf16 v[208:223], v[88:91], v[124:127], v[208:223]
    buffer_load_dwordx4 v17, s[12:15], s73 offen offset:1024 lds
    v_mfma_f32_32x32x16_bf16 v[224:239], v[92:95], v[120:123], v[224:239]
    v_mfma_f32_32x32x16_bf16 v[240:255], v[92:95], v[124:127], v[240:255]
    s_waitcnt lgkmcnt(2)
    v_mfma_f32_32x32x16_bf16 v[128:143], v[72:75], a[0:3], 0
    ds_read_b64_tr_b16 v[88:89], v18 offset:36864
    ds_read_b64_tr_b16 v[90:91], v18 offset:37120
    s_nop 1
    v_mul_f32 v56, v192, v192
    v_mul_f32 v57, v193, v193
    v_mul_f32 v58, v194, v194
    v_mfma_f32_32x32x16_bf16 v[144:159], v[72:75], a[4:7], 0
    v_mul_f32 v59, v195, v195
    v_mul_f32 v196, v192, v196
    v_mul_f32 v197, v193, v197
    v_mul_f32 v198, v194, v198
    v_mul_f32 v199, v195, v199
    v_fma_f32 v56, v56, s27, v15
    v_fma_f32 v57, v57, s27, v15
    v_fma_f32 v58, v58, s27, v15
    s_waitcnt lgkmcnt(2)
    v_mfma_f32_32x32x16_bf16 v[128:143], v[80:83], a[8:11], v[128:143]
    ds_read_b64_tr_b16 v[72:73], v18 offset:38912
    ds_read_b64_tr_b16 v[74:75], v18 offset:39168
    v_fma_f32 v59, v59, s27, v15
    v_mul_f32 v192, v56, v192
    v_mul_f32 v193, v57, v193
    v_mfma_f32_32x32x16_bf16 v[144:159], v[80:83], a[12:15], v[144:159]
    v_mul_f32 v194, v58, v194
    v_mul_f32 v195, v59, v195
    v_exp_f32 v192, v192
    v_exp_f32 v193, v193
    v_exp_f32 v194, v194
    s_waitcnt lgkmcnt(2)
    v_mfma_f32_32x32x16_bf16 v[128:143], v[88:91], a[16:19], v[128:143]
    ds_read_b64_tr_b16 v[80:81], v18 offset:40960
    ds_read_b64_tr_b16 v[82:83], v18 offset:41216
    v_exp_f32 v195, v195
    v_add_f32 v192, 1.0, v192
    v_mfma_f32_32x32x16_bf16 v[144:159], v[88:91], a[20:23], v[144:159]
    v_add_f32 v193, 1.0, v193
    v_add_f32 v194, 1.0, v194
    v_add_f32 v195, 1.0, v195
    v_rcp_f32 v192, v192
    v_rcp_f32 v193, v193
    v_rcp_f32 v194, v194
    s_waitcnt lgkmcnt(2)
    v_mfma_f32_32x32x16_bf16 v[128:143], v[72:75], a[24:27], v[128:143]
    ds_read_b64_tr_b16 v[88:89], v18 offset:43008
    ds_read_b64_tr_b16 v[90:91], v18 offset:43264
    v_rcp_f32 v195, v195
    v_mul_f32 v196, v196, v192
    v_mfma_f32_32x32x16_bf16 v[144:159], v[72:75], a[28:31], v[144:159]
    v_mul_f32 v197, v197, v193
    v_mul_f32 v198, v198, v194
    v_mul_f32 v199, v199, v195
    v_cvt_pk_bf16_f32 v64, v196, v197
    v_cvt_pk_bf16_f32 v65, v198, v199
    v_mul_f32 v60, v200, v200
    v_mul_f32 v61, v201, v201
    v_mul_f32 v62, v202, v202
    s_waitcnt lgkmcnt(2)
    v_mfma_f32_32x32x16_bf16 v[128:143], v[80:83], a[32:35], v[128:143]
    ds_read_b64_tr_b16 v[72:73], v18 offset:45056
    ds_read_b64_tr_b16 v[74:75], v18 offset:45312
    v_mul_f32 v63, v203, v203
    v_mul_f32 v204, v200, v204
    v_mul_f32 v205, v201, v205
    v_mfma_f32_32x32x16_bf16 v[144:159], v[80:83], a[36:39], v[144:159]
    v_mul_f32 v206, v202, v206
    v_mul_f32 v207, v203, v207
    v_fma_f32 v60, v60, s27, v15
    v_fma_f32 v61, v61, s27, v15
    v_fma_f32 v62, v62, s27, v15
    v_fma_f32 v63, v63, s27, v15
    v_mul_f32 v200, v60, v200
    v_mul_f32 v201, v61, v201
    s_waitcnt lgkmcnt(2)
    v_mfma_f32_32x32x16_bf16 v[128:143], v[88:91], a[40:43], v[128:143]
    ds_read_b64_tr_b16 v[80:81], v18 offset:47104
    ds_read_b64_tr_b16 v[82:83], v18 offset:47360
    v_mul_f32 v202, v62, v202
    v_mul_f32 v203, v63, v203
    v_mfma_f32_32x32x16_bf16 v[144:159], v[88:91], a[44:47], v[144:159]
    v_exp_f32 v200, v200
    v_exp_f32 v201, v201
    v_exp_f32 v202, v202
    v_exp_f32 v203, v203
    v_add_f32 v200, 1.0, v200
    s_waitcnt lgkmcnt(2)
    v_mfma_f32_32x32x16_bf16 v[128:143], v[72:75], a[48:51], v[128:143]
    s_waitcnt vmcnt(10)
    s_waitcnt lgkmcnt(0)
    s_barrier
    ds_read_b64_tr_b16 v[88:89], v18 offset:49152
    ds_read_b64_tr_b16 v[90:91], v18 offset:49408
    v_mfma_f32_32x32x16_bf16 v[144:159], v[72:75], a[52:55], v[144:159]
    s_mov_b32 s4, s44
    s_and_b32 s5, s45, 0xffff
    s_mov_b32 s6, 5308416
    s_add_u32 m0, s28, 36864
    s_nop 0
    buffer_load_dwordx4 v34, s[4:7], s74 offen lds
    v_add_f32 v201, 1.0, v201
    v_add_f32 v202, 1.0, v202
    v_add_f32 v203, 1.0, v203
    v_rcp_f32 v200, v200
    v_rcp_f32 v201, v201
    v_rcp_f32 v202, v202
    v_rcp_f32 v203, v203
    v_mfma_f32_32x32x16_bf16 v[128:143], v[80:83], a[56:59], v[128:143]
    ds_read_b64_tr_b16 v[72:73], v18 offset:51200
    ds_read_b64_tr_b16 v[74:75], v18 offset:51456
    v_mul_f32 v204, v204, v200
    v_mul_f32 v205, v205, v201
    v_mul_f32 v206, v206, v202
    v_mfma_f32_32x32x16_bf16 v[144:159], v[80:83], a[60:63], v[144:159]
    buffer_load_dwordx4 v35, s[4:7], s74 offen offset:1024 lds
    v_mul_f32 v207, v207, v203
    v_cvt_pk_bf16_f32 v66, v204, v205
    v_cvt_pk_bf16_f32 v67, v206, v207
    ds_write_b128 v14, v[64:67] offset:49152
    v_mul_f32 v56, v208, v208
    v_mul_f32 v57, v209, v209
    v_mul_f32 v58, v210, v210
    s_waitcnt lgkmcnt(3)
    v_mfma_f32_32x32x16_bf16 v[128:143], v[88:91], a[64:67], v[128:143]
    ds_read_b64_tr_b16 v[80:81], v18 offset:53248
    ds_read_b64_tr_b16 v[82:83], v18 offset:53504
    v_mul_f32 v59, v211, v211
    v_mul_f32 v212, v208, v212
    v_mul_f32 v213, v209, v213
    v_mfma_f32_32x32x16_bf16 v[144:159], v[88:91], a[68:71], v[144:159]
    v_mul_f32 v214, v210, v214
    v_mul_f32 v215, v211, v215
    v_fma_f32 v56, v56, s27, v15
    v_fma_f32 v57, v57, s27, v15
    v_fma_f32 v58, v58, s27, v15
    v_fma_f32 v59, v59, s27, v15
    v_mul_f32 v208, v56, v208
    v_mul_f32 v209, v57, v209
    s_waitcnt lgkmcnt(3)
    v_mfma_f32_32x32x16_bf16 v[128:143], v[72:75], a[72:75], v[128:143]
    ds_read_b64_tr_b16 v[88:89], v18 offset:55296
    ds_read_b64_tr_b16 v[90:91], v18 offset:55552
    v_mul_f32 v210, v58, v210
    v_mul_f32 v211, v59, v211
    v_mfma_f32_32x32x16_bf16 v[144:159], v[72:75], a[76:79], v[144:159]
    buffer_load_dwordx4 v36, s[4:7], s74 offen offset:2048 lds
    v_exp_f32 v208, v208
    v_exp_f32 v209, v209
    v_exp_f32 v210, v210
    v_exp_f32 v211, v211
    v_add_f32 v208, 1.0, v208
    s_waitcnt lgkmcnt(2)
    v_mfma_f32_32x32x16_bf16 v[128:143], v[80:83], a[80:83], v[128:143]
    ds_read_b64_tr_b16 v[72:73], v18 offset:57344
    ds_read_b64_tr_b16 v[74:75], v18 offset:57600
    v_add_f32 v209, 1.0, v209
    v_add_f32 v210, 1.0, v210
    v_add_f32 v211, 1.0, v211
    v_mfma_f32_32x32x16_bf16 v[144:159], v[80:83], a[84:87], v[144:159]
    v_rcp_f32 v208, v208
    v_rcp_f32 v209, v209
    v_rcp_f32 v210, v210
    v_rcp_f32 v211, v211
    s_waitcnt lgkmcnt(2)
    v_mfma_f32_32x32x16_bf16 v[128:143], v[88:91], a[88:91], v[128:143]
    ds_read_b64_tr_b16 v[80:81], v18 offset:59392
    ds_read_b64_tr_b16 v[82:83], v18 offset:59648
    v_mul_f32 v212, v212, v208
    v_mul_f32 v213, v213, v209
    v_mul_f32 v214, v214, v210
    v_mfma_f32_32x32x16_bf16 v[144:159], v[88:91], a[92:95], v[144:159]
    v_mul_f32 v215, v215, v211
    v_cvt_pk_bf16_f32 v68, v212, v213
    v_cvt_pk_bf16_f32 v69, v214, v215
    v_mul_f32 v60, v216, v216
    v_mul_f32 v61, v217, v217
    v_mul_f32 v62, v218, v218
    v_mul_f32 v63, v219, v219
    v_mul_f32 v220, v216, v220
    s_waitcnt lgkmcnt(2)
    v_mfma_f32_32x32x16_bf16 v[128:143], v[72:75], a[96:99], v[128:143]
    ds_read_b64_tr_b16 v[88:89], v18 offset:61440
    ds_read_b64_tr_b16 v[90:91], v18 offset:61696
    v_mul_f32 v221, v217, v221
    v_mul_f32 v222, v218, v222
    v_mul_f32 v223, v219, v223
    v_mfma_f32_32x32x16_bf16 v[144:159], v[72:75], a[100:103], v[144:159]
    v_fma_f32 v60, v60, s27, v15
    v_fma_f32 v61, v61, s27, v15
    v_fma_f32 v62, v62, s27, v15
    v_fma_f32 v63, v63, s27, v15
    v_mul_f32 v216, v60, v216
    v_mul_f32 v217, v61, v217
    v_mul_f32 v218, v62, v218
    v_mul_f32 v219, v63, v219
    s_waitcnt lgkmcnt(2)
    v_mfma_f32_32x32x16_bf16 v[128:143], v[80:83], a[104:107], v[128:143]
    ds_read_b64_tr_b16 v[72:73], v18 offset:63488
    ds_read_b64_tr_b16 v[74:75], v18 offset:63744
    v_exp_f32 v216, v216
    v_mfma_f32_32x32x16_bf16 v[144:159], v[80:83], a[108:111], v[144:159]
    v_exp_f32 v217, v217
    v_exp_f32 v218, v218
    v_exp_f32 v219, v219
    v_add_f32 v216, 1.0, v216
    v_add_f32 v217, 1.0, v217
    s_waitcnt lgkmcnt(2)
    v_mfma_f32_32x32x16_bf16 v[128:143], v[88:91], a[112:115], v[128:143]
    s_waitcnt vmcnt(9)
    s_waitcnt lgkmcnt(0)
    s_barrier
    ds_read_b64_tr_b16 v[80:81], v19 offset:0
    ds_read_b64_tr_b16 v[82:83], v19 offset:256
    v_mfma_f32_32x32x16_bf16 v[144:159], v[88:91], a[116:119], v[144:159]
    s_add_u32 m0, s28, 49152
    s_nop 0
    buffer_load_dwordx4 v34, s[4:7], s75 offen lds
    v_add_f32 v218, 1.0, v218
    v_add_f32 v219, 1.0, v219
    v_rcp_f32 v216, v216
    v_rcp_f32 v217, v217
    v_rcp_f32 v218, v218
    v_rcp_f32 v219, v219
    v_mfma_f32_32x32x16_bf16 v[128:143], v[72:75], a[120:123], v[128:143]
    ds_read_b64_tr_b16 v[88:89], v19 offset:2048
    ds_read_b64_tr_b16 v[90:91], v19 offset:2304
    v_mul_f32 v220, v220, v216
    v_mul_f32 v221, v221, v217
    v_mul_f32 v222, v222, v218
    v_mfma_f32_32x32x16_bf16 v[144:159], v[72:75], a[124:127], v[144:159]
    buffer_load_dwordx4 v35, s[4:7], s75 offen offset:1024 lds
    v_mul_f32 v223, v223, v219
    v_cvt_pk_bf16_f32 v70, v220, v221
    v_cvt_pk_bf16_f32 v71, v222, v223
    ds_write_b128 v14, v[68:71] offset:50176
    v_mul_f32 v56, v224, v224
    v_mul_f32 v57, v225, v225
    s_waitcnt lgkmcnt(3)
    v_mfma_f32_32x32x16_bf16 v[128:143], v[80:83], a[128:131], v[128:143]
    ds_read_b64_tr_b16 v[72:73], v19 offset:4096
    ds_read_b64_tr_b16 v[74:75], v19 offset:4352
    v_mul_f32 v58, v226, v226
    v_mul_f32 v59, v227, v227
    v_mul_f32 v228, v224, v228
    v_mfma_f32_32x32x16_bf16 v[144:159], v[80:83], a[132:135], v[144:159]
    v_mul_f32 v229, v225, v229
    v_mul_f32 v230, v226, v230
    v_mul_f32 v231, v227, v231
    v_fma_f32 v56, v56, s27, v15
    v_fma_f32 v57, v57, s27, v15
    v_fma_f32 v58, v58, s27, v15
    v_fma_f32 v59, v59, s27, v15
    s_waitcnt lgkmcnt(3)
    v_mfma_f32_32x32x16_bf16 v[128:143], v[88:91], a[136:139], v[128:143]
    ds_read_b64_tr_b16 v[80:81], v19 offset:6144
    ds_read_b64_tr_b16 v[82:83], v19 offset:6400
    v_mul_f32 v224, v56, v224
    v_mul_f32 v225, v57, v225
    v_mul_f32 v226, v58, v226
    v_mfma_f32_32x32x16_bf16 v[144:159], v[88:91], a[140:143], v[144:159]
    buffer_load_dwordx4 v36, s[4:7], s75 offen offset:2048 lds
    v_mul_f32 v227, v59, v227
    v_exp_f32 v224, v224
    v_exp_f32 v225, v225
    v_exp_f32 v226, v226
    s_waitcnt lgkmcnt(2)
    v_mfma_f32_32x32x16_bf16 v[128:143], v[72:75], a[144:147], v[128:143]
    ds_read_b64_tr_b16 v[88:89], v19 offset:8192
    ds_read_b64_tr_b16 v[90:91], v19 offset:8448
    v_exp_f32 v227, v227
    v_add_f32 v224, 1.0, v224
    v_mfma_f32_32x32x16_bf16 v[144:159], v[72:75], a[148:151], v[144:159]
    v_add_f32 v225, 1.0, v225
    v_add_f32 v226, 1.0, v226
    v_add_f32 v227, 1.0, v227
    v_rcp_f32 v224, v224
    v_rcp_f32 v225, v225
    s_waitcnt lgkmcnt(2)
    v_mfma_f32_32x32x16_bf16 v[128:143], v[80:83], a[152:155], v[128:143]
    ds_read_b64_tr_b16 v[72:73], v19 offset:10240
    ds_read_b64_tr_b16 v[74:75], v19 offset:10496
    v_rcp_f32 v226, v226
    v_mfma_f32_32x32x16_bf16 v[144:159], v[80:83], a[156:159], v[144:159]
    v_rcp_f32 v227, v227
    v_mul_f32 v228, v228, v224
    v_mul_f32 v229, v229, v225
    v_mul_f32 v230, v230, v226
    v_mul_f32 v231, v231, v227
    v_cvt_pk_bf16_f32 v64, v228, v229
    v_cvt_pk_bf16_f32 v65, v230, v231
    s_waitcnt lgkmcnt(2)
    v_mfma_f32_32x32x16_bf16 v[128:143], v[88:91], a[160:163], v[128:143]
    ds_read_b64_tr_b16 v[80:81], v19 offset:12288
    ds_read_b64_tr_b16 v[82:83], v19 offset:12544
    v_mul_f32 v60, v232, v232
    v_mul_f32 v61, v233, v233
    v_mul_f32 v62, v234, v234
    v_mfma_f32_32x32x16_bf16 v[144:159], v[88:91], a[164:167], v[144:159]
    v_mul_f32 v63, v235, v235
    v_mul_f32 v236, v232, v236
    v_mul_f32 v237, v233, v237
    v_mul_f32 v238, v234, v238
    v_mul_f32 v239, v235, v239
    v_fma_f32 v60, v60, s27, v15
    v_fma_f32 v61, v61, s27, v15
    s_waitcnt lgkmcnt(2)
    v_mfma_f32_32x32x16_bf16 v[128:143], v[72:75], a[168:171], v[128:143]
    ds_read_b64_tr_b16 v[88:89], v19 offset:14336
    ds_read_b64_tr_b16 v[90:91], v19 offset:14592
    v_fma_f32 v62, v62, s27, v15
    v_fma_f32 v63, v63, s27, v15
    v_mul_f32 v232, v60, v232
    v_mfma_f32_32x32x16_bf16 v[144:159], v[72:75], a[172:175], v[144:159]
    v_mul_f32 v233, v61, v233
    v_mul_f32 v234, v62, v234
    v_mul_f32 v235, v63, v235
    v_exp_f32 v232, v232
    v_exp_f32 v233, v233
    s_waitcnt lgkmcnt(2)
    v_mfma_f32_32x32x16_bf16 v[128:143], v[80:83], a[176:179], v[128:143]
    s_waitcnt vmcnt(8)
    s_waitcnt lgkmcnt(0)
    s_barrier
    ds_read_b64_tr_b16 v[72:73], v18 offset:0
    ds_read_b64_tr_b16 v[74:75], v18 offset:256
    v_mfma_f32_32x32x16_bf16 v[144:159], v[80:83], a[180:183], v[144:159]
    s_add_u32 m0, s28, 61440
    s_nop 0
    buffer_load_dwordx4 v34, s[4:7], s76 offen lds
    v_exp_f32 v234, v234
    v_exp_f32 v235, v235
    v_add_f32 v232, 1.0, v232
    v_add_f32 v233, 1.0, v233
    v_add_f32 v234, 1.0, v234
    v_add_f32 v235, 1.0, v235
    v_rcp_f32 v232, v232
    v_mfma_f32_32x32x16_bf16 v[128:143], v[88:91], a[184:187], v[128:143]
    ds_read_b64_tr_b16 v[80:81], v18 offset:2048
    ds_read_b64_tr_b16 v[82:83], v18 offset:2304
    v_rcp_f32 v233, v233
    v_mfma_f32_32x32x16_bf16 v[144:159], v[88:91], a[188:191], v[144:159]
    buffer_load_dwordx4 v35, s[4:7], s76 offen offset:1024 lds
    v_rcp_f32 v234, v234
    v_rcp_f32 v235, v235
    v_mul_f32 v236, v236, v232
    v_mul_f32 v237, v237, v233
    v_mul_f32 v238, v238, v234
    v_mul_f32 v239, v239, v235
    s_waitcnt lgkmcnt(2)
    v_mfma_f32_32x32x16_bf16 v[128:143], v[72:75], a[192:195], v[128:143]
    ds_read_b64_tr_b16 v[88:89], v18 offset:4096
    ds_read_b64_tr_b16 v[90:91], v18 offset:4352
    v_cvt_pk_bf16_f32 v66, v236, v237
    v_cvt_pk_bf16_f32 v67, v238, v239
    v_mfma_f32_32x32x16_bf16 v[144:159], v[72:75], a[196:199], v[144:159]
    ds_write_b128 v14, v[64:67] offset:53248
    v_mul_f32 v56, v240, v240
    v_mul_f32 v57, v241, v241
    v_mul_f32 v58, v242, v242
    v_mul_f32 v59, v243, v243
    v_mul_f32 v244, v240, v244
    v_mul_f32 v245, v241, v245
    s_waitcnt lgkmcnt(3)
    v_mfma_f32_32x32x16_bf16 v[128:143], v[80:83], a[200:203], v[128:143]
    ds_read_b64_tr_b16 v[72:73], v18 offset:6144
    ds_read_b64_tr_b16 v[74:75], v18 offset:6400
    v_mul_f32 v246, v242, v246
    v_mul_f32 v247, v243, v247
    v_fma_f32 v56, v56, s27, v15
    v_mfma_f32_32x32x16_bf16 v[144:159], v[80:83], a[204:207], v[144:159]
    buffer_load_dwordx4 v36, s[4:7], s76 offen offset:2048 lds
    v_fma_f32 v57, v57, s27, v15
    v_fma_f32 v58, v58, s27, v15
    v_fma_f32 v59, v59, s27, v15
    v_mul_f32 v240, v56, v240
    v_mul_f32 v241, v57, v241
    v_mul_f32 v242, v58, v242
    v_mul_f32 v243, v59, v243
    s_waitcnt lgkmcnt(3)
    v_mfma_f32_32x32x16_bf16 v[128:143], v[88:91], a[208:211], v[128:143]
    ds_read_b64_tr_b16 v[80:81], v18 offset:8192
    ds_read_b64_tr_b16 v[82:83], v18 offset:8448
    v_exp_f32 v240, v240
    v_mfma_f32_32x32x16_bf16 v[144:159], v[88:91], a[212:215], v[144:159]
    v_exp_f32 v241, v241
    v_exp_f32 v242, v242
    v_exp_f32 v243, v243
    v_add_f32 v240, 1.0, v240
    v_add_f32 v241, 1.0, v241
    s_waitcnt lgkmcnt(2)
    v_mfma_f32_32x32x16_bf16 v[128:143], v[72:75], a[216:219], v[128:143]
    ds_read_b64_tr_b16 v[88:89], v18 offset:10240
    ds_read_b64_tr_b16 v[90:91], v18 offset:10496
    v_add_f32 v242, 1.0, v242
    v_add_f32 v243, 1.0, v243
    v_mfma_f32_32x32x16_bf16 v[144:159], v[72:75], a[220:223], v[144:159]
    v_rcp_f32 v240, v240
    v_rcp_f32 v241, v241
    v_rcp_f32 v242, v242
    v_rcp_f32 v243, v243
    s_waitcnt lgkmcnt(2)
    v_mfma_f32_32x32x16_bf16 v[128:143], v[80:83], a[224:227], v[128:143]
    ds_read_b64_tr_b16 v[72:73], v18 offset:12288
    ds_read_b64_tr_b16 v[74:75], v18 offset:12544
    v_mul_f32 v244, v244, v240
    v_mul_f32 v245, v245, v241
    v_mul_f32 v246, v246, v242
    v_mfma_f32_32x32x16_bf16 v[144:159], v[80:83], a[228:231], v[144:159]
    v_mul_f32 v247, v247, v243
    v_cvt_pk_bf16_f32 v68, v244, v245
    v_cvt_pk_bf16_f32 v69, v246, v247
    v_mul_f32 v60, v248, v248
    v_mul_f32 v61, v249, v249
    v_mul_f32 v62, v250, v250
    v_mul_f32 v63, v251, v251
    s_waitcnt lgkmcnt(2)
    v_mfma_f32_32x32x16_bf16 v[128:143], v[88:91], a[232:235], v[128:143]
    ds_read_b64_tr_b16 v[80:81], v18 offset:14336
    ds_read_b64_tr_b16 v[82:83], v18 offset:14592
    v_mul_f32 v252, v248, v252
    v_mul_f32 v253, v249, v253
    v_mul_f32 v254, v250, v254
    v_mfma_f32_32x32x16_bf16 v[144:159], v[88:91], a[236:239], v[144:159]
    v_mul_f32 v255, v251, v255
    v_fma_f32 v60, v60, s27, v15
    v_fma_f32 v61, v61, s27, v15
    v_fma_f32 v62, v62, s27, v15
    v_fma_f32 v63, v63, s27, v15
    v_mul_f32 v248, v60, v248
    v_mul_f32 v249, v61, v249
    s_waitcnt lgkmcnt(2)
    v_mfma_f32_32x32x16_bf16 v[128:143], v[72:75], a[240:243], v[128:143]
    s_waitcnt vmcnt(9)
    s_waitcnt lgkmcnt(0)
    s_barrier
    ds_read_b64_tr_b16 v[88:89], v18 offset:16384
    ds_read_b64_tr_b16 v[90:91], v18 offset:16640
    v_mfma_f32_32x32x16_bf16 v[144:159], v[72:75], a[244:247], v[144:159]
    s_add_u32 m0, s28, 0
    s_nop 0
    buffer_load_dwordx4 v34, s[4:7], s77 offen lds
    v_mul_f32 v250, v62, v250
    v_mul_f32 v251, v63, v251
    v_exp_f32 v248, v248
    v_exp_f32 v249, v249
    v_exp_f32 v250, v250
    v_exp_f32 v251, v251
    v_mfma_f32_32x32x16_bf16 v[128:143], v[80:83], a[248:251], v[128:143]
    ds_read_b64_tr_b16 v[72:73], v18 offset:18432
    ds_read_b64_tr_b16 v[74:75], v18 offset:18688
    v_add_f32 v248, 1.0, v248
    v_add_f32 v249, 1.0, v249
    v_add_f32 v250, 1.0, v250
    v_mfma_f32_32x32x16_bf16 v[144:159], v[80:83], a[252:255], v[144:159]
    buffer_load_dwordx4 v35, s[4:7], s77 offen offset:1024 lds
    v_add_f32 v251, 1.0, v251
    v_rcp_f32 v248, v248
    v_rcp_f32 v249, v249
    v_rcp_f32 v250, v250
    s_waitcnt lgkmcnt(2)
    v_mfma_f32_32x32x16_bf16 v[128:143], v[88:91], v[96:99], v[128:143]
    ds_read_b64_tr_b16 v[80:81], v18 offset:20480
    ds_read_b64_tr_b16 v[82:83], v18 offset:20736
    v_rcp_f32 v251, v251
    v_mul_f32 v252, v252, v248
    v_mfma_f32_32x32x16_bf16 v[144:159], v[88:91], v[100:103], v[144:159]
    v_mul_f32 v253, v253, v249
    v_mul_f32 v254, v254, v250
    v_mul_f32 v255, v255, v251
    v_cvt_pk_bf16_f32 v70, v252, v253
    v_cvt_pk_bf16_f32 v71, v254, v255
    ds_write_b128 v14, v[68:71] offset:54272
    s_waitcnt lgkmcnt(3)
    v_mfma_f32_32x32x16_bf16 v[128:143], v[72:75], v[104:107], v[128:143]
    ds_read_b64_tr_b16 v[88:89], v18 offset:22528
    ds_read_b64_tr_b16 v[90:91], v18 offset:22784
    v_mfma_f32_32x32x16_bf16 v[144:159], v[72:75], v[108:111], v[144:159]
    buffer_load_dwordx4 v36, s[4:7], s77 offen offset:2048 lds
    s_waitcnt lgkmcnt(3)
    v_mfma_f32_32x32x16_bf16 v[128:143], v[80:83], v[112:115], v[128:143]
    s_waitcnt vmcnt(9)
    s_waitcnt lgkmcnt(0)
    s_barrier
    v_add_u32 v48, s83, v47
    ds_read_b128 a[0:3], v48 offset:0
    ds_read_b128 a[4:7], v48 offset:1024
    ds_read_b64_tr_b16 a[144:145], v37 offset:36864
    ds_read_b64_tr_b16 a[146:147], v37 offset:39936
    v_mfma_f32_32x32x16_bf16 v[144:159], v[80:83], v[116:119], v[144:159]
    ds_read_b64_tr_b16 a[148:149], v40 offset:36864
    ds_read_b64_tr_b16 a[150:151], v40 offset:39936
    ds_read_b64_tr_b16 a[152:153], v43 offset:36864
    ds_read_b64_tr_b16 a[154:155], v43 offset:39936
    v_mfma_f32_32x32x16_bf16 v[128:143], v[88:91], v[120:123], v[128:143]
    ds_read_b128 a[8:11], v48 offset:4096
    ds_read_b128 a[12:15], v48 offset:5120
    ds_read_b64_tr_b16 a[156:157], v37 offset:43008
    ds_read_b64_tr_b16 a[158:159], v37 offset:46080
    v_mfma_f32_32x32x16_bf16 v[144:159], v[88:91], v[124:127], v[144:159]
    ds_read_b64_tr_b16 a[160:161], v40 offset:43008
    ds_read_b64_tr_b16 a[162:163], v40 offset:46080
    ds_read_b64_tr_b16 a[164:165], v43 offset:43008
    ds_read_b64_tr_b16 a[166:167], v43 offset:46080
    s_waitcnt lgkmcnt(8)
    v_mfma_f32_32x32x16_bf16 v[160:175], a[144:147], a[0:3], 0
    s_waitcnt vmcnt(6)
    s_waitcnt lgkmcnt(0)
    s_barrier
    v_mfma_f32_32x32x16_bf16 v[176:191], a[144:147], a[4:7], 0
    v_add_u32 v48, s84, v47
    ds_read_b128 a[16:19], v48 offset:0
    s_add_u32 m0, s28, 12288
    s_nop 0
    buffer_load_dwordx4 v34, s[4:7], s78 offen lds
    v_mfma_f32_32x32x16_bf16 v[192:207], a[148:151], a[0:3], 0
    ds_read_b128 a[20:23], v48 offset:1024
    ds_read_b64_tr_b16 a[168:169], v37 offset:49152
    buffer_load_dwordx4 v35, s[4:7], s78 offen offset:1024 lds
    v_lshlrev_b32 v72, 2, v0
    v_mfma_f32_32x32x16_bf16 v[208:223], a[148:151], a[4:7], 0
    ds_read_b64_tr_b16 a[170:171], v37 offset:52224
    ds_read_b64_tr_b16 a[172:173], v40 offset:49152
    s_lshl_b32 s55, s46, 4
    s_add_u32 s55, s55, s48
    s_lshl_b32 s55, s55, 2
    v_mfma_f32_32x32x16_bf16 v[224:239], a[152:155], a[0:3], 0
    ds_read_b64_tr_b16 a[174:175], v40 offset:52224
    ds_read_b64_tr_b16 a[176:177], v43 offset:49152
    s_add_u32 s55, s55, s20
    s_lshl_b32 s26, s55, 1
    s_lshl_b32 s3, s26, 3
    v_mfma_f32_32x32x16_bf16 v[240:255], a[152:155], a[4:7], 0
    ds_read_b64_tr_b16 a[178:179], v43 offset:52224
    buffer_load_dwordx4 v36, s[4:7], s78 offen offset:2048 lds
    s_add_u32 s3, s3, 45088768
    s_mul_i32 s29, s26, 1152
    s_mov_b32 s8, s32
    s_and_b32 s9, s33, 0xffff
    s_mov_b32 s10, 2359296
    s_mov_b32 s12, s100
    s_and_b32 s13, s101, 0xffff
    s_mov_b32 s14, 1152
    buffer_load_dword v96, v72, s[8:11], s29 offen offset:0
    buffer_load_dword v97, v72, s[8:11], s29 offen offset:256
    buffer_load_dword v98, v72, s[8:11], s29 offen offset:512
    v_mfma_f32_32x32x16_bf16 v[160:175], a[156:159], a[8:11], v[160:175]
    ds_read_b128 a[24:27], v48 offset:4096
    ds_read_b128 a[28:31], v48 offset:5120
    buffer_load_dword v99, v72, s[8:11], s29 offen offset:768
    v_mfma_f32_32x32x16_bf16 v[176:191], a[156:159], a[12:15], v[176:191]
    ds_read_b64_tr_b16 a[144:145], v37 offset:55296
    ds_read_b64_tr_b16 a[146:147], v37 offset:58368
    buffer_load_dword v100, v72, s[8:11], s29 offen offset:1024
    v_mfma_f32_32x32x16_bf16 v[192:207], a[160:163], a[8:11], v[192:207]
    ds_read_b64_tr_b16 a[148:149], v40 offset:55296
    ds_read_b64_tr_b16 a[150:151], v40 offset:58368
    s_add_u32 m0, s28, 24576
    s_nop 0
    buffer_load_dwordx4 v34, s[4:7], s79 offen lds
    v_mfma_f32_32x32x16_bf16 v[208:223], a[160:163], a[12:15], v[208:223]
    ds_read_b64_tr_b16 a[152:153], v43 offset:55296
    ds_read_b64_tr_b16 a[154:155], v43 offset:58368
    buffer_load_dword v101, v72, s[8:11], s29 offen offset:1152
    v_mfma_f32_32x32x16_bf16 v[224:239], a[164:167], a[8:11], v[224:239]
    buffer_load_dword v102, v72, s[8:11], s29 offen offset:1408
    buffer_load_dword v103, v72, s[8:11], s29 offen offset:1664
    v_mfma_f32_32x32x16_bf16 v[240:255], a[164:167], a[12:15], v[240:255]
    buffer_load_dwordx4 v35, s[4:7], s79 offen offset:1024 lds
    buffer_load_dword v104, v72, s[8:11], s29 offen offset:1920
    buffer_load_dword v105, v72, s[8:11], s29 offen offset:2176
    buffer_load_dword v106, v72, s[12:15], 0 offen offset:0
    buffer_load_dword v107, v72, s[12:15], 0 offen offset:256
    buffer_load_dword v108, v72, s[12:15], 0 offen offset:512
    s_waitcnt lgkmcnt(8)
    v_mfma_f32_32x32x16_bf16 v[160:175], a[168:171], a[16:19], v[160:175]
    s_waitcnt vmcnt(21)
    s_waitcnt lgkmcnt(0)
    s_barrier
    v_mfma_f32_32x32x16_bf16 v[176:191], a[168:171], a[20:23], v[176:191]
    v_add_u32 v48, s85, v47
    ds_read_b128 a[32:35], v48 offset:0
    buffer_load_dword v109, v72, s[12:15], 0 offen offset:768
    v_mfma_f32_32x32x16_bf16 v[192:207], a[172:175], a[16:19], v[192:207]
    ds_read_b128 a[36:39], v48 offset:1024
    ds_read_b64_tr_b16 a[156:157], v37 offset:61440
    buffer_load_dword v110, v72, s[12:15], 0 offen offset:1024
    v_mul_f32 v56, v128, v128
    v_mfma_f32_32x32x16_bf16 v[208:223], a[172:175], a[20:23], v[208:223]
    ds_read_b64_tr_b16 a[158:159], v37 offset:64512
    ds_read_b64_tr_b16 a[160:161], v40 offset:61440
    buffer_load_dwordx4 v36, s[4:7], s79 offen offset:2048 lds
    v_mul_f32 v57, v129, v129
    v_mfma_f32_32x32x16_bf16 v[224:239], a[176:179], a[16:19], v[224:239]
    ds_read_b64_tr_b16 a[162:163], v40 offset:64512
    ds_read_b64_tr_b16 a[164:165], v43 offset:61440
    v_mul_f32 v58, v130, v130
    v_mul_f32 v59, v131, v131
    v_mul_f32 v132, v128, v132
    v_mfma_f32_32x32x16_bf16 v[240:255], a[176:179], a[20:23], v[240:255]
    ds_read_b64_tr_b16 a[166:167], v43 offset:64512
    v_mul_f32 v133, v129, v133
    v_mul_f32 v134, v130, v134
    v_mul_f32 v135, v131, v135
    v_fma_f32 v56, v56, s27, v15
    v_fma_f32 v57, v57, s27, v15
    v_fma_f32 v58, v58, s27, v15
    v_fma_f32 v59, v59, s27, v15
    v_mul_f32 v128, v56, v128
    v_mul_f32 v129, v57, v129
    v_mul_f32 v130, v58, v130
    v_mul_f32 v131, v59, v131
    v_mfma_f32_32x32x16_bf16 v[160:175], a[144:147], a[24:27], v[160:175]
    ds_read_b128 a[40:43], v48 offset:4096
    ds_read_b128 a[44:47], v48 offset:5120
    s_add_u32 m0, s28, 36864
    s_nop 0
    buffer_load_dwordx4 v34, s[4:7], s80 offen lds
    v_mfma_f32_32x32x16_bf16 v[176:191], a[144:147], a[28:31], v[176:191]
    ds_read_b64_tr_b16 a[168:169], v38 offset:2048
    ds_read_b64_tr_b16 a[170:171], v38 offset:5120
    v_exp_f32 v128, v128
    v_mfma_f32_32x32x16_bf16 v[192:207], a[148:151], a[24:27], v[192:207]
    ds_read_b64_tr_b16 a[172:173], v41 offset:2048
    ds_read_b64_tr_b16 a[174:175], v41 offset:5120
    v_exp_f32 v129, v129
    v_mfma_f32_32x32x16_bf16 v[208:223], a[148:151], a[28:31], v[208:223]
    ds_read_b64_tr_b16 a[176:177], v44 offset:2048
    ds_read_b64_tr_b16 a[178:179], v44 offset:5120
    buffer_load_dwordx4 v35, s[4:7], s80 offen offset:1024 lds
    v_mfma_f32_32x32x16_bf16 v[224:239], a[152:155], a[24:27], v[224:239]
    v_exp_f32 v130, v130
    v_exp_f32 v131, v131
    v_add_f32 v128, 1.0, v128
    v_mfma_f32_32x32x16_bf16 v[240:255], a[152:155], a[28:31], v[240:255]
    v_add_f32 v129, 1.0, v129
    v_add_f32 v130, 1.0, v130
    v_add_f32 v131, 1.0, v131
    v_rcp_f32 v128, v128
    v_rcp_f32 v129, v129
    v_rcp_f32 v130, v130
    v_rcp_f32 v131, v131
    s_waitcnt lgkmcnt(8)
    v_mfma_f32_32x32x16_bf16 v[160:175], a[156:159], a[32:35], v[160:175]
    s_waitcnt vmcnt(23)
    s_waitcnt lgkmcnt(0)
    s_barrier
    v_mfma_f32_32x32x16_bf16 v[176:191], a[156:159], a[36:39], v[176:191]
    v_add_u32 v48, s86, v47
    ds_read_b128 a[48:51], v48 offset:0
    buffer_load_dwordx4 v36, s[4:7], s80 offen offset:2048 lds
    v_mul_f32 v132, v132, v128
    v_mfma_f32_32x32x16_bf16 v[192:207], a[160:163], a[32:35], v[192:207]
    ds_read_b128 a[52:55], v48 offset:1024
    ds_read_b64_tr_b16 a[144:145], v37 offset:0
    v_mul_f32 v133, v133, v129
    v_mul_f32 v134, v134, v130
    v_mul_f32 v135, v135, v131
    v_mfma_f32_32x32x16_bf16 v[208:223], a[160:163], a[36:39], v[208:223]
    ds_read_b64_tr_b16 a[146:147], v37 offset:3072
    ds_read_b64_tr_b16 a[148:149], v40 offset:0
    v_cvt_pk_bf16_f32 v64, v132, v133
    v_cvt_pk_bf16_f32 v65, v134, v135
    v_mul_f32 v60, v136, v136
    v_mfma_f32_32x32x16_bf16 v[224:239], a[164:167], a[32:35], v[224:239]
    ds_read_b64_tr_b16 a[150:151], v40 offset:3072
    ds_read_b64_tr_b16 a[152:153], v43 offset:0
    s_add_u32 m0, s28, 49152
    s_nop 0
    buffer_load_dwordx4 v34, s[4:7], s81 offen lds
    v_mfma_f32_32x32x16_bf16 v[240:255], a[164:167], a[36:39], v[240:255]
    ds_read_b64_tr_b16 a[154:155], v43 offset:3072
    v_mul_f32 v61, v137, v137
    v_mul_f32 v62, v138, v138
    v_mul_f32 v63, v139, v139
    v_mul_f32 v140, v136, v140
    v_mul_f32 v141, v137, v141
    v_mul_f32 v142, v138, v142
    v_mul_f32 v143, v139, v143
    v_fma_f32 v60, v60, s27, v15
    v_fma_f32 v61, v61, s27, v15
    v_fma_f32 v62, v62, s27, v15
    v_fma_f32 v63, v63, s27, v15
    v_mul_f32 v136, v60, v136
    v_mul_f32 v137, v61, v137
    v_mfma_f32_32x32x16_bf16 v[160:175], a[168:171], a[40:43], v[160:175]
    ds_read_b128 a[56:59], v48 offset:4096
    ds_read_b128 a[60:63], v48 offset:5120
    v_mul_f32 v138, v62, v138
    v_mul_f32 v139, v63, v139
    v_mfma_f32_32x32x16_bf16 v[176:191], a[168:171], a[44:47], v[176:191]
    ds_read_b64_tr_b16 a[156:157], v37 offset:6144
    ds_read_b64_tr_b16 a[158:159], v37 offset:9216
    buffer_load_dwordx4 v35, s[4:7], s81 offen offset:1024 lds
    v_mfma_f32_32x32x16_bf16 v[192:207], a[172:175], a[40:43], v[192:207]
    ds_read_b64_tr_b16 a[160:161], v40 offset:6144
    ds_read_b64_tr_b16 a[162:163], v40 offset:9216
    v_exp_f32 v136, v136
    v_mfma_f32_32x32x16_bf16 v[208:223], a[172:175], a[44:47], v[208:223]
    ds_read_b64_tr_b16 a[164:165], v43 offset:6144
    ds_read_b64_tr_b16 a[166:167], v43 offset:9216
    v_exp_f32 v137, v137
    v_mfma_f32_32x32x16_bf16 v[224:239], a[176:179], a[40:43], v[224:239]
    buffer_load_dwordx4 v36, s[4:7], s81 offen offset:2048 lds
    v_exp_f32 v138, v138
    v_mfma_f32_32x32x16_bf16 v[240:255], a[176:179], a[44:47], v[240:255]
    v_exp_f32 v139, v139
    v_add_f32 v136, 1.0, v136
    v_add_f32 v137, 1.0, v137
    v_add_f32 v138, 1.0, v138
    v_add_f32 v139, 1.0, v139
    v_rcp_f32 v136, v136
    v_rcp_f32 v137, v137
    v_rcp_f32 v138, v138
    s_waitcnt lgkmcnt(8)
    v_mfma_f32_32x32x16_bf16 v[160:175], a[144:147], a[48:51], v[160:175]
    s_waitcnt vmcnt(24)
    s_waitcnt lgkmcnt(0)
    s_barrier
    v_mfma_f32_32x32x16_bf16 v[176:191], a[144:147], a[52:55], v[176:191]
    v_add_u32 v48, s87, v47
    ds_read_b128 a[64:67], v48 offset:0
    v_rcp_f32 v139, v139
    v_mul_f32 v140, v140, v136
    v_mfma_f32_32x32x16_bf16 v[192:207], a[148:151], a[48:51], v[192:207]
    ds_read_b128 a[68:71], v48 offset:1024
    ds_read_b64_tr_b16 a[168:169], v37 offset:12288
    s_add_u32 m0, s28, 61440
    s_nop 0
    buffer_load_dwordx4 v34, s[4:7], s82 offen lds
    v_mfma_f32_32x32x16_bf16 v[208:223], a[148:151], a[52:55], v[208:223]
    ds_read_b64_tr_b16 a[170:171], v37 offset:15360
    ds_read_b64_tr_b16 a[172:173], v40 offset:12288
    v_mul_f32 v141, v141, v137
    v_mul_f32 v142, v142, v138
    v_mul_f32 v143, v143, v139
    v_mfma_f32_32x32x16_bf16 v[224:239], a[152:155], a[48:51], v[224:239]
    ds_read_b64_tr_b16 a[174:175], v40 offset:15360
    ds_read_b64_tr_b16 a[176:177], v43 offset:12288
    v_cvt_pk_bf16_f32 v66, v140, v141
    v_cvt_pk_bf16_f32 v67, v142, v143
    v_mfma_f32_32x32x16_bf16 v[240:255], a[152:155], a[52:55], v[240:255]
    ds_read_b64_tr_b16 a[178:179], v43 offset:15360
    buffer_load_dwordx4 v35, s[4:7], s82 offen offset:1024 lds
    ds_write_b128 v33, v[64:67] offset:0
    v_mul_f32 v56, v144, v144
    v_mul_f32 v57, v145, v145
    v_mul_f32 v58, v146, v146
    v_mul_f32 v59, v147, v147
    v_mul_f32 v148, v144, v148
    v_mul_f32 v149, v145, v149
    v_mul_f32 v150, v146, v150
    v_mul_f32 v151, v147, v151
    v_fma_f32 v56, v56, s27, v15
    v_fma_f32 v57, v57, s27, v15
    v_mfma_f32_32x32x16_bf16 v[160:175], a[156:159], a[56:59], v[160:175]
    ds_read_b128 a[72:75], v48 offset:4096
    ds_read_b128 a[76:79], v48 offset:5120
    v_fma_f32 v58, v58, s27, v15
    v_fma_f32 v59, v59, s27, v15
    v_mul_f32 v144, v56, v144
    v_mfma_f32_32x32x16_bf16 v[176:191], a[156:159], a[60:63], v[176:191]
    ds_read_b64_tr_b16 a[144:145], v37 offset:18432
    ds_read_b64_tr_b16 a[146:147], v37 offset:21504
    v_mul_f32 v145, v57, v145
    v_mul_f32 v146, v58, v146
    v_mul_f32 v147, v59, v147
    v_mfma_f32_32x32x16_bf16 v[192:207], a[160:163], a[56:59], v[192:207]
    ds_read_b64_tr_b16 a[148:149], v40 offset:18432
    ds_read_b64_tr_b16 a[150:151], v40 offset:21504
    buffer_load_dwordx4 v36, s[4:7], s82 offen offset:2048 lds
    v_mfma_f32_32x32x16_bf16 v[208:223], a[160:163], a[60:63], v[208:223]
    ds_read_b64_tr_b16 a[152:153], v43 offset:18432
    ds_read_b64_tr_b16 a[154:155], v43 offset:21504
    v_exp_f32 v144, v144
    v_mfma_f32_32x32x16_bf16 v[224:239], a[164:167], a[56:59], v[224:239]
    v_exp_f32 v145, v145
    v_exp_f32 v146, v146
    v_mfma_f32_32x32x16_bf16 v[240:255], a[164:167], a[60:63], v[240:255]
    s_add_u32 s4, s4, 384
    s_addc_u32 s5, s5, 0
    s_add_u32 m0, s28, 0
    s_nop 0
    buffer_load_dwordx4 v34, s[4:7], s74 offen lds
    v_exp_f32 v147, v147
    v_add_f32 v144, 1.0, v144
    v_add_f32 v145, 1.0, v145
    v_add_f32 v146, 1.0, v146
    v_add_f32 v147, 1.0, v147
    v_rcp_f32 v144, v144
    s_waitcnt lgkmcnt(9)
    v_mfma_f32_32x32x16_bf16 v[160:175], a[168:171], a[64:67], v[160:175]
    s_waitcnt vmcnt(10)
    s_waitcnt lgkmcnt(0)
    s_barrier
    v_mfma_f32_32x32x16_bf16 v[176:191], a[168:171], a[68:71], v[176:191]
    v_add_u32 v48, s88, v47
    ds_read_b128 a[80:83], v48 offset:0
    v_rcp_f32 v145, v145
    v_mfma_f32_32x32x16_bf16 v[192:207], a[172:175], a[64:67], v[192:207]
    ds_read_b128 a[84:87], v48 offset:1024
    ds_read_b64_tr_b16 a[156:157], v37 offset:24576
    v_rcp_f32 v146, v146
    v_mfma_f32_32x32x16_bf16 v[208:223], a[172:175], a[68:71], v[208:223]
    ds_read_b64_tr_b16 a[158:159], v37 offset:27648
    ds_read_b64_tr_b16 a[160:161], v40 offset:24576
    buffer_load_dwordx4 v35, s[4:7], s74 offen offset:1024 lds
    v_mfma_f32_32x32x16_bf16 v[224:239], a[176:179], a[64:67], v[224:239]
    ds_read_b64_tr_b16 a[162:163], v40 offset:27648
    ds_read_b64_tr_b16 a[164:165], v43 offset:24576
    v_rcp_f32 v147, v147
    v_mul_f32 v148, v148, v144
    v_mfma_f32_32x32x16_bf16 v[240:255], a[176:179], a[68:71], v[240:255]
    ds_read_b64_tr_b16 a[166:167], v43 offset:27648
    v_mul_f32 v149, v149, v145
    v_mul_f32 v150, v150, v146
    v_mul_f32 v151, v151, v147
    v_cvt_pk_bf16_f32 v68, v148, v149
    v_cvt_pk_bf16_f32 v69, v150, v151
    v_mul_f32 v60, v152, v152
    v_mul_f32 v61, v153, v153
    v_mul_f32 v62, v154, v154
    v_mul_f32 v63, v155, v155
    v_mul_f32 v156, v152, v156
    v_mul_f32 v157, v153, v157
    v_mul_f32 v158, v154, v158
    v_mfma_f32_32x32x16_bf16 v[160:175], a[144:147], a[72:75], v[160:175]
    ds_read_b128 a[88:91], v48 offset:4096
    ds_read_b128 a[92:95], v48 offset:5120
    buffer_load_dwordx4 v36, s[4:7], s74 offen offset:2048 lds
    v_mul_f32 v159, v155, v159
    v_mfma_f32_32x32x16_bf16 v[176:191], a[144:147], a[76:79], v[176:191]
    ds_read_b64_tr_b16 a[168:169], v37 offset:30720
    ds_read_b64_tr_b16 a[170:171], v37 offset:33792
    v_fma_f32 v60, v60, s27, v15
    v_fma_f32 v61, v61, s27, v15
    v_fma_f32 v62, v62, s27, v15
    v_mfma_f32_32x32x16_bf16 v[192:207], a[148:151], a[72:75], v[192:207]
    ds_read_b64_tr_b16 a[172:173], v40 offset:30720
    ds_read_b64_tr_b16 a[174:175], v40 offset:33792
    v_fma_f32 v63, v63, s27, v15
    v_mul_f32 v152, v60, v152
    v_mul_f32 v153, v61, v153
    v_mfma_f32_32x32x16_bf16 v[208:223], a[148:151], a[76:79], v[208:223]
    ds_read_b64_tr_b16 a[176:177], v43 offset:30720
    ds_read_b64_tr_b16 a[178:179], v43 offset:33792
    s_add_u32 m0, s28, 12288
    s_nop 0
    buffer_load_dwordx4 v34, s[4:7], s75 offen lds
    v_mfma_f32_32x32x16_bf16 v[224:239], a[152:155], a[72:75], v[224:239]
    v_mul_f32 v154, v62, v154
    v_mul_f32 v155, v63, v155
    v_exp_f32 v152, v152
    v_mfma_f32_32x32x16_bf16 v[240:255], a[152:155], a[76:79], v[240:255]
    v_exp_f32 v153, v153
    v_exp_f32 v154, v154
    v_exp_f32 v155, v155
    v_add_f32 v152, 1.0, v152
    v_add_f32 v153, 1.0, v153
    s_waitcnt lgkmcnt(8)
    v_mfma_f32_32x32x16_bf16 v[160:175], a[156:159], a[80:83], v[160:175]
    s_waitcnt vmcnt(10)
    s_waitcnt lgkmcnt(0)
    s_barrier
    v_mfma_f32_32x32x16_bf16 v[176:191], a[156:159], a[84:87], v[176:191]
    v_add_u32 v48, s89, v47
    ds_read_b128 a[96:99], v48 offset:0
    buffer_load_dwordx4 v35, s[4:7], s75 offen offset:1024 lds
    v_add_f32 v154, 1.0, v154
    v_mfma_f32_32x32x16_bf16 v[192:207], a[160:163], a[80:83], v[192:207]
    ds_read_b128 a[100:103], v48 offset:1024
    ds_read_b64_tr_b16 a[144:145], v37 offset:36864
    v_add_f32 v155, 1.0, v155
    v_rcp_f32 v152, v152
    v_mfma_f32_32x32x16_bf16 v[208:223], a[160:163], a[84:87], v[208:223]
    ds_read_b64_tr_b16 a[146:147], v37 offset:39936
    ds_read_b64_tr_b16 a[148:149], v40 offset:36864
    v_rcp_f32 v153, v153
    v_mfma_f32_32x32x16_bf16 v[224:239], a[164:167], a[80:83], v[224:239]
    ds_read_b64_tr_b16 a[150:151], v40 offset:39936
    ds_read_b64_tr_b16 a[152:153], v43 offset:36864
    buffer_load_dwordx4 v36, s[4:7], s75 offen offset:2048 lds
    v_mfma_f32_32x32x16_bf16 v[240:255], a[164:167], a[84:87], v[240:255]
    ds_read_b64_tr_b16 a[154:155], v43 offset:39936
    v_rcp_f32 v154, v154
    v_rcp_f32 v155, v155
    v_mul_f32 v156, v156, v152
    v_mul_f32 v157, v157, v153
    v_mul_f32 v158, v158, v154
    v_mul_f32 v159, v159, v155
    v_cvt_pk_bf16_f32 v70, v156, v157
    v_cvt_pk_bf16_f32 v71, v158, v159
    ds_write_b128 v33, v[68:71] offset:1024
    v_mfma_f32_32x32x16_bf16 v[160:175], a[168:171], a[88:91], v[160:175]
    ds_read_b128 a[104:107], v48 offset:4096
    ds_read_b128 a[108:111], v48 offset:5120
    v_lshlrev_b32 v112, 16, v106
    v_and_b32 v113, 0xffff0000, v106
    v_mfma_f32_32x32x16_bf16 v[176:191], a[168:171], a[92:95], v[176:191]
    ds_read_b64_tr_b16 a[156:157], v37 offset:43008
    ds_read_b64_tr_b16 a[158:159], v37 offset:46080
    s_add_u32 m0, s28, 24576
    s_nop 0
    buffer_load_dwordx4 v34, s[4:7], s76 offen lds
    v_mfma_f32_32x32x16_bf16 v[192:207], a[172:175], a[88:91], v[192:207]
    ds_read_b64_tr_b16 a[160:161], v40 offset:43008
    ds_read_b64_tr_b16 a[162:163], v40 offset:46080
    v_lshlrev_b32 v114, 16, v107
    v_and_b32 v115, 0xffff0000, v107
    v_lshlrev_b32 v116, 16, v108
    v_mfma_f32_32x32x16_bf16 v[208:223], a[172:175], a[92:95], v[208:223]
    ds_read_b64_tr_b16 a[164:165], v43 offset:43008
    ds_read_b64_tr_b16 a[166:167], v43 offset:46080
    v_and_b32 v117, 0xffff0000, v108
    v_lshlrev_b32 v118, 16, v109
    v_and_b32 v119, 0xffff0000, v109
    v_mfma_f32_32x32x16_bf16 v[224:239], a[176:179], a[88:91], v[224:239]
    buffer_load_dwordx4 v35, s[4:7], s76 offen offset:1024 lds
    v_lshlrev_b32 v120, 16, v110
    v_and_b32 v121, 0xffff0000, v110
    v_lshlrev_b32 v74, 16, v96
    v_mfma_f32_32x32x16_bf16 v[240:255], a[176:179], a[92:95], v[240:255]
    v_and_b32 v75, 0xffff0000, v96
    v_mul_f32 v74, v74, v112
    v_mul_f32 v75, v75, v113
    v_cvt_pk_bf16_f32 v73, v74, v75
    v_lshlrev_b32 v74, 16, v73
    v_and_b32 v75, 0xffff0000, v73
    v_add_f32 v76, v74, v75
    v_lshlrev_b32 v74, 16, v97
    v_and_b32 v75, 0xffff0000, v97
    v_mul_f32 v74, v74, v114
    v_mul_f32 v75, v75, v115
    v_cvt_pk_bf16_f32 v73, v74, v75
    s_waitcnt lgkmcnt(9)
    v_mfma_f32_32x32x16_bf16 v[160:175], a[144:147], a[96:99], v[160:175]
    s_waitcnt vmcnt(11)
    s_waitcnt lgkmcnt(0)
    s_barrier
    v_mfma_f32_32x32x16_bf16 v[176:191], a[144:147], a[100:103], v[176:191]
    v_add_u32 v48, s90, v47
    ds_read_b128 a[112:115], v48 offset:0
    v_lshlrev_b32 v74, 16, v73
    v_and_b32 v75, 0xffff0000, v73
    v_add_f32 v76, v76, v74
    v_mfma_f32_32x32x16_bf16 v[192:207], a[148:151], a[96:99], v[192:207]
    ds_read_b128 a[116:119], v48 offset:1024
    ds_read_b64_tr_b16 a[168:169], v37 offset:49152
    buffer_load_dwordx4 v36, s[4:7], s76 offen offset:2048 lds
    v_add_f32 v76, v76, v75
    v_mfma_f32_32x32x16_bf16 v[208:223], a[148:151], a[100:103], v[208:223]
    ds_read_b64_tr_b16 a[170:171], v37 offset:52224
    ds_read_b64_tr_b16 a[172:173], v40 offset:49152
    v_lshlrev_b32 v74, 16, v98
    v_and_b32 v75, 0xffff0000, v98
    v_mul_f32 v74, v74, v116
    v_mfma_f32_32x32x16_bf16 v[224:239], a[152:155], a[96:99], v[224:239]
    ds_read_b64_tr_b16 a[174:175], v40 offset:52224
    ds_read_b64_tr_b16 a[176:177], v43 offset:49152
    v_mul_f32 v75, v75, v117
    v_cvt_pk_bf16_f32 v73, v74, v75
    v_lshlrev_b32 v74, 16, v73
    v_mfma_f32_32x32x16_bf16 v[240:255], a[152:155], a[100:103], v[240:255]
    ds_read_b64_tr_b16 a[178:179], v43 offset:52224
    s_add_u32 m0, s28, 36864
    s_nop 0
    buffer_load_dwordx4 v34, s[4:7], s77 offen lds
    v_and_b32 v75, 0xffff0000, v73
    v_add_f32 v76, v76, v74
    v_add_f32 v76, v76, v75
    v_lshlrev_b32 v74, 16, v99
    v_and_b32 v75, 0xffff0000, v99
    v_mul_f32 v74, v74, v118
    v_mul_f32 v75, v75, v119
    v_cvt_pk_bf16_f32 v73, v74, v75
    v_lshlrev_b32 v74, 16, v73
    v_and_b32 v75, 0xffff0000, v73
    v_add_f32 v76, v76, v74
    v_add_f32 v76, v76, v75
    v_lshlrev_b32 v74, 16, v100
    v_and_b32 v75, 0xffff0000, v100
    v_mfma_f32_32x32x16_bf16 v[160:175], a[156:159], a[104:107], v[160:175]
    ds_read_b128 a[120:123], v48 offset:4096
    ds_read_b128 a[124:127], v48 offset:5120
    v_mul_f32 v74, v74, v120
    v_mul_f32 v75, v75, v121
    v_cvt_pk_bf16_f32 v73, v74, v75
    v_mfma_f32_32x32x16_bf16 v[176:191], a[156:159], a[108:111], v[176:191]
    ds_read_b64_tr_b16 a[144:145], v37 offset:55296
    ds_read_b64_tr_b16 a[146:147], v37 offset:58368
    v_lshlrev_b32 v74, 16, v73
    v_and_b32 v75, 0xffff0000, v73
    v_add_f32 v76, v76, v74
    v_mfma_f32_32x32x16_bf16 v[192:207], a[160:163], a[104:107], v[192:207]
    ds_read_b64_tr_b16 a[148:149], v40 offset:55296
    ds_read_b64_tr_b16 a[150:151], v40 offset:58368
    buffer_load_dwordx4 v35, s[4:7], s77 offen offset:1024 lds
    v_add_f32 v76, v76, v75
    v_mfma_f32_32x32x16_bf16 v[208:223], a[160:163], a[108:111], v[208:223]
    ds_read_b64_tr_b16 a[152:153], v43 offset:55296
    ds_read_b64_tr_b16 a[154:155], v43 offset:58368
    v_lshlrev_b32 v74, 16, v101
    v_and_b32 v75, 0xffff0000, v101
    v_mul_f32 v74, v74, v112
    v_mfma_f32_32x32x16_bf16 v[224:239], a[164:167], a[104:107], v[224:239]
    v_mul_f32 v75, v75, v113
    v_cvt_pk_bf16_f32 v73, v74, v75
    v_lshlrev_b32 v74, 16, v73
    v_and_b32 v75, 0xffff0000, v73
    v_add_f32 v77, v74, v75
    v_mfma_f32_32x32x16_bf16 v[240:255], a[164:167], a[108:111], v[240:255]
    buffer_load_dwordx4 v36, s[4:7], s77 offen offset:2048 lds
    v_lshlrev_b32 v74, 16, v102
    v_and_b32 v75, 0xffff0000, v102
    v_mul_f32 v74, v74, v114
    v_mul_f32 v75, v75, v115
    v_cvt_pk_bf16_f32 v73, v74, v75
    v_lshlrev_b32 v74, 16, v73
    v_and_b32 v75, 0xffff0000, v73
    v_add_f32 v77, v77, v74
    v_add_f32 v77, v77, v75
    s_waitcnt lgkmcnt(8)
    v_mfma_f32_32x32x16_bf16 v[160:175], a[168:171], a[112:115], v[160:175]
    s_waitcnt vmcnt(12)
    s_waitcnt lgkmcnt(0)
    s_barrier
    v_mfma_f32_32x32x16_bf16 v[176:191], a[168:171], a[116:119], v[176:191]
    v_add_u32 v48, s91, v47
    ds_read_b128 a[128:131], v48 offset:0
    v_lshlrev_b32 v74, 16, v103
    v_and_b32 v75, 0xffff0000, v103
    v_mul_f32 v74, v74, v116
    v_mfma_f32_32x32x16_bf16 v[192:207], a[172:175], a[112:115], v[192:207]
    ds_read_b128 a[132:135], v48 offset:1024
    ds_read_b64_tr_b16 a[156:157], v37 offset:61440
    v_mul_f32 v75, v75, v117
    v_cvt_pk_bf16_f32 v73, v74, v75
    v_lshlrev_b32 v74, 16, v73
    v_mfma_f32_32x32x16_bf16 v[208:223], a[172:175], a[116:119], v[208:223]
    ds_read_b64_tr_b16 a[158:159], v37 offset:64512
    ds_read_b64_tr_b16 a[160:161], v40 offset:61440
    s_add_u32 m0, s28, 49152
    s_nop 0
    buffer_load_dwordx4 v34, s[4:7], s78 offen lds
    v_mfma_f32_32x32x16_bf16 v[224:239], a[176:179], a[112:115], v[224:239]
    ds_read_b64_tr_b16 a[162:163], v40 offset:64512
    ds_read_b64_tr_b16 a[164:165], v43 offset:61440
    v_and_b32 v75, 0xffff0000, v73
    v_add_f32 v77, v77, v74
    v_add_f32 v77, v77, v75
    v_mfma_f32_32x32x16_bf16 v[240:255], a[176:179], a[116:119], v[240:255]
    ds_read_b64_tr_b16 a[166:167], v43 offset:64512
    v_lshlrev_b32 v74, 16, v104
    v_and_b32 v75, 0xffff0000, v104
    v_mul_f32 v74, v74, v118
    v_mul_f32 v75, v75, v119
    v_cvt_pk_bf16_f32 v73, v74, v75
    v_lshlrev_b32 v74, 16, v73
    v_and_b32 v75, 0xffff0000, v73
    v_add_f32 v77, v77, v74
    v_add_f32 v77, v77, v75
    v_lshlrev_b32 v74, 16, v105
    v_and_b32 v75, 0xffff0000, v105
    v_mul_f32 v74, v74, v120
    v_mul_f32 v75, v75, v121
    v_cvt_pk_bf16_f32 v73, v74, v75
    v_lshlrev_b32 v74, 16, v73
    v_mfma_f32_32x32x16_bf16 v[160:175], a[144:147], a[120:123], v[160:175]
    ds_read_b128 a[136:139], v48 offset:4096
    ds_read_b128 a[140:143], v48 offset:5120
    buffer_load_dwordx4 v35, s[4:7], s78 offen offset:1024 lds
    v_and_b32 v75, 0xffff0000, v73
    v_mfma_f32_32x32x16_bf16 v[176:191], a[144:147], a[124:127], v[176:191]
    ds_read_b64_tr_b16 a[168:169], v38 offset:2048
    ds_read_b64_tr_b16 a[170:171], v38 offset:5120
    v_add_f32 v77, v77, v74
    v_add_f32 v77, v77, v75
    v_add_f32_dpp v76, v76, v76 row_shr:1 row_mask:0xf bank_mask:0xf bound_ctrl:0
    v_mfma_f32_32x32x16_bf16 v[192:207], a[148:151], a[120:123], v[192:207]
    ds_read_b64_tr_b16 a[172:173], v41 offset:2048
    ds_read_b64_tr_b16 a[174:175], v41 offset:5120
    v_add_f32_dpp v77, v77, v77 row_shr:1 row_mask:0xf bank_mask:0xf bound_ctrl:0
    v_add_f32_dpp v76, v76, v76 row_shr:2 row_mask:0xf bank_mask:0xf bound_ctrl:0
    s_nop 0
    v_add_f32_dpp v77, v77, v77 row_shr:2 row_mask:0xf bank_mask:0xf bound_ctrl:0
    v_mfma_f32_32x32x16_bf16 v[208:223], a[148:151], a[124:127], v[208:223]
    ds_read_b64_tr_b16 a[176:177], v44 offset:2048
    ds_read_b64_tr_b16 a[178:179], v44 offset:5120
    buffer_load_dwordx4 v36, s[4:7], s78 offen offset:2048 lds
    v_add_f32_dpp v76, v76, v76 row_shr:4 row_mask:0xf bank_mask:0xf bound_ctrl:0
    v_mfma_f32_32x32x16_bf16 v[224:239], a[152:155], a[120:123], v[224:239]
    v_add_f32_dpp v77, v77, v77 row_shr:4 row_mask:0xf bank_mask:0xf bound_ctrl:0
    v_add_f32_dpp v76, v76, v76 row_shr:8 row_mask:0xf bank_mask:0xf bound_ctrl:0
    s_nop 0
    v_add_f32_dpp v77, v77, v77 row_shr:8 row_mask:0xf bank_mask:0xf bound_ctrl:0
    v_add_f32_dpp v76, v76, v76 row_bcast:15 row_mask:0xa bank_mask:0xf
    s_nop 0
    v_add_f32_dpp v77, v77, v77 row_bcast:15 row_mask:0xa bank_mask:0xf
    v_mfma_f32_32x32x16_bf16 v[240:255], a[152:155], a[124:127], v[240:255]
    v_add_f32_dpp v76, v76, v76 row_bcast:31 row_mask:0xc bank_mask:0xf
    v_add_f32_dpp v77, v77, v77 row_bcast:31 row_mask:0xc bank_mask:0xf
    v_readlane_b32 s55, v76, 63
    s_nop 1
    v_mov_b32 v76, s55
    v_cvt_pk_bf16_f32 v76, v76, v76
    v_lshlrev_b32 v76, 16, v76
    v_mul_f32 v76, 0xbfb8aa3b, v76
    v_exp_f32 v76, v76
    s_nop 0
    v_add_f32 v76, 1.0, v76
    v_rcp_f32 v76, v76
    s_waitcnt lgkmcnt(8)
    v_mfma_f32_32x32x16_bf16 v[160:175], a[156:159], a[128:131], v[160:175]
    s_waitcnt vmcnt(12)
    s_waitcnt lgkmcnt(0)
    s_barrier
    v_mfma_f32_32x32x16_bf16 v[176:191], a[156:159], a[132:135], v[176:191]
    ds_read_b64_tr_b16 a[144:145], v37 offset:0
    ds_read_b64_tr_b16 a[146:147], v37 offset:3072
    s_add_u32 m0, s28, 61440
    s_nop 0
    buffer_load_dwordx4 v34, s[4:7], s79 offen lds
    v_mfma_f32_32x32x16_bf16 v[192:207], a[160:163], a[128:131], v[192:207]
    ds_read_b64_tr_b16 a[148:149], v40 offset:0
    ds_read_b64_tr_b16 a[150:151], v40 offset:3072
    buffer_load_dwordx4 v35, s[4:7], s79 offen offset:1024 lds
    v_cvt_pk_bf16_f32 v80, v76, v76
    v_mfma_f32_32x32x16_bf16 v[208:223], a[160:163], a[132:135], v[208:223]
    ds_read_b64_tr_b16 a[152:153], v43 offset:0
    ds_read_b64_tr_b16 a[154:155], v43 offset:3072
    buffer_load_dwordx4 v36, s[4:7], s79 offen offset:2048 lds
    v_lshlrev_b32 v80, 16, v80
    v_mfma_f32_32x32x16_bf16 v[224:239], a[164:167], a[128:131], v[224:239]
    s_add_u32 m0, s28, 81920
    s_nop 0
    buffer_load_dwordx4 v34, s[4:7], s80 offen lds
    v_sub_f32 v81, 1.0, v80
    v_cvt_pk_bf16_f32 v81, v81, v81
    v_mfma_f32_32x32x16_bf16 v[240:255], a[164:167], a[132:135], v[240:255]
    buffer_load_dwordx4 v35, s[4:7], s80 offen offset:1024 lds
    v_lshlrev_b32 v81, 16, v81
    v_readlane_b32 s55, v77, 63
    s_nop 1
    v_mov_b32 v77, s55
    v_cvt_pk_bf16_f32 v77, v77, v77
    v_lshlrev_b32 v77, 16, v77
    v_mul_f32 v77, 0xbfb8aa3b, v77
    v_exp_f32 v77, v77
    s_nop 0
    v_add_f32 v77, 1.0, v77
    v_rcp_f32 v77, v77
    s_nop 0
    v_cvt_pk_bf16_f32 v82, v77, v77
    v_lshlrev_b32 v82, 16, v82
    v_sub_f32 v83, 1.0, v82
    v_cvt_pk_bf16_f32 v83, v83, v83
    v_lshlrev_b32 v83, 16, v83
    v_mov_b32 v74, s3
    buffer_store_dwordx4 v[80:83], v74, s[16:19], 0 offen
    v_mfma_f32_32x32x16_bf16 v[160:175], a[168:171], a[136:139], v[160:175]
    ds_read_b64_tr_b16 a[156:157], v37 offset:6144
    ds_read_b64_tr_b16 a[158:159], v37 offset:9216
    buffer_load_dwordx4 v36, s[4:7], s80 offen offset:2048 lds
    v_mfma_f32_32x32x16_bf16 v[176:191], a[168:171], a[140:143], v[176:191]
    ds_read_b64_tr_b16 a[160:161], v40 offset:6144
    ds_read_b64_tr_b16 a[162:163], v40 offset:9216
    s_add_u32 m0, s28, 94208
    s_nop 0
    buffer_load_dwordx4 v34, s[4:7], s81 offen lds
    v_mfma_f32_32x32x16_bf16 v[192:207], a[172:175], a[136:139], v[192:207]
    ds_read_b64_tr_b16 a[164:165], v43 offset:6144
    ds_read_b64_tr_b16 a[166:167], v43 offset:9216
    buffer_load_dwordx4 v35, s[4:7], s81 offen offset:1024 lds
    v_mfma_f32_32x32x16_bf16 v[208:223], a[172:175], a[140:143], v[208:223]
    buffer_load_dwordx4 v36, s[4:7], s81 offen offset:2048 lds
    v_mfma_f32_32x32x16_bf16 v[224:239], a[176:179], a[136:139], v[224:239]
    s_add_u32 m0, s28, 106496
    s_nop 0
    buffer_load_dwordx4 v34, s[4:7], s82 offen lds
    v_mfma_f32_32x32x16_bf16 v[240:255], a[176:179], a[140:143], v[240:255]
    buffer_load_dwordx4 v35, s[4:7], s82 offen offset:1024 lds
    s_waitcnt lgkmcnt(6)
    v_mfma_f32_32x32x16_bf16 v[64:79], a[144:147], a[0:3], 0
    s_waitcnt vmcnt(21)
    s_waitcnt lgkmcnt(0)
    s_barrier
    v_mfma_f32_32x32x16_bf16 v[80:95], a[144:147], a[4:7], 0
    ds_read_b64_tr_b16 a[168:169], v37 offset:12288
    ds_read_b64_tr_b16 a[170:171], v37 offset:15360
    buffer_load_dwordx4 v36, s[4:7], s82 offen offset:2048 lds
    s_add_u32 s26, s25, 0
    v_mfma_f32_32x32x16_bf16 v[96:111], a[148:151], a[0:3], 0
    ds_read_b64_tr_b16 a[172:173], v40 offset:12288
    ds_read_b64_tr_b16 a[174:175], v40 offset:15360
    s_add_u32 s4, s4, 384
    s_addc_u32 s5, s5, 0
    s_add_u32 m0, s28, 118784
    s_nop 0
    buffer_load_dwordx4 v34, s[4:7], s74 offen lds
    v_mfma_f32_32x32x16_bf16 v[112:127], a[148:151], a[4:7], 0
    ds_read_b64_tr_b16 a[176:177], v43 offset:12288
    ds_read_b64_tr_b16 a[178:179], v43 offset:15360
    buffer_load_dwordx4 v35, s[4:7], s74 offen offset:1024 lds
    v_cvt_pk_bf16_f32 v56, v160, v161
    v_mfma_f32_32x32x16_bf16 v[128:143], a[152:155], a[0:3], 0
    buffer_load_dwordx4 v36, s[4:7], s74 offen offset:2048 lds
    v_cvt_pk_bf16_f32 v57, v162, v163
    buffer_store_dwordx2 v[56:57], v46, s[16:19], s26 offen
    v_mfma_f32_32x32x16_bf16 v[144:159], a[152:155], a[4:7], 0
    s_add_u32 m0, s28, 131072
    s_nop 0
    buffer_load_dwordx4 v34, s[4:7], s75 offen lds
    v_cvt_pk_bf16_f32 v58, v176, v177
    v_cvt_pk_bf16_f32 v59, v178, v179
    buffer_store_dwordx2 v[58:59], v46, s[16:19], s26 offen offset:256
    v_mfma_f32_32x32x16_bf16 v[64:79], a[156:159], a[8:11], v[64:79]
    ds_read_b64_tr_b16 a[144:145], v37 offset:18432
    ds_read_b64_tr_b16 a[146:147], v37 offset:21504
    buffer_load_dwordx4 v35, s[4:7], s75 offen offset:1024 lds
    s_add_u32 s26, s25, 524288
    v_mfma_f32_32x32x16_bf16 v[80:95], a[156:159], a[12:15], v[80:95]
    ds_read_b64_tr_b16 a[148:149], v40 offset:18432
    ds_read_b64_tr_b16 a[150:151], v40 offset:21504
    v_cvt_pk_bf16_f32 v60, v164, v165
    v_cvt_pk_bf16_f32 v61, v166, v167
    v_mfma_f32_32x32x16_bf16 v[96:111], a[160:163], a[8:11], v[96:111]
    ds_read_b64_tr_b16 a[152:153], v43 offset:18432
    ds_read_b64_tr_b16 a[154:155], v43 offset:21504
    buffer_store_dwordx2 v[60:61], v46, s[16:19], s26 offen
    v_cvt_pk_bf16_f32 v62, v180, v181
    v_mfma_f32_32x32x16_bf16 v[112:127], a[160:163], a[12:15], v[112:127]
    buffer_load_dwordx4 v36, s[4:7], s75 offen offset:2048 lds
    v_cvt_pk_bf16_f32 v63, v182, v183
    buffer_store_dwordx2 v[62:63], v46, s[16:19], s26 offen offset:256
    v_mfma_f32_32x32x16_bf16 v[128:143], a[164:167], a[8:11], v[128:143]
    v_mfma_f32_32x32x16_bf16 v[144:159], a[164:167], a[12:15], v[144:159]
    s_waitcnt lgkmcnt(6)
    v_mfma_f32_32x32x16_bf16 v[64:79], a[168:171], a[16:19], v[64:79]
    s_waitcnt vmcnt(29)
    s_waitcnt lgkmcnt(0)
    s_barrier
    v_mfma_f32_32x32x16_bf16 v[80:95], a[168:171], a[20:23], v[80:95]
    ds_read_b64_tr_b16 a[156:157], v37 offset:24576
    ds_read_b64_tr_b16 a[158:159], v37 offset:27648
    s_add_u32 m0, s28, 143360
    s_nop 0
    buffer_load_dwordx4 v34, s[4:7], s76 offen lds
    v_mfma_f32_32x32x16_bf16 v[96:111], a[172:175], a[16:19], v[96:111]
    ds_read_b64_tr_b16 a[160:161], v40 offset:24576
    ds_read_b64_tr_b16 a[162:163], v40 offset:27648
    buffer_load_dwordx4 v35, s[4:7], s76 offen offset:1024 lds
    s_add_u32 s26, s25, 1048576
    v_mfma_f32_32x32x16_bf16 v[112:127], a[172:175], a[20:23], v[112:127]
    ds_read_b64_tr_b16 a[164:165], v43 offset:24576
    ds_read_b64_tr_b16 a[166:167], v43 offset:27648
    v_cvt_pk_bf16_f32 v56, v168, v169
    v_cvt_pk_bf16_f32 v57, v170, v171
    v_mfma_f32_32x32x16_bf16 v[128:143], a[176:179], a[16:19], v[128:143]
    buffer_store_dwordx2 v[56:57], v46, s[16:19], s26 offen
    v_cvt_pk_bf16_f32 v58, v184, v185
    v_cvt_pk_bf16_f32 v59, v186, v187
    v_mfma_f32_32x32x16_bf16 v[144:159], a[176:179], a[20:23], v[144:159]
    buffer_load_dwordx4 v36, s[4:7], s76 offen offset:2048 lds
    v_mfma_f32_32x32x16_bf16 v[64:79], a[144:147], a[24:27], v[64:79]
    ds_read_b64_tr_b16 a[168:169], v37 offset:30720
    ds_read_b64_tr_b16 a[170:171], v37 offset:33792
    buffer_store_dwordx2 v[58:59], v46, s[16:19], s26 offen offset:256
    s_add_u32 s26, s25, 1572864
    v_mfma_f32_32x32x16_bf16 v[80:95], a[144:147], a[28:31], v[80:95]
    ds_read_b64_tr_b16 a[172:173], v40 offset:30720
    ds_read_b64_tr_b16 a[174:175], v40 offset:33792
    v_cvt_pk_bf16_f32 v60, v172, v173
    v_cvt_pk_bf16_f32 v61, v174, v175
    v_mfma_f32_32x32x16_bf16 v[96:111], a[148:151], a[24:27], v[96:111]
    ds_read_b64_tr_b16 a[176:177], v43 offset:30720
    ds_read_b64_tr_b16 a[178:179], v43 offset:33792
    s_add_u32 m0, s28, 0
    s_nop 0
    buffer_load_dwordx4 v34, s[4:7], s77 offen lds
    v_mfma_f32_32x32x16_bf16 v[112:127], a[148:151], a[28:31], v[112:127]
    buffer_store_dwordx2 v[60:61], v46, s[16:19], s26 offen
    v_mfma_f32_32x32x16_bf16 v[128:143], a[152:155], a[24:27], v[128:143]
    v_mfma_f32_32x32x16_bf16 v[144:159], a[152:155], a[28:31], v[144:159]
    buffer_load_dwordx4 v35, s[4:7], s77 offen offset:1024 lds
    s_waitcnt lgkmcnt(6)
    v_mfma_f32_32x32x16_bf16 v[64:79], a[156:159], a[32:35], v[64:79]
    s_waitcnt vmcnt(34)
    s_waitcnt lgkmcnt(0)
    s_barrier
    v_mfma_f32_32x32x16_bf16 v[80:95], a[156:159], a[36:39], v[80:95]
    v_min_u32 v55, 4, v0
    s_mul_i32 s55, s2, 5
    v_add_u32 v55, s55, v55
    v_min_u32 v55, 1151, v55
    v_lshlrev_b32 v55, 7, v55
    v_readlane_b32 s40, v54, 0
    v_readlane_b32 s41, v54, 1
    s_nop 4
    global_load_dword v53, v55, s[40:41]
    v_readlane_b32 s40, v54, 2
    v_readlane_b32 s41, v54, 3
    s_nop 4
    global_load_dword v53, v55, s[40:41]
    v_readlane_b32 s40, v54, 4
    v_readlane_b32 s41, v54, 5
    s_nop 4
    global_load_dword v53, v55, s[40:41]
    v_readlane_b32 s40, v54, 6
    v_readlane_b32 s41, v54, 7
    s_nop 4
    global_load_dword v53, v55, s[40:41]
    ds_read_b64_tr_b16 a[144:145], v37 offset:36864
    ds_read_b64_tr_b16 a[146:147], v37 offset:39936
    v_mfma_f32_32x32x16_bf16 v[96:111], a[160:163], a[32:35], v[96:111]
    ds_read_b64_tr_b16 a[148:149], v40 offset:36864
    ds_read_b64_tr_b16 a[150:151], v40 offset:39936
    v_cvt_pk_bf16_f32 v62, v188, v189
    v_cvt_pk_bf16_f32 v63, v190, v191
    v_mfma_f32_32x32x16_bf16 v[112:127], a[160:163], a[36:39], v[112:127]
    ds_read_b64_tr_b16 a[152:153], v43 offset:36864
    ds_read_b64_tr_b16 a[154:155], v43 offset:39936
    buffer_load_dwordx4 v36, s[4:7], s77 offen offset:2048 lds
    v_mfma_f32_32x32x16_bf16 v[128:143], a[164:167], a[32:35], v[128:143]
    buffer_store_dwordx2 v[62:63], v46, s[16:19], s26 offen offset:256
    s_add_u32 s26, s25, 2097152
    v_cvt_pk_bf16_f32 v56, v192, v193
    v_cvt_pk_bf16_f32 v57, v194, v195
    v_mfma_f32_32x32x16_bf16 v[144:159], a[164:167], a[36:39], v[144:159]
    v_mfma_f32_32x32x16_bf16 v[64:79], a[168:171], a[40:43], v[64:79]
    ds_read_b64_tr_b16 a[156:157], v37 offset:43008
    ds_read_b64_tr_b16 a[158:159], v37 offset:46080
    s_add_u32 m0, s28, 12288
    s_nop 0
    buffer_load_dwordx4 v34, s[4:7], s78 offen lds
    v_mfma_f32_32x32x16_bf16 v[80:95], a[168:171], a[44:47], v[80:95]
    ds_read_b64_tr_b16 a[160:161], v40 offset:43008
    ds_read_b64_tr_b16 a[162:163], v40 offset:46080
    buffer_store_dwordx2 v[56:57], v46, s[16:19], s26 offen
    v_cvt_pk_bf16_f32 v58, v208, v209
    v_mfma_f32_32x32x16_bf16 v[96:111], a[172:175], a[40:43], v[96:111]
    ds_read_b64_tr_b16 a[164:165], v43 offset:43008
    ds_read_b64_tr_b16 a[166:167], v43 offset:46080
    v_cvt_pk_bf16_f32 v59, v210, v211
    buffer_store_dwordx2 v[58:59], v46, s[16:19], s26 offen offset:256
    v_mfma_f32_32x32x16_bf16 v[112:127], a[172:175], a[44:47], v[112:127]
    buffer_load_dwordx4 v35, s[4:7], s78 offen offset:1024 lds
    s_add_u32 s26, s25, 2621440
    v_mfma_f32_32x32x16_bf16 v[128:143], a[176:179], a[40:43], v[128:143]
    v_mfma_f32_32x32x16_bf16 v[144:159], a[176:179], a[44:47], v[144:159]
    s_waitcnt lgkmcnt(6)
    v_mfma_f32_32x32x16_bf16 v[64:79], a[144:147], a[48:51], v[64:79]
    s_waitcnt vmcnt(41)
    s_waitcnt lgkmcnt(0)
    s_barrier
    v_mfma_f32_32x32x16_bf16 v[80:95], a[144:147], a[52:55], v[80:95]
    ds_read_b64_tr_b16 a[168:169], v37 offset:49152
    ds_read_b64_tr_b16 a[170:171], v37 offset:52224
    buffer_load_dwordx4 v36, s[4:7], s78 offen offset:2048 lds
    v_cvt_pk_bf16_f32 v60, v196, v197
    v_mfma_f32_32x32x16_bf16 v[96:111], a[148:151], a[48:51], v[96:111]
    ds_read_b64_tr_b16 a[172:173], v40 offset:49152
    ds_read_b64_tr_b16 a[174:175], v40 offset:52224
    v_cvt_pk_bf16_f32 v61, v198, v199
    buffer_store_dwordx2 v[60:61], v46, s[16:19], s26 offen
    v_mfma_f32_32x32x16_bf16 v[112:127], a[148:151], a[52:55], v[112:127]
    ds_read_b64_tr_b16 a[176:177], v43 offset:49152
    ds_read_b64_tr_b16 a[178:179], v43 offset:52224
    v_cvt_pk_bf16_f32 v62, v212, v213
    v_cvt_pk_bf16_f32 v63, v214, v215
    v_mfma_f32_32x32x16_bf16 v[128:143], a[152:155], a[48:51], v[128:143]
    s_add_u32 m0, s28, 24576
    s_nop 0
    buffer_load_dwordx4 v34, s[4:7], s79 offen lds
    buffer_store_dwordx2 v[62:63], v46, s[16:19], s26 offen offset:256
    v_mfma_f32_32x32x16_bf16 v[144:159], a[152:155], a[52:55], v[144:159]
    v_mfma_f32_32x32x16_bf16 v[64:79], a[156:159], a[56:59], v[64:79]
    ds_read_b64_tr_b16 a[144:145], v37 offset:55296
    ds_read_b64_tr_b16 a[146:147], v37 offset:58368
    s_add_u32 s26, s25, 3145728
    v_cvt_pk_bf16_f32 v56, v200, v201
    v_cvt_pk_bf16_f32 v57, v202, v203
    v_mfma_f32_32x32x16_bf16 v[80:95], a[156:159], a[60:63], v[80:95]
    ds_read_b64_tr_b16 a[148:149], v40 offset:55296
    ds_read_b64_tr_b16 a[150:151], v40 offset:58368
    buffer_load_dwordx4 v35, s[4:7], s79 offen offset:1024 lds
    v_mfma_f32_32x32x16_bf16 v[96:111], a[160:163], a[56:59], v[96:111]
    ds_read_b64_tr_b16 a[152:153], v43 offset:55296
    ds_read_b64_tr_b16 a[154:155], v43 offset:58368
    buffer_store_dwordx2 v[56:57], v46, s[16:19], s26 offen
    v_cvt_pk_bf16_f32 v58, v216, v217
    v_mfma_f32_32x32x16_bf16 v[112:127], a[160:163], a[60:63], v[112:127]
    v_cvt_pk_bf16_f32 v59, v218, v219
    v_mfma_f32_32x32x16_bf16 v[128:143], a[164:167], a[56:59], v[128:143]
    buffer_load_dwordx4 v36, s[4:7], s79 offen offset:2048 lds
    v_mfma_f32_32x32x16_bf16 v[144:159], a[164:167], a[60:63], v[144:159]
    s_waitcnt lgkmcnt(6)
    v_mfma_f32_32x32x16_bf16 v[64:79], a[168:171], a[64:67], v[64:79]
    s_waitcnt vmcnt(45)
    s_waitcnt lgkmcnt(0)
    s_barrier
    v_mfma_f32_32x32x16_bf16 v[80:95], a[168:171], a[68:71], v[80:95]
    ds_read_b64_tr_b16 a[156:157], v37 offset:61440
    ds_read_b64_tr_b16 a[158:159], v37 offset:64512
    buffer_store_dwordx2 v[58:59], v46, s[16:19], s26 offen offset:256
    s_add_u32 s26, s25, 3670016
    v_mfma_f32_32x32x16_bf16 v[96:111], a[172:175], a[64:67], v[96:111]
    ds_read_b64_tr_b16 a[160:161], v40 offset:61440
    ds_read_b64_tr_b16 a[162:163], v40 offset:64512
    s_add_u32 m0, s28, 36864
    s_nop 0
    buffer_load_dwordx4 v34, s[4:7], s80 offen lds
    v_mfma_f32_32x32x16_bf16 v[112:127], a[172:175], a[68:71], v[112:127]
    ds_read_b64_tr_b16 a[164:165], v43 offset:61440
    ds_read_b64_tr_b16 a[166:167], v43 offset:64512
    v_cvt_pk_bf16_f32 v60, v204, v205
    v_cvt_pk_bf16_f32 v61, v206, v207
    v_mfma_f32_32x32x16_bf16 v[128:143], a[176:179], a[64:67], v[128:143]
    buffer_store_dwordx2 v[60:61], v46, s[16:19], s26 offen
    v_mfma_f32_32x32x16_bf16 v[144:159], a[176:179], a[68:71], v[144:159]
    buffer_load_dwordx4 v35, s[4:7], s80 offen offset:1024 lds
    v_mfma_f32_32x32x16_bf16 v[64:79], a[144:147], a[72:75], v[64:79]
    ds_read_b64_tr_b16 a[168:169], v38 offset:2048
    ds_read_b64_tr_b16 a[170:171], v38 offset:5120
    v_cvt_pk_bf16_f32 v62, v220, v221
    v_cvt_pk_bf16_f32 v63, v222, v223
    v_mfma_f32_32x32x16_bf16 v[80:95], a[144:147], a[76:79], v[80:95]
    ds_read_b64_tr_b16 a[172:173], v41 offset:2048
    ds_read_b64_tr_b16 a[174:175], v41 offset:5120
    buffer_store_dwordx2 v[62:63], v46, s[16:19], s26 offen offset:256
    s_add_u32 s26, s25, 4194304
    v_mfma_f32_32x32x16_bf16 v[96:111], a[148:151], a[72:75], v[96:111]
    ds_read_b64_tr_b16 a[176:177], v44 offset:2048
    ds_read_b64_tr_b16 a[178:179], v44 offset:5120
    buffer_load_dwordx4 v36, s[4:7], s80 offen offset:2048 lds
    v_cvt_pk_bf16_f32 v56, v224, v225
    v_mfma_f32_32x32x16_bf16 v[112:127], a[148:151], a[76:79], v[112:127]
    v_cvt_pk_bf16_f32 v57, v226, v227
    v_mfma_f32_32x32x16_bf16 v[128:143], a[152:155], a[72:75], v[128:143]
    v_mfma_f32_32x32x16_bf16 v[144:159], a[152:155], a[76:79], v[144:159]
    s_add_u32 m0, s28, 49152
    s_nop 0
    buffer_load_dwordx4 v34, s[4:7], s81 offen lds
    s_waitcnt lgkmcnt(6)
    v_mfma_f32_32x32x16_bf16 v[64:79], a[156:159], a[80:83], v[64:79]
    s_waitcnt vmcnt(48)
    s_waitcnt lgkmcnt(0)
    s_barrier
    v_mfma_f32_32x32x16_bf16 v[80:95], a[156:159], a[84:87], v[80:95]
    ds_read_b64_tr_b16 a[144:145], v38 offset:16384
    ds_read_b64_tr_b16 a[146:147], v38 offset:19456
    buffer_store_dwordx2 v[56:57], v46, s[16:19], s26 offen
    v_cvt_pk_bf16_f32 v58, v240, v241
    v_mfma_f32_32x32x16_bf16 v[96:111], a[160:163], a[80:83], v[96:111]
    ds_read_b64_tr_b16 a[148:149], v41 offset:16384
    ds_read_b64_tr_b16 a[150:151], v41 offset:19456
    v_cvt_pk_bf16_f32 v59, v242, v243
    buffer_store_dwordx2 v[58:59], v46, s[16:19], s26 offen offset:256
    v_mfma_f32_32x32x16_bf16 v[112:127], a[160:163], a[84:87], v[112:127]
    ds_read_b64_tr_b16 a[152:153], v44 offset:16384
    ds_read_b64_tr_b16 a[154:155], v44 offset:19456
    buffer_load_dwordx4 v35, s[4:7], s81 offen offset:1024 lds
    s_add_u32 s26, s25, 4718592
    v_mfma_f32_32x32x16_bf16 v[128:143], a[164:167], a[80:83], v[128:143]
    v_mfma_f32_32x32x16_bf16 v[144:159], a[164:167], a[84:87], v[144:159]
    v_mfma_f32_32x32x16_bf16 v[64:79], a[168:171], a[88:91], v[64:79]
    ds_read_b64_tr_b16 a[156:157], v38 offset:22528
    ds_read_b64_tr_b16 a[158:159], v38 offset:25600
    buffer_load_dwordx4 v36, s[4:7], s81 offen offset:2048 lds
    v_cvt_pk_bf16_f32 v60, v228, v229
    v_mfma_f32_32x32x16_bf16 v[80:95], a[168:171], a[92:95], v[80:95]
    ds_read_b64_tr_b16 a[160:161], v41 offset:22528
    ds_read_b64_tr_b16 a[162:163], v41 offset:25600
    v_cvt_pk_bf16_f32 v61, v230, v231
    buffer_store_dwordx2 v[60:61], v46, s[16:19], s26 offen
    v_mfma_f32_32x32x16_bf16 v[96:111], a[172:175], a[88:91], v[96:111]
    ds_read_b64_tr_b16 a[164:165], v44 offset:22528
    ds_read_b64_tr_b16 a[166:167], v44 offset:25600
    v_cvt_pk_bf16_f32 v62, v244, v245
    v_cvt_pk_bf16_f32 v63, v246, v247
    v_mfma_f32_32x32x16_bf16 v[112:127], a[172:175], a[92:95], v[112:127]
    s_add_u32 m0, s28, 61440
    s_nop 0
    buffer_load_dwordx4 v34, s[4:7], s82 offen lds
    buffer_store_dwordx2 v[62:63], v46, s[16:19], s26 offen offset:256
    v_mfma_f32_32x32x16_bf16 v[128:143], a[176:179], a[88:91], v[128:143]
    v_mfma_f32_32x32x16_bf16 v[144:159], a[176:179], a[92:95], v[144:159]
    s_waitcnt lgkmcnt(6)
    v_mfma_f32_32x32x16_bf16 v[64:79], a[144:147], a[96:99], v[64:79]
    s_waitcnt vmcnt(52)
    s_waitcnt lgkmcnt(0)
    s_barrier
    v_mfma_f32_32x32x16_bf16 v[80:95], a[144:147], a[100:103], v[80:95]
    ds_read_b64_tr_b16 a[168:169], v38 offset:28672
    ds_read_b64_tr_b16 a[170:171], v38 offset:31744
    buffer_load_dwordx4 v35, s[4:7], s82 offen offset:1024 lds
    s_add_u32 s26, s25, 5242880
    v_mfma_f32_32x32x16_bf16 v[96:111], a[148:151], a[96:99], v[96:111]
    ds_read_b64_tr_b16 a[172:173], v41 offset:28672
    ds_read_b64_tr_b16 a[174:175], v41 offset:31744
    v_cvt_pk_bf16_f32 v56, v232, v233
    v_cvt_pk_bf16_f32 v57, v234, v235
    v_mfma_f32_32x32x16_bf16 v[112:127], a[148:151], a[100:103], v[112:127]
    ds_read_b64_tr_b16 a[176:177], v44 offset:28672
    ds_read_b64_tr_b16 a[178:179], v44 offset:31744
    buffer_store_dwordx2 v[56:57], v46, s[16:19], s26 offen
    v_cvt_pk_bf16_f32 v58, v248, v249
    v_mfma_f32_32x32x16_bf16 v[128:143], a[152:155], a[96:99], v[128:143]
    buffer_load_dwordx4 v36, s[4:7], s82 offen offset:2048 lds
    v_mfma_f32_32x32x16_bf16 v[144:159], a[152:155], a[100:103], v[144:159]
    v_mfma_f32_32x32x16_bf16 v[64:79], a[156:159], a[104:107], v[64:79]
    ds_read_b64_tr_b16 a[144:145], v38 offset:34816
    ds_read_b64_tr_b16 a[146:147], v38 offset:37888
    v_cvt_pk_bf16_f32 v59, v250, v251
    buffer_store_dwordx2 v[58:59], v46, s[16:19], s26 offen offset:256
    v_mfma_f32_32x32x16_bf16 v[80:95], a[156:159], a[108:111], v[80:95]
    ds_read_b64_tr_b16 a[148:149], v41 offset:34816
    ds_read_b64_tr_b16 a[150:151], v41 offset:37888
    s_add_u32 s26, s25, 5767168
    v_cvt_pk_bf16_f32 v60, v236, v237
    v_cvt_pk_bf16_f32 v61, v238, v239
    v_mfma_f32_32x32x16_bf16 v[96:111], a[160:163], a[104:107], v[96:111]
    ds_read_b64_tr_b16 a[152:153], v44 offset:34816
    ds_read_b64_tr_b16 a[154:155], v44 offset:37888
    v_mfma_f32_32x32x16_bf16 v[112:127], a[160:163], a[108:111], v[112:127]
    v_mfma_f32_32x32x16_bf16 v[128:143], a[164:167], a[104:107], v[128:143]
    v_mfma_f32_32x32x16_bf16 v[144:159], a[164:167], a[108:111], v[144:159]
    s_waitcnt lgkmcnt(6)
    v_mfma_f32_32x32x16_bf16 v[64:79], a[168:171], a[112:115], v[64:79]
    s_waitcnt vmcnt(53)
    s_waitcnt lgkmcnt(0)
    s_barrier
    v_mfma_f32_32x32x16_bf16 v[80:95], a[168:171], a[116:119], v[80:95]
    ds_read_b64_tr_b16 a[156:157], v38 offset:40960
    ds_read_b64_tr_b16 a[158:159], v38 offset:44032
    buffer_store_dwordx2 v[60:61], v46, s[16:19], s26 offen
    v_cvt_pk_bf16_f32 v62, v252, v253
    v_mfma_f32_32x32x16_bf16 v[96:111], a[172:175], a[112:115], v[96:111]
    ds_read_b64_tr_b16 a[160:161], v41 offset:40960
    ds_read_b64_tr_b16 a[162:163], v41 offset:44032
    v_cvt_pk_bf16_f32 v63, v254, v255
    buffer_store_dwordx2 v[62:63], v46, s[16:19], s26 offen offset:256
    v_mfma_f32_32x32x16_bf16 v[112:127], a[172:175], a[116:119], v[112:127]
    ds_read_b64_tr_b16 a[164:165], v44 offset:40960
    ds_read_b64_tr_b16 a[166:167], v44 offset:44032
    v_mfma_f32_32x32x16_bf16 v[128:143], a[176:179], a[112:115], v[128:143]
    v_mfma_f32_32x32x16_bf16 v[144:159], a[176:179], a[116:119], v[144:159]
    v_mfma_f32_32x32x16_bf16 v[64:79], a[144:147], a[120:123], v[64:79]
    ds_read_b64_tr_b16 a[168:169], v38 offset:47104
    ds_read_b64_tr_b16 a[170:171], v38 offset:50176
    v_mfma_f32_32x32x16_bf16 v[80:95], a[144:147], a[124:127], v[80:95]
    ds_read_b64_tr_b16 a[172:173], v41 offset:47104
    ds_read_b64_tr_b16 a[174:175], v41 offset:50176
    v_mfma_f32_32x32x16_bf16 v[96:111], a[148:151], a[120:123], v[96:111]
    ds_read_b64_tr_b16 a[176:177], v44 offset:47104
    ds_read_b64_tr_b16 a[178:179], v44 offset:50176
    v_mfma_f32_32x32x16_bf16 v[112:127], a[148:151], a[124:127], v[112:127]
    v_mfma_f32_32x32x16_bf16 v[128:143], a[152:155], a[120:123], v[128:143]
    v_mfma_f32_32x32x16_bf16 v[144:159], a[152:155], a[124:127], v[144:159]
    s_waitcnt lgkmcnt(6)
    v_mfma_f32_32x32x16_bf16 v[64:79], a[156:159], a[128:131], v[64:79]
    s_waitcnt vmcnt(52)
    s_waitcnt lgkmcnt(0)
    s_barrier
    v_mfma_f32_32x32x16_bf16 v[80:95], a[156:159], a[132:135], v[80:95]
    ds_read_b64_tr_b16 a[144:145], v38 offset:53248
    ds_read_b64_tr_b16 a[146:147], v38 offset:56320
    v_mfma_f32_32x32x16_bf16 v[96:111], a[160:163], a[128:131], v[96:111]
    ds_read_b64_tr_b16 a[148:149], v41 offset:53248
    ds_read_b64_tr_b16 a[150:151], v41 offset:56320
    v_mfma_f32_32x32x16_bf16 v[112:127], a[160:163], a[132:135], v[112:127]
    ds_read_b64_tr_b16 a[152:153], v44 offset:53248
    ds_read_b64_tr_b16 a[154:155], v44 offset:56320
    v_mfma_f32_32x32x16_bf16 v[128:143], a[164:167], a[128:131], v[128:143]
    v_mfma_f32_32x32x16_bf16 v[144:159], a[164:167], a[132:135], v[144:159]
    v_mfma_f32_32x32x16_bf16 v[64:79], a[168:171], a[136:139], v[64:79]
    ds_read_b64_tr_b16 a[156:157], v38 offset:59392
    ds_read_b64_tr_b16 a[158:159], v38 offset:62464
    v_mfma_f32_32x32x16_bf16 v[80:95], a[168:171], a[140:143], v[80:95]
    ds_read_b64_tr_b16 a[160:161], v41 offset:59392
    ds_read_b64_tr_b16 a[162:163], v41 offset:62464
    v_mfma_f32_32x32x16_bf16 v[96:111], a[172:175], a[136:139], v[96:111]
    ds_read_b64_tr_b16 a[164:165], v44 offset:59392
    ds_read_b64_tr_b16 a[166:167], v44 offset:62464
    v_mfma_f32_32x32x16_bf16 v[112:127], a[172:175], a[140:143], v[112:127]
    v_mfma_f32_32x32x16_bf16 v[128:143], a[176:179], a[136:139], v[128:143]
    v_mfma_f32_32x32x16_bf16 v[144:159], a[176:179], a[140:143], v[144:159]
    s_waitcnt lgkmcnt(6)
    v_mfma_f32_32x32x16_bf16 v[160:175], a[144:147], a[0:3], 0
    s_waitcnt vmcnt(46)
    s_waitcnt lgkmcnt(0)
    s_barrier
    v_mfma_f32_32x32x16_bf16 v[176:191], a[144:147], a[4:7], 0
    ds_read_b64_tr_b16 a[168:169], v39 offset:0
    ds_read_b64_tr_b16 a[170:171], v39 offset:3072
    s_add_u32 s26, s25, 12582912
    v_cvt_pk_bf16_f32 v56, v64, v65
    v_cvt_pk_bf16_f32 v57, v66, v67
    v_mfma_f32_32x32x16_bf16 v[192:207], a[148:151], a[0:3], 0
    ds_read_b64_tr_b16 a[172:173], v42 offset:0
    ds_read_b64_tr_b16 a[174:175], v42 offset:3072
    buffer_store_dwordx2 v[56:57], v46, s[16:19], s26 offen
    v_cvt_pk_bf16_f32 v58, v80, v81
    v_mfma_f32_32x32x16_bf16 v[208:223], a[148:151], a[4:7], 0
    ds_read_b64_tr_b16 a[176:177], v45 offset:0
    ds_read_b64_tr_b16 a[178:179], v45 offset:3072
    v_cvt_pk_bf16_f32 v59, v82, v83
    buffer_store_dwordx2 v[58:59], v46, s[16:19], s26 offen offset:256
    v_mfma_f32_32x32x16_bf16 v[224:239], a[152:155], a[0:3], 0
    v_mfma_f32_32x32x16_bf16 v[240:255], a[152:155], a[4:7], 0
    v_mfma_f32_32x32x16_bf16 v[160:175], a[156:159], a[8:11], v[160:175]
    ds_read_b64_tr_b16 a[144:145], v39 offset:6144
    ds_read_b64_tr_b16 a[146:147], v39 offset:9216
    s_add_u32 s26, s25, 13107200
    v_cvt_pk_bf16_f32 v60, v68, v69
    v_cvt_pk_bf16_f32 v61, v70, v71
    v_mfma_f32_32x32x16_bf16 v[176:191], a[156:159], a[12:15], v[176:191]
    ds_read_b64_tr_b16 a[148:149], v42 offset:6144
    ds_read_b64_tr_b16 a[150:151], v42 offset:9216
    buffer_store_dwordx2 v[60:61], v46, s[16:19], s26 offen
    v_cvt_pk_bf16_f32 v62, v84, v85
    v_mfma_f32_32x32x16_bf16 v[192:207], a[160:163], a[8:11], v[192:207]
    ds_read_b64_tr_b16 a[152:153], v45 offset:6144
    ds_read_b64_tr_b16 a[154:155], v45 offset:9216
    v_cvt_pk_bf16_f32 v63, v86, v87
    buffer_store_dwordx2 v[62:63], v46, s[16:19], s26 offen offset:256
    v_mfma_f32_32x32x16_bf16 v[208:223], a[160:163], a[12:15], v[208:223]
    v_mfma_f32_32x32x16_bf16 v[224:239], a[164:167], a[8:11], v[224:239]
    v_mfma_f32_32x32x16_bf16 v[240:255], a[164:167], a[12:15], v[240:255]
    s_waitcnt lgkmcnt(6)
    v_mfma_f32_32x32x16_bf16 v[160:175], a[168:171], a[16:19], v[160:175]
    s_waitcnt vmcnt(45)
    s_waitcnt lgkmcnt(0)
    s_barrier
    v_mfma_f32_32x32x16_bf16 v[176:191], a[168:171], a[20:23], v[176:191]
    ds_read_b64_tr_b16 a[156:157], v39 offset:12288
    ds_read_b64_tr_b16 a[158:159], v39 offset:15360
    s_add_u32 s26, s25, 13631488
    v_cvt_pk_bf16_f32 v56, v72, v73
    v_cvt_pk_bf16_f32 v57, v74, v75
    v_mfma_f32_32x32x16_bf16 v[192:207], a[172:175], a[16:19], v[192:207]
    ds_read_b64_tr_b16 a[160:161], v42 offset:12288
    ds_read_b64_tr_b16 a[162:163], v42 offset:15360
    buffer_store_dwordx2 v[56:57], v46, s[16:19], s26 offen
    v_cvt_pk_bf16_f32 v58, v88, v89
    v_mfma_f32_32x32x16_bf16 v[208:223], a[172:175], a[20:23], v[208:223]
    ds_read_b64_tr_b16 a[164:165], v45 offset:12288
    ds_read_b64_tr_b16 a[166:167], v45 offset:15360
    v_cvt_pk_bf16_f32 v59, v90, v91
    v_mfma_f32_32x32x16_bf16 v[224:239], a[176:179], a[16:19], v[224:239]
    v_mfma_f32_32x32x16_bf16 v[240:255], a[176:179], a[20:23], v[240:255]
    v_mfma_f32_32x32x16_bf16 v[160:175], a[144:147], a[24:27], v[160:175]
    ds_read_b64_tr_b16 a[168:169], v39 offset:18432
    ds_read_b64_tr_b16 a[170:171], v39 offset:21504
    buffer_store_dwordx2 v[58:59], v46, s[16:19], s26 offen offset:256
    s_add_u32 s26, s25, 14155776
    v_mfma_f32_32x32x16_bf16 v[176:191], a[144:147], a[28:31], v[176:191]
    ds_read_b64_tr_b16 a[172:173], v42 offset:18432
    ds_read_b64_tr_b16 a[174:175], v42 offset:21504
    v_cvt_pk_bf16_f32 v60, v76, v77
    v_cvt_pk_bf16_f32 v61, v78, v79
    v_mfma_f32_32x32x16_bf16 v[192:207], a[148:151], a[24:27], v[192:207]
    ds_read_b64_tr_b16 a[176:177], v45 offset:18432
    ds_read_b64_tr_b16 a[178:179], v45 offset:21504
    buffer_store_dwordx2 v[60:61], v46, s[16:19], s26 offen
    v_mfma_f32_32x32x16_bf16 v[208:223], a[148:151], a[28:31], v[208:223]
    v_mfma_f32_32x32x16_bf16 v[224:239], a[152:155], a[24:27], v[224:239]
    v_mfma_f32_32x32x16_bf16 v[240:255], a[152:155], a[28:31], v[240:255]
    s_waitcnt lgkmcnt(6)
    v_mfma_f32_32x32x16_bf16 v[160:175], a[156:159], a[32:35], v[160:175]
    s_waitcnt vmcnt(39)
    s_waitcnt lgkmcnt(0)
    s_barrier
    v_mfma_f32_32x32x16_bf16 v[176:191], a[156:159], a[36:39], v[176:191]
    ds_read_b64_tr_b16 a[144:145], v37 offset:0
    ds_read_b64_tr_b16 a[146:147], v37 offset:3072
    v_cvt_pk_bf16_f32 v62, v92, v93
    v_cvt_pk_bf16_f32 v63, v94, v95
    v_mfma_f32_32x32x16_bf16 v[192:207], a[160:163], a[32:35], v[192:207]
    ds_read_b64_tr_b16 a[148:149], v40 offset:0
    ds_read_b64_tr_b16 a[150:151], v40 offset:3072
    buffer_store_dwordx2 v[62:63], v46, s[16:19], s26 offen offset:256
    s_add_u32 s26, s25, 14680064
    v_mfma_f32_32x32x16_bf16 v[208:223], a[160:163], a[36:39], v[208:223]
    ds_read_b64_tr_b16 a[152:153], v43 offset:0
    ds_read_b64_tr_b16 a[154:155], v43 offset:3072
    v_cvt_pk_bf16_f32 v56, v96, v97
    v_cvt_pk_bf16_f32 v57, v98, v99
    v_mfma_f32_32x32x16_bf16 v[224:239], a[164:167], a[32:35], v[224:239]
    v_mfma_f32_32x32x16_bf16 v[240:255], a[164:167], a[36:39], v[240:255]
    v_mfma_f32_32x32x16_bf16 v[160:175], a[168:171], a[40:43], v[160:175]
    ds_read_b64_tr_b16 a[156:157], v37 offset:6144
    ds_read_b64_tr_b16 a[158:159], v37 offset:9216
    buffer_store_dwordx2 v[56:57], v46, s[16:19], s26 offen
    v_cvt_pk_bf16_f32 v58, v112, v113
    v_mfma_f32_32x32x16_bf16 v[176:191], a[168:171], a[44:47], v[176:191]
    ds_read_b64_tr_b16 a[160:161], v40 offset:6144
    ds_read_b64_tr_b16 a[162:163], v40 offset:9216
    v_cvt_pk_bf16_f32 v59, v114, v115
    buffer_store_dwordx2 v[58:59], v46, s[16:19], s26 offen offset:256
    v_mfma_f32_32x32x16_bf16 v[192:207], a[172:175], a[40:43], v[192:207]
    ds_read_b64_tr_b16 a[164:165], v43 offset:6144
    ds_read_b64_tr_b16 a[166:167], v43 offset:9216
    s_add_u32 s26, s25, 15204352
    v_mfma_f32_32x32x16_bf16 v[208:223], a[172:175], a[44:47], v[208:223]
    v_mfma_f32_32x32x16_bf16 v[224:239], a[176:179], a[40:43], v[224:239]
    v_mfma_f32_32x32x16_bf16 v[240:255], a[176:179], a[44:47], v[240:255]
    s_waitcnt lgkmcnt(6)
    v_mfma_f32_32x32x16_bf16 v[160:175], a[144:147], a[48:51], v[160:175]
    s_waitcnt vmcnt(36)
    s_waitcnt lgkmcnt(0)
    s_barrier
    v_mfma_f32_32x32x16_bf16 v[176:191], a[144:147], a[52:55], v[176:191]
    ds_read_b64_tr_b16 a[168:169], v37 offset:12288
    ds_read_b64_tr_b16 a[170:171], v37 offset:15360
    v_cvt_pk_bf16_f32 v60, v100, v101
    v_cvt_pk_bf16_f32 v61, v102, v103
    v_mfma_f32_32x32x16_bf16 v[192:207], a[148:151], a[48:51], v[192:207]
    ds_read_b64_tr_b16 a[172:173], v40 offset:12288
    ds_read_b64_tr_b16 a[174:175], v40 offset:15360
    buffer_store_dwordx2 v[60:61], v46, s[16:19], s26 offen
    v_cvt_pk_bf16_f32 v62, v116, v117
    v_mfma_f32_32x32x16_bf16 v[208:223], a[148:151], a[52:55], v[208:223]
    ds_read_b64_tr_b16 a[176:177], v43 offset:12288
    ds_read_b64_tr_b16 a[178:179], v43 offset:15360
    v_cvt_pk_bf16_f32 v63, v118, v119
    buffer_store_dwordx2 v[62:63], v46, s[16:19], s26 offen offset:256
    v_mfma_f32_32x32x16_bf16 v[224:239], a[152:155], a[48:51], v[224:239]
    v_mfma_f32_32x32x16_bf16 v[240:255], a[152:155], a[52:55], v[240:255]
    v_mfma_f32_32x32x16_bf16 v[160:175], a[156:159], a[56:59], v[160:175]
    ds_read_b64_tr_b16 a[144:145], v37 offset:18432
    ds_read_b64_tr_b16 a[146:147], v37 offset:21504
    s_add_u32 s26, s25, 15728640
    v_cvt_pk_bf16_f32 v56, v104, v105
    v_cvt_pk_bf16_f32 v57, v106, v107
    v_mfma_f32_32x32x16_bf16 v[176:191], a[156:159], a[60:63], v[176:191]
    ds_read_b64_tr_b16 a[148:149], v40 offset:18432
    ds_read_b64_tr_b16 a[150:151], v40 offset:21504
    buffer_store_dwordx2 v[56:57], v46, s[16:19], s26 offen
    v_cvt_pk_bf16_f32 v58, v120, v121
    v_mfma_f32_32x32x16_bf16 v[192:207], a[160:163], a[56:59], v[192:207]
    ds_read_b64_tr_b16 a[152:153], v43 offset:18432
    ds_read_b64_tr_b16 a[154:155], v43 offset:21504
    v_cvt_pk_bf16_f32 v59, v122, v123
    v_mfma_f32_32x32x16_bf16 v[208:223], a[160:163], a[60:63], v[208:223]
    v_mfma_f32_32x32x16_bf16 v[224:239], a[164:167], a[56:59], v[224:239]
    v_mfma_f32_32x32x16_bf16 v[240:255], a[164:167], a[60:63], v[240:255]
    s_waitcnt lgkmcnt(6)
    v_mfma_f32_32x32x16_bf16 v[160:175], a[168:171], a[64:67], v[160:175]
    s_waitcnt vmcnt(33)
    s_waitcnt lgkmcnt(0)
    s_barrier
    v_mfma_f32_32x32x16_bf16 v[176:191], a[168:171], a[68:71], v[176:191]
    ds_read_b64_tr_b16 a[156:157], v37 offset:24576
    ds_read_b64_tr_b16 a[158:159], v37 offset:27648
    buffer_store_dwordx2 v[58:59], v46, s[16:19], s26 offen offset:256
    s_add_u32 s26, s25, 16252928
    v_mfma_f32_32x32x16_bf16 v[192:207], a[172:175], a[64:67], v[192:207]
    ds_read_b64_tr_b16 a[160:161], v40 offset:24576
    ds_read_b64_tr_b16 a[162:163], v40 offset:27648
    v_cvt_pk_bf16_f32 v60, v108, v109
    v_cvt_pk_bf16_f32 v61, v110, v111
    v_mfma_f32_32x32x16_bf16 v[208:223], a[172:175], a[68:71], v[208:223]
    ds_read_b64_tr_b16 a[164:165], v43 offset:24576
    ds_read_b64_tr_b16 a[166:167], v43 offset:27648
    buffer_store_dwordx2 v[60:61], v46, s[16:19], s26 offen
    v_mfma_f32_32x32x16_bf16 v[224:239], a[176:179], a[64:67], v[224:239]
    v_mfma_f32_32x32x16_bf16 v[240:255], a[176:179], a[68:71], v[240:255]
    v_mfma_f32_32x32x16_bf16 v[160:175], a[144:147], a[72:75], v[160:175]
    ds_read_b64_tr_b16 a[168:169], v37 offset:30720
    ds_read_b64_tr_b16 a[170:171], v37 offset:33792
    v_cvt_pk_bf16_f32 v62, v124, v125
    v_cvt_pk_bf16_f32 v63, v126, v127
    v_mfma_f32_32x32x16_bf16 v[176:191], a[144:147], a[76:79], v[176:191]
    ds_read_b64_tr_b16 a[172:173], v40 offset:30720
    ds_read_b64_tr_b16 a[174:175], v40 offset:33792
    buffer_store_dwordx2 v[62:63], v46, s[16:19], s26 offen offset:256
    s_add_u32 s26, s25, 16777216
    v_mfma_f32_32x32x16_bf16 v[192:207], a[148:151], a[72:75], v[192:207]
    ds_read_b64_tr_b16 a[176:177], v43 offset:30720
    ds_read_b64_tr_b16 a[178:179], v43 offset:33792
    v_cvt_pk_bf16_f32 v56, v128, v129
    v_cvt_pk_bf16_f32 v57, v130, v131
    v_mfma_f32_32x32x16_bf16 v[208:223], a[148:151], a[76:79], v[208:223]
    v_mfma_f32_32x32x16_bf16 v[224:239], a[152:155], a[72:75], v[224:239]
    v_mfma_f32_32x32x16_bf16 v[240:255], a[152:155], a[76:79], v[240:255]
    s_waitcnt lgkmcnt(6)
    v_mfma_f32_32x32x16_bf16 v[160:175], a[156:159], a[80:83], v[160:175]
    s_waitcnt vmcnt(30)
    s_waitcnt lgkmcnt(0)
    s_barrier
    v_mfma_f32_32x32x16_bf16 v[176:191], a[156:159], a[84:87], v[176:191]
    ds_read_b64_tr_b16 a[144:145], v37 offset:36864
    ds_read_b64_tr_b16 a[146:147], v37 offset:39936
    buffer_store_dwordx2 v[56:57], v46, s[16:19], s26 offen
    v_cvt_pk_bf16_f32 v58, v144, v145
    v_mfma_f32_32x32x16_bf16 v[192:207], a[160:163], a[80:83], v[192:207]
    ds_read_b64_tr_b16 a[148:149], v40 offset:36864
    ds_read_b64_tr_b16 a[150:151], v40 offset:39936
    v_cvt_pk_bf16_f32 v59, v146, v147
    buffer_store_dwordx2 v[58:59], v46, s[16:19], s26 offen offset:256
    v_mfma_f32_32x32x16_bf16 v[208:223], a[160:163], a[84:87], v[208:223]
    ds_read_b64_tr_b16 a[152:153], v43 offset:36864
    ds_read_b64_tr_b16 a[154:155], v43 offset:39936
    s_add_u32 s26, s25, 17301504
    v_mfma_f32_32x32x16_bf16 v[224:239], a[164:167], a[80:83], v[224:239]
    v_mfma_f32_32x32x16_bf16 v[240:255], a[164:167], a[84:87], v[240:255]
    v_mfma_f32_32x32x16_bf16 v[160:175], a[168:171], a[88:91], v[160:175]
    ds_read_b64_tr_b16 a[156:157], v37 offset:43008
    ds_read_b64_tr_b16 a[158:159], v37 offset:46080
    v_cvt_pk_bf16_f32 v60, v132, v133
    v_cvt_pk_bf16_f32 v61, v134, v135
    v_mfma_f32_32x32x16_bf16 v[176:191], a[168:171], a[92:95], v[176:191]
    ds_read_b64_tr_b16 a[160:161], v40 offset:43008
    ds_read_b64_tr_b16 a[162:163], v40 offset:46080
    buffer_store_dwordx2 v[60:61], v46, s[16:19], s26 offen
    v_cvt_pk_bf16_f32 v62, v148, v149
    v_mfma_f32_32x32x16_bf16 v[192:207], a[172:175], a[88:91], v[192:207]
    ds_read_b64_tr_b16 a[164:165], v43 offset:43008
    ds_read_b64_tr_b16 a[166:167], v43 offset:46080
    v_cvt_pk_bf16_f32 v63, v150, v151
    buffer_store_dwordx2 v[62:63], v46, s[16:19], s26 offen offset:256
    v_mfma_f32_32x32x16_bf16 v[208:223], a[172:175], a[92:95], v[208:223]
    v_mfma_f32_32x32x16_bf16 v[224:239], a[176:179], a[88:91], v[224:239]
    v_mfma_f32_32x32x16_bf16 v[240:255], a[176:179], a[92:95], v[240:255]
    s_waitcnt lgkmcnt(6)
    v_mfma_f32_32x32x16_bf16 v[160:175], a[144:147], a[96:99], v[160:175]
    s_waitcnt vmcnt(29)
    s_waitcnt lgkmcnt(0)
    s_barrier
    v_mfma_f32_32x32x16_bf16 v[176:191], a[144:147], a[100:103], v[176:191]
    ds_read_b64_tr_b16 a[168:169], v37 offset:49152
    ds_read_b64_tr_b16 a[170:171], v37 offset:52224
    s_add_u32 s26, s25, 17825792
    v_cvt_pk_bf16_f32 v56, v136, v137
    v_cvt_pk_bf16_f32 v57, v138, v139
    v_mfma_f32_32x32x16_bf16 v[192:207], a[148:151], a[96:99], v[192:207]
    ds_read_b64_tr_b16 a[172:173], v40 offset:49152
    ds_read_b64_tr_b16 a[174:175], v40 offset:52224
    buffer_store_dwordx2 v[56:57], v46, s[16:19], s26 offen
    v_cvt_pk_bf16_f32 v58, v152, v153
    v_mfma_f32_32x32x16_bf16 v[208:223], a[148:151], a[100:103], v[208:223]
    ds_read_b64_tr_b16 a[176:177], v43 offset:49152
    ds_read_b64_tr_b16 a[178:179], v43 offset:52224
    v_mfma_f32_32x32x16_bf16 v[224:239], a[152:155], a[96:99], v[224:239]
    v_mfma_f32_32x32x16_bf16 v[240:255], a[152:155], a[100:103], v[240:255]
    v_mfma_f32_32x32x16_bf16 v[160:175], a[156:159], a[104:107], v[160:175]
    ds_read_b64_tr_b16 a[144:145], v37 offset:55296
    ds_read_b64_tr_b16 a[146:147], v37 offset:58368
    v_cvt_pk_bf16_f32 v59, v154, v155
    buffer_store_dwordx2 v[58:59], v46, s[16:19], s26 offen offset:256
    v_mfma_f32_32x32x16_bf16 v[176:191], a[156:159], a[108:111], v[176:191]
    ds_read_b64_tr_b16 a[148:149], v40 offset:55296
    ds_read_b64_tr_b16 a[150:151], v40 offset:58368
    s_add_u32 s26, s25, 18350080
    v_cvt_pk_bf16_f32 v60, v140, v141
    v_cvt_pk_bf16_f32 v61, v142, v143
    v_mfma_f32_32x32x16_bf16 v[192:207], a[160:163], a[104:107], v[192:207]
    ds_read_b64_tr_b16 a[152:153], v43 offset:55296
    ds_read_b64_tr_b16 a[154:155], v43 offset:58368
    v_mfma_f32_32x32x16_bf16 v[208:223], a[160:163], a[108:111], v[208:223]
    v_mfma_f32_32x32x16_bf16 v[224:239], a[164:167], a[104:107], v[224:239]
    v_mfma_f32_32x32x16_bf16 v[240:255], a[164:167], a[108:111], v[240:255]
    s_waitcnt lgkmcnt(6)
    v_mfma_f32_32x32x16_bf16 v[160:175], a[168:171], a[112:115], v[160:175]
    s_waitcnt vmcnt(25)
    s_waitcnt lgkmcnt(0)
    s_barrier
    v_mfma_f32_32x32x16_bf16 v[176:191], a[168:171], a[116:119], v[176:191]
    ds_read_b64_tr_b16 a[156:157], v37 offset:61440
    ds_read_b64_tr_b16 a[158:159], v37 offset:64512
    buffer_store_dwordx2 v[60:61], v46, s[16:19], s26 offen
    v_cvt_pk_bf16_f32 v62, v156, v157
    v_mfma_f32_32x32x16_bf16 v[192:207], a[172:175], a[112:115], v[192:207]
    ds_read_b64_tr_b16 a[160:161], v40 offset:61440
    ds_read_b64_tr_b16 a[162:163], v40 offset:64512
    v_cvt_pk_bf16_f32 v63, v158, v159
    buffer_store_dwordx2 v[62:63], v46, s[16:19], s26 offen offset:256
    v_mfma_f32_32x32x16_bf16 v[208:223], a[172:175], a[116:119], v[208:223]
    ds_read_b64_tr_b16 a[164:165], v43 offset:61440
    ds_read_b64_tr_b16 a[166:167], v43 offset:64512
    v_mfma_f32_32x32x16_bf16 v[224:239], a[176:179], a[112:115], v[224:239]
    v_mfma_f32_32x32x16_bf16 v[240:255], a[176:179], a[116:119], v[240:255]
    v_mfma_f32_32x32x16_bf16 v[160:175], a[144:147], a[120:123], v[160:175]
    ds_read_b64_tr_b16 a[168:169], v38 offset:2048
    ds_read_b64_tr_b16 a[170:171], v38 offset:5120
    v_mfma_f32_32x32x16_bf16 v[176:191], a[144:147], a[124:127], v[176:191]
    ds_read_b64_tr_b16 a[172:173], v41 offset:2048
    ds_read_b64_tr_b16 a[174:175], v41 offset:5120
    v_mfma_f32_32x32x16_bf16 v[192:207], a[148:151], a[120:123], v[192:207]
    ds_read_b64_tr_b16 a[176:177], v44 offset:2048
    ds_read_b64_tr_b16 a[178:179], v44 offset:5120
    v_mfma_f32_32x32x16_bf16 v[208:223], a[148:151], a[124:127], v[208:223]
    v_mfma_f32_32x32x16_bf16 v[224:239], a[152:155], a[120:123], v[224:239]
    v_mfma_f32_32x32x16_bf16 v[240:255], a[152:155], a[124:127], v[240:255]
    s_waitcnt lgkmcnt(6)
    v_mfma_f32_32x32x16_bf16 v[160:175], a[156:159], a[128:131], v[160:175]
    v_mfma_f32_32x32x16_bf16 v[176:191], a[156:159], a[132:135], v[176:191]
    v_mfma_f32_32x32x16_bf16 v[192:207], a[160:163], a[128:131], v[192:207]
    v_mfma_f32_32x32x16_bf16 v[208:223], a[160:163], a[132:135], v[208:223]
    v_mfma_f32_32x32x16_bf16 v[224:239], a[164:167], a[128:131], v[224:239]
    v_mfma_f32_32x32x16_bf16 v[240:255], a[164:167], a[132:135], v[240:255]
    s_waitcnt lgkmcnt(0)
    v_mfma_f32_32x32x16_bf16 v[160:175], a[168:171], a[136:139], v[160:175]
    v_mfma_f32_32x32x16_bf16 v[176:191], a[168:171], a[140:143], v[176:191]
    v_mfma_f32_32x32x16_bf16 v[192:207], a[172:175], a[136:139], v[192:207]
    v_mfma_f32_32x32x16_bf16 v[208:223], a[172:175], a[140:143], v[208:223]
    v_mfma_f32_32x32x16_bf16 v[224:239], a[176:179], a[136:139], v[224:239]
    v_mfma_f32_32x32x16_bf16 v[240:255], a[176:179], a[140:143], v[240:255]
    s_add_u32 s26, s25, 25165824
    s_nop 5
    v_cvt_pk_bf16_f32 v56, v160, v161
    v_cvt_pk_bf16_f32 v57, v162, v163
    buffer_store_dwordx2 v[56:57], v46, s[16:19], s26 offen
    v_cvt_pk_bf16_f32 v58, v176, v177
    v_cvt_pk_bf16_f32 v59, v178, v179
    buffer_store_dwordx2 v[58:59], v46, s[16:19], s26 offen offset:256
    s_add_u32 s26, s25, 25690112
    v_cvt_pk_bf16_f32 v60, v164, v165
    v_cvt_pk_bf16_f32 v61, v166, v167
    buffer_store_dwordx2 v[60:61], v46, s[16:19], s26 offen
    v_cvt_pk_bf16_f32 v62, v180, v181
    v_cvt_pk_bf16_f32 v63, v182, v183
    buffer_store_dwordx2 v[62:63], v46, s[16:19], s26 offen offset:256
    s_add_u32 s26, s25, 26214400
    v_cvt_pk_bf16_f32 v56, v168, v169
    v_cvt_pk_bf16_f32 v57, v170, v171
    buffer_store_dwordx2 v[56:57], v46, s[16:19], s26 offen
    v_cvt_pk_bf16_f32 v58, v184, v185
    v_cvt_pk_bf16_f32 v59, v186, v187
    buffer_store_dwordx2 v[58:59], v46, s[16:19], s26 offen offset:256
    s_add_u32 s26, s25, 26738688
    v_cvt_pk_bf16_f32 v60, v172, v173
    v_cvt_pk_bf16_f32 v61, v174, v175
    buffer_store_dwordx2 v[60:61], v46, s[16:19], s26 offen
    v_cvt_pk_bf16_f32 v62, v188, v189
    v_cvt_pk_bf16_f32 v63, v190, v191
    buffer_store_dwordx2 v[62:63], v46, s[16:19], s26 offen offset:256
    s_add_u32 s26, s25, 27262976
    v_cvt_pk_bf16_f32 v56, v192, v193
    v_cvt_pk_bf16_f32 v57, v194, v195
    buffer_store_dwordx2 v[56:57], v46, s[16:19], s26 offen
    v_cvt_pk_bf16_f32 v58, v208, v209
    v_cvt_pk_bf16_f32 v59, v210, v211
    buffer_store_dwordx2 v[58:59], v46, s[16:19], s26 offen offset:256
    s_add_u32 s26, s25, 27787264
    v_cvt_pk_bf16_f32 v60, v196, v197
    v_cvt_pk_bf16_f32 v61, v198, v199
    buffer_store_dwordx2 v[60:61], v46, s[16:19], s26 offen
    v_cvt_pk_bf16_f32 v62, v212, v213
    v_cvt_pk_bf16_f32 v63, v214, v215
    buffer_store_dwordx2 v[62:63], v46, s[16:19], s26 offen offset:256
    s_add_u32 s26, s25, 28311552
    v_cvt_pk_bf16_f32 v56, v200, v201
    v_cvt_pk_bf16_f32 v57, v202, v203
    buffer_store_dwordx2 v[56:57], v46, s[16:19], s26 offen
    v_cvt_pk_bf16_f32 v58, v216, v217
    v_cvt_pk_bf16_f32 v59, v218, v219
    buffer_store_dwordx2 v[58:59], v46, s[16:19], s26 offen offset:256
    s_add_u32 s26, s25, 28835840
    v_cvt_pk_bf16_f32 v60, v204, v205
    v_cvt_pk_bf16_f32 v61, v206, v207
    buffer_store_dwordx2 v[60:61], v46, s[16:19], s26 offen
    v_cvt_pk_bf16_f32 v62, v220, v221
    v_cvt_pk_bf16_f32 v63, v222, v223
    buffer_store_dwordx2 v[62:63], v46, s[16:19], s26 offen offset:256
    s_add_u32 s26, s25, 29360128
    v_cvt_pk_bf16_f32 v56, v224, v225
    v_cvt_pk_bf16_f32 v57, v226, v227
    buffer_store_dwordx2 v[56:57], v46, s[16:19], s26 offen
    v_cvt_pk_bf16_f32 v58, v240, v241
    v_cvt_pk_bf16_f32 v59, v242, v243
    buffer_store_dwordx2 v[58:59], v46, s[16:19], s26 offen offset:256
    s_add_u32 s26, s25, 29884416
    v_cvt_pk_bf16_f32 v60, v228, v229
    v_cvt_pk_bf16_f32 v61, v230, v231
    buffer_store_dwordx2 v[60:61], v46, s[16:19], s26 offen
    v_cvt_pk_bf16_f32 v62, v244, v245
    v_cvt_pk_bf16_f32 v63, v246, v247
    buffer_store_dwordx2 v[62:63], v46, s[16:19], s26 offen offset:256
    s_add_u32 s26, s25, 30408704
    v_cvt_pk_bf16_f32 v56, v232, v233
    v_cvt_pk_bf16_f32 v57, v234, v235
    buffer_store_dwordx2 v[56:57], v46, s[16:19], s26 offen
    v_cvt_pk_bf16_f32 v58, v248, v249
    v_cvt_pk_bf16_f32 v59, v250, v251
    buffer_store_dwordx2 v[58:59], v46, s[16:19], s26 offen offset:256
    s_add_u32 s26, s25, 30932992
    v_cvt_pk_bf16_f32 v60, v236, v237
    v_cvt_pk_bf16_f32 v61, v238, v239
    buffer_store_dwordx2 v[60:61], v46, s[16:19], s26 offen
    v_cvt_pk_bf16_f32 v62, v252, v253
    v_cvt_pk_bf16_f32 v63, v254, v255
    buffer_store_dwordx2 v[62:63], v46, s[16:19], s26 offen offset:256
ffn_fused_kernel_end1:
    s_endpgm
.globl ssm_mix_kernel
.p2align 8
.type ssm_mix_kernel,@function
ssm_mix_kernel:
    s_cmp_ge_u32 s2, 144
    s_cbranch_scc1 ssm_mix_kernel_end1
    s_load_dwordx8 s[8:15], s[0:1], 8
    s_load_dwordx4 s[16:19], s[0:1], 40
    s_load_dwordx2 s[20:21], s[0:1], 96
    s_load_dwordx2 s[22:23], s[0:1], 112
    s_getpc_b64 s[40:41]
ssm_mix_kernel_pf5:
    v_min_u32 v1, 7, v0
    s_lshr_b32 s43, s2, 3
    s_lshl_b32 s43, s43, 3
    v_add_u32 v1, s43, v1
    v_lshlrev_b32 v1, 7, v1
    v_min_u32 v1, (ssm_mix_kernel_end1 - ssm_mix_kernel_pf5), v1
    global_load_dword v255, v1, s[40:41]
    v_lshrrev_b32 v2, 6, v0
    v_and_b32 v1, 255, v0
    v_and_b32 v0, 63, v0
    v_readfirstlane_b32 s24, v2
    s_and_b32 s25, s2, 7
    s_mul_i32 s25, s25, 18
    s_lshr_b32 s26, s2, 3
    s_add_u32 s25, s25, s26
    s_and_b32 s27, s24, 3
    s_lshr_b32 s28, s24, 2
    s_lshl_b32 s29, s25, 2
    s_add_u32 s29, s29, s27
    s_mul_i32 s30, s27, 31616
    s_mul_i32 s31, s27, 5120
    s_add_u32 s31, s31, 126464
    s_lshl_b32 s32, s28, 6
    v_add_u32 v3, s32, v0
    v_lshlrev_b32 v4, 1, v3
    s_lshl_b32 s33, s29, 8
    s_lshl_b32 s34, s29, 1
    v_mov_b32 v5, s34
    v_lshrrev_b32 v6, 2, v0
    v_and_b32 v7, 3, v0
    v_bfe_u32 v13, v6, 2, 1
    v_lshlrev_b32 v13, 1, v13
    v_xor_b32 v7, v7, v13
    v_lshlrev_b32 v6, 6, v6
    v_lshl_add_u32 v6, v7, 4, v6
    s_lshl_b32 s35, s29, 12
    s_lshl_b32 s36, s28, 11
    s_add_u32 s35, s35, s36
    s_add_u32 s35, s35, 41943040
    s_add_u32 s36, s36, s31
    s_add_u32 m0, s36, 1024
    v_mov_b32 v14, 0
    v_mov_b32 v15, 0
    v_mov_b32 v16, 0
    v_mov_b32 v17, 0
    v_lshlrev_b32 v13, 4, v0
    v_add_u32 v13, s31, v13
    ds_write_b128 v13, v[14:17]
    v_lshlrev_b32 v18, 4, v1
    s_mul_i32 s37, s25, 262144
    s_waitcnt lgkmcnt(0)
    s_mov_b32 s60, s8
    s_and_b32 s61, s9, 0xffff
    s_mov_b32 s62, 147456
    s_mov_b32 s63, 0x00020000
    s_mov_b32 s64, s10
    s_and_b32 s65, s11, 0xffff
    s_mov_b32 s66, 147456
    s_mov_b32 s67, 0x00020000
    s_mov_b32 s68, s12
    s_and_b32 s69, s13, 0xffff
    s_mov_b32 s70, 147456
    s_mov_b32 s71, 0x00020000
    s_mov_b32 s72, s14
    s_and_b32 s73, s15, 0xffff
    s_mov_b32 s74, 147456
    s_mov_b32 s75, 0x00020000
    s_mov_b32 s44, s16
    s_and_b32 s45, s17, 0xffff
    s_mov_b32 s46, 1152
    s_mov_b32 s47, 0x00020000
    buffer_load_ushort v8, v4, s[60:63], s33 offen
    buffer_load_ushort v9, v4, s[64:67], s33 offen
    buffer_load_ushort v10, v4, s[68:71], s33 offen
    buffer_load_ushort v11, v4, s[72:75], s33 offen
    buffer_load_ushort v12, v5, s[44:47], 0 offen
    s_mov_b32 s48, s22
    s_and_b32 s49, s23, 0xffff
    s_mov_b32 s50, 50331648
    s_mov_b32 s51, 0x00020000
    buffer_load_dwordx4 v6, s[48:51], s35 offen lds
    buffer_load_dwordx4 v6, s[48:51], s35 offen offset:1024 lds
    s_mov_b32 s52, s20
    s_and_b32 s53, s21, 0xffff
    s_mov_b32 s54, 2359296
    s_mov_b32 s55, 0x00020000
    s_mov_b32 s56, s18
    s_and_b32 s57, s19, 0xffff
    s_mov_b32 s58, 1152
    s_mov_b32 s59, 0x00020000
    s_waitcnt vmcnt(2)
    s_cmp_eq_u32 s28, 0
    s_cbranch_scc1 ssm_mix_kernel_nop4
    s_add_u32 s38, s37, 0
    buffer_load_dwordx4 v[160:163], v18, s[48:51], s38 offen
    s_add_u32 s38, s37, 16384
    buffer_load_dwordx4 v[164:167], v18, s[48:51], s38 offen
    s_add_u32 s38, s37, 32768
    buffer_load_dwordx4 v[168:171], v18, s[48:51], s38 offen
    s_add_u32 s38, s37, 49152
    buffer_load_dwordx4 v[172:175], v18, s[48:51], s38 offen
    s_add_u32 s38, s37, 65536
    buffer_load_dwordx4 v[176:179], v18, s[48:51], s38 offen
    s_add_u32 s38, s37, 81920
    buffer_load_dwordx4 v[180:183], v18, s[48:51], s38 offen
    s_add_u32 s38, s37, 98304
    buffer_load_dwordx4 v[184:187], v18, s[48:51], s38 offen
    s_add_u32 s38, s37, 114688
    buffer_load_dwordx4 v[188:191], v18, s[48:51], s38 offen
    s_add_u32 s38, s37, 131072
    buffer_load_dwordx4 v[192:195], v18, s[48:51], s38 offen
    s_add_u32 s38, s37, 147456
    buffer_load_dwordx4 v[196:199], v18, s[48:51], s38 offen
    s_add_u32 s38, s37, 163840
    buffer_load_dwordx4 v[200:203], v18, s[48:51], s38 offen
    s_add_u32 s38, s37, 180224
    buffer_load_dwordx4 v[204:207], v18, s[48:51], s38 offen
ssm_mix_kernel_nop4:
    v_lshlrev_b32 v8, 16, v8
    v_lshlrev_b32 v9, 16, v9
    v_lshlrev_b32 v10, 16, v10
    v_lshlrev_b32 v11, 16, v11
    v_lshlrev_b32 v12, 16, v12
    v_mul_f32 v12, 0x3fb8aa3b, v12
    v_exp_f32 v12, v12
    s_nop 0
    v_cvt_pk_bf16_f32 v12, v12, v12
    v_lshlrev_b32 v12, 16, v12
    v_mul_f32 v8, 0x3fb8aa3b, v8
    v_exp_f32 v8, v8
    s_nop 0
    v_cvt_pk_bf16_f32 v8, v8, v8
    v_lshlrev_b32 v8, 16, v8
    v_mul_f32 v8, v8, v12
    v_mul_f32 v9, v9, v12
    v_mul_f32 v10, v10, v12
    v_mul_f32 v11, v11, v12
    v_add_f32 v20, v10, v10
    v_add_f32 v21, v11, v11
    v_mul_f32 v8, 0xbfb8aa3b, v8
    v_mul_f32 v9, 0x3e22f983, v9
    v_mov_b32 v64, v8
    v_mov_b32 v65, v9
    v_ldexp_f32 v67, v8, 1
    v_ldexp_f32 v68, v9, 1
    v_ldexp_f32 v70, v8, 2
    v_ldexp_f32 v71, v9, 2
    v_ldexp_f32 v73, v8, 3
    v_ldexp_f32 v74, v9, 3
    v_ldexp_f32 v76, v8, 7
    v_ldexp_f32 v77, v9, 7
    v_ldexp_f32 v79, v8, 8
    v_ldexp_f32 v80, v9, 8
    v_ldexp_f32 v82, v8, 9
    v_ldexp_f32 v83, v9, 9
    v_ldexp_f32 v85, v8, 10
    v_ldexp_f32 v86, v9, 10
    v_fract_f32 v65, v65
    v_fract_f32 v68, v68
    v_fract_f32 v71, v71
    v_fract_f32 v74, v74
    v_fract_f32 v77, v77
    v_fract_f32 v80, v80
    v_fract_f32 v83, v83
    v_fract_f32 v86, v86
    v_exp_f32 v64, v64
    v_exp_f32 v67, v67
    v_exp_f32 v70, v70
    v_exp_f32 v73, v73
    v_exp_f32 v76, v76
    v_exp_f32 v79, v79
    v_exp_f32 v82, v82
    v_exp_f32 v85, v85
    v_sin_f32 v66, v65
    v_sin_f32 v69, v68
    v_sin_f32 v72, v71
    v_sin_f32 v75, v74
    v_sin_f32 v78, v77
    v_sin_f32 v81, v80
    v_sin_f32 v84, v83
    v_sin_f32 v87, v86
    v_cos_f32 v65, v65
    v_cos_f32 v68, v68
    v_cos_f32 v71, v71
    v_cos_f32 v74, v74
    v_cos_f32 v77, v77
    v_cos_f32 v80, v80
    v_cos_f32 v83, v83
    v_cos_f32 v86, v86
    v_mul_f32 v22, v64, v65
    v_mul_f32 v23, v64, v66
    v_mul_f32 v24, v67, v68
    v_mul_f32 v25, v67, v69
    v_mul_f32 v26, v70, v71
    v_mul_f32 v27, v70, v72
    v_mul_f32 v28, v73, v74
    v_mul_f32 v29, v73, v75
    v_mul_f32 v30, v76, v77
    v_mul_f32 v31, v76, v78
    v_mul_f32 v32, v79, v80
    v_mul_f32 v33, v79, v81
    v_mul_f32 v34, v82, v83
    v_mul_f32 v35, v82, v84
    v_mul_f32 v36, v85, v86
    v_mul_f32 v37, v85, v87
    v_lshlrev_b32 v6, 2, v3
    v_add_u32 v6, s30, v6
    v_mov_b32 v92, 1.0
    v_cvt_pk_bf16_f32 v100, v20, v21
    v_pk_mul_f32 v[68:69], v[20:21], v[30:31] op_sel:[0,0] op_sel_hi:[0,1]
    v_pk_mul_f32 v[88:89], v[20:21], v[36:37] op_sel:[0,0] op_sel_hi:[0,1]
    v_pk_mul_f32 v[72:73], v[20:21], v[32:33] op_sel:[0,0] op_sel_hi:[0,1]
    v_pk_mul_f32 v[80:81], v[20:21], v[34:35] op_sel:[0,0] op_sel_hi:[0,1]
    v_mov_b32 v93, 0
    ds_write_b32 v6, v100 offset:0
    v_pk_fma_f32 v[68:69], v[20:21], v[30:31], v[68:69] op_sel:[1,1,0] op_sel_hi:[1,0,1] neg_lo:[0,1,0]
    v_pk_fma_f32 v[88:89], v[20:21], v[36:37], v[88:89] op_sel:[1,1,0] op_sel_hi:[1,0,1] neg_lo:[0,1,0]
    v_pk_fma_f32 v[72:73], v[20:21], v[32:33], v[72:73] op_sel:[1,1,0] op_sel_hi:[1,0,1] neg_lo:[0,1,0]
    v_pk_fma_f32 v[80:81], v[20:21], v[34:35], v[80:81] op_sel:[1,1,0] op_sel_hi:[1,0,1] neg_lo:[0,1,0]
    v_cvt_pk_bf16_f32 v101, v92, -v93
    v_pk_mul_f32 v[64:65], v[20:21], v[22:23] op_sel:[0,0] op_sel_hi:[0,1]
    v_cvt_pk_bf16_f32 v102, v68, v69
    v_cvt_pk_bf16_f32 v103, v88, v89
    v_cvt_pk_bf16_f32 v104, v72, v73
    v_pk_mul_f32 v[82:83], v[80:81], v[26:27] op_sel:[0,0] op_sel_hi:[0,1]
    ds_write_b32 v6, v101 offset:21648
    v_pk_fma_f32 v[64:65], v[20:21], v[22:23], v[64:65] op_sel:[1,1,0] op_sel_hi:[1,0,1] neg_lo:[0,1,0]
    ds_write_b32 v6, v102 offset:4224
    ds_write_b32 v6, v103 offset:16896
    ds_write_b32 v6, v104 offset:8448
    v_pk_fma_f32 v[82:83], v[80:81], v[26:27], v[82:83] op_sel:[1,1,0] op_sel_hi:[1,0,1] neg_lo:[0,1,0]
    v_cvt_pk_bf16_f32 v105, v28, -v29
    v_cvt_pk_bf16_f32 v106, v64, v65
    v_pk_mul_f32 v[70:71], v[68:69], v[22:23] op_sel:[0,0] op_sel_hi:[0,1]
    v_pk_mul_f32 v[90:91], v[88:89], v[30:31] op_sel:[0,0] op_sel_hi:[0,1]
    v_pk_mul_f32 v[76:77], v[72:73], v[30:31] op_sel:[0,0] op_sel_hi:[0,1]
    v_cvt_pk_bf16_f32 v107, v80, v81
    ds_write_b32 v6, v105 offset:22176
    ds_write_b32 v6, v106 offset:528
    v_pk_fma_f32 v[70:71], v[68:69], v[22:23], v[70:71] op_sel:[1,1,0] op_sel_hi:[1,0,1] neg_lo:[0,1,0]
    v_pk_fma_f32 v[90:91], v[88:89], v[30:31], v[90:91] op_sel:[1,1,0] op_sel_hi:[1,0,1] neg_lo:[0,1,0]
    v_pk_fma_f32 v[76:77], v[72:73], v[30:31], v[76:77] op_sel:[1,1,0] op_sel_hi:[1,0,1] neg_lo:[0,1,0]
    ds_write_b32 v6, v107 offset:12672
    v_pk_mul_f32 v[92:93], v[28:29], v[28:29] op_sel:[0,0] op_sel_hi:[0,1]
    v_pk_mul_f32 v[66:67], v[64:65], v[22:23] op_sel:[0,0] op_sel_hi:[0,1]
    v_cvt_pk_bf16_f32 v100, v70, v71
    v_cvt_pk_bf16_f32 v101, v90, v91
    v_cvt_pk_bf16_f32 v102, v76, v77
    v_cvt_pk_bf16_f32 v103, v82, v83
    v_pk_fma_f32 v[92:93], v[28:29], v[28:29], v[92:93] op_sel:[1,1,0] op_sel_hi:[1,0,1] neg_lo:[0,1,0]
    v_pk_fma_f32 v[66:67], v[64:65], v[22:23], v[66:67] op_sel:[1,1,0] op_sel_hi:[1,0,1] neg_lo:[0,1,0]
    ds_write_b32 v6, v100 offset:4752
    ds_write_b32 v6, v101 offset:17424
    ds_write_b32 v6, v102 offset:10560
    ds_write_b32 v6, v103 offset:13200
    v_cvt_pk_bf16_f32 v104, v92, -v93
    v_cvt_pk_bf16_f32 v105, v66, v67
    v_pk_mul_f32 v[68:69], v[70:71], v[22:23] op_sel:[0,0] op_sel_hi:[0,1]
    v_pk_mul_f32 v[88:89], v[90:91], v[30:31] op_sel:[0,0] op_sel_hi:[0,1]
    v_pk_mul_f32 v[74:75], v[72:73], v[24:25] op_sel:[0,0] op_sel_hi:[0,1]
    v_pk_mul_f32 v[84:85], v[80:81], v[30:31] op_sel:[0,0] op_sel_hi:[0,1]
    ds_write_b32 v6, v104 offset:22704
    ds_write_b32 v6, v105 offset:1056
    v_pk_fma_f32 v[68:69], v[70:71], v[22:23], v[68:69] op_sel:[1,1,0] op_sel_hi:[1,0,1] neg_lo:[0,1,0]
    v_pk_fma_f32 v[88:89], v[90:91], v[30:31], v[88:89] op_sel:[1,1,0] op_sel_hi:[1,0,1] neg_lo:[0,1,0]
    v_pk_fma_f32 v[74:75], v[72:73], v[24:25], v[74:75] op_sel:[1,1,0] op_sel_hi:[1,0,1] neg_lo:[0,1,0]
    v_pk_fma_f32 v[84:85], v[80:81], v[30:31], v[84:85] op_sel:[1,1,0] op_sel_hi:[1,0,1] neg_lo:[0,1,0]
    v_pk_mul_f32 v[94:95], v[92:93], v[28:29] op_sel:[0,0] op_sel_hi:[0,1]
    v_pk_mul_f32 v[64:65], v[66:67], v[22:23] op_sel:[0,0] op_sel_hi:[0,1]
    v_cvt_pk_bf16_f32 v106, v68, v69
    v_cvt_pk_bf16_f32 v107, v88, v89
    v_cvt_pk_bf16_f32 v100, v74, v75
    v_pk_mul_f32 v[86:87], v[82:83], v[30:31] op_sel:[0,0] op_sel_hi:[0,1]
    v_pk_fma_f32 v[94:95], v[92:93], v[28:29], v[94:95] op_sel:[1,1,0] op_sel_hi:[1,0,1] neg_lo:[0,1,0]
    v_pk_fma_f32 v[64:65], v[66:67], v[22:23], v[64:65] op_sel:[1,1,0] op_sel_hi:[1,0,1] neg_lo:[0,1,0]
    ds_write_b32 v6, v106 offset:5280
    ds_write_b32 v6, v107 offset:17952
    ds_write_b32 v6, v100 offset:8976
    v_pk_fma_f32 v[86:87], v[82:83], v[30:31], v[86:87] op_sel:[1,1,0] op_sel_hi:[1,0,1] neg_lo:[0,1,0]
    v_cvt_pk_bf16_f32 v101, v94, -v95
    v_cvt_pk_bf16_f32 v102, v64, v65
    v_pk_mul_f32 v[70:71], v[68:69], v[22:23] op_sel:[0,0] op_sel_hi:[0,1]
    v_pk_mul_f32 v[90:91], v[88:89], v[30:31] op_sel:[0,0] op_sel_hi:[0,1]
    v_pk_mul_f32 v[78:79], v[74:75], v[30:31] op_sel:[0,0] op_sel_hi:[0,1]
    v_cvt_pk_bf16_f32 v103, v84, v85
    ds_write_b32 v6, v101 offset:23232
    ds_write_b32 v6, v102 offset:1584
    v_pk_fma_f32 v[70:71], v[68:69], v[22:23], v[70:71] op_sel:[1,1,0] op_sel_hi:[1,0,1] neg_lo:[0,1,0]
    v_pk_fma_f32 v[90:91], v[88:89], v[30:31], v[90:91] op_sel:[1,1,0] op_sel_hi:[1,0,1] neg_lo:[0,1,0]
    v_pk_fma_f32 v[78:79], v[74:75], v[30:31], v[78:79] op_sel:[1,1,0] op_sel_hi:[1,0,1] neg_lo:[0,1,0]
    ds_write_b32 v6, v103 offset:13728
    v_pk_mul_f32 v[92:93], v[94:95], v[28:29] op_sel:[0,0] op_sel_hi:[0,1]
    v_pk_mul_f32 v[66:67], v[64:65], v[22:23] op_sel:[0,0] op_sel_hi:[0,1]
    v_cvt_pk_bf16_f32 v104, v70, v71
    v_cvt_pk_bf16_f32 v105, v90, v91
    v_cvt_pk_bf16_f32 v106, v78, v79
    v_cvt_pk_bf16_f32 v107, v86, v87
    v_pk_fma_f32 v[92:93], v[94:95], v[28:29], v[92:93] op_sel:[1,1,0] op_sel_hi:[1,0,1] neg_lo:[0,1,0]
    v_pk_fma_f32 v[66:67], v[64:65], v[22:23], v[66:67] op_sel:[1,1,0] op_sel_hi:[1,0,1] neg_lo:[0,1,0]
    ds_write_b32 v6, v104 offset:5808
    ds_write_b32 v6, v105 offset:18480
    ds_write_b32 v6, v106 offset:11088
    ds_write_b32 v6, v107 offset:14256
    v_cvt_pk_bf16_f32 v100, v92, -v93
    v_cvt_pk_bf16_f32 v101, v66, v67
    v_pk_mul_f32 v[68:69], v[70:71], v[22:23] op_sel:[0,0] op_sel_hi:[0,1]
    v_pk_mul_f32 v[88:89], v[90:91], v[30:31] op_sel:[0,0] op_sel_hi:[0,1]
    v_pk_mul_f32 v[72:73], v[74:75], v[24:25] op_sel:[0,0] op_sel_hi:[0,1]
    v_pk_mul_f32 v[80:81], v[84:85], v[30:31] op_sel:[0,0] op_sel_hi:[0,1]
    ds_write_b32 v6, v100 offset:23760
    ds_write_b32 v6, v101 offset:2112
    v_pk_fma_f32 v[68:69], v[70:71], v[22:23], v[68:69] op_sel:[1,1,0] op_sel_hi:[1,0,1] neg_lo:[0,1,0]
    v_pk_fma_f32 v[88:89], v[90:91], v[30:31], v[88:89] op_sel:[1,1,0] op_sel_hi:[1,0,1] neg_lo:[0,1,0]
    v_pk_fma_f32 v[72:73], v[74:75], v[24:25], v[72:73] op_sel:[1,1,0] op_sel_hi:[1,0,1] neg_lo:[0,1,0]
    v_pk_fma_f32 v[80:81], v[84:85], v[30:31], v[80:81] op_sel:[1,1,0] op_sel_hi:[1,0,1] neg_lo:[0,1,0]
    v_pk_mul_f32 v[94:95], v[92:93], v[28:29] op_sel:[0,0] op_sel_hi:[0,1]
    v_pk_mul_f32 v[64:65], v[66:67], v[22:23] op_sel:[0,0] op_sel_hi:[0,1]
    v_cvt_pk_bf16_f32 v102, v68, v69
    v_cvt_pk_bf16_f32 v103, v88, v89
    v_cvt_pk_bf16_f32 v104, v72, v73
    v_pk_mul_f32 v[82:83], v[86:87], v[30:31] op_sel:[0,0] op_sel_hi:[0,1]
    v_pk_fma_f32 v[94:95], v[92:93], v[28:29], v[94:95] op_sel:[1,1,0] op_sel_hi:[1,0,1] neg_lo:[0,1,0]
    v_pk_fma_f32 v[64:65], v[66:67], v[22:23], v[64:65] op_sel:[1,1,0] op_sel_hi:[1,0,1] neg_lo:[0,1,0]
    ds_write_b32 v6, v102 offset:6336
    ds_write_b32 v6, v103 offset:19008
    ds_write_b32 v6, v104 offset:9504
    v_pk_fma_f32 v[82:83], v[86:87], v[30:31], v[82:83] op_sel:[1,1,0] op_sel_hi:[1,0,1] neg_lo:[0,1,0]
    v_cvt_pk_bf16_f32 v105, v94, -v95
    v_cvt_pk_bf16_f32 v106, v64, v65
    v_pk_mul_f32 v[70:71], v[68:69], v[22:23] op_sel:[0,0] op_sel_hi:[0,1]
    v_pk_mul_f32 v[90:91], v[88:89], v[30:31] op_sel:[0,0] op_sel_hi:[0,1]
    v_pk_mul_f32 v[76:77], v[72:73], v[30:31] op_sel:[0,0] op_sel_hi:[0,1]
    v_cvt_pk_bf16_f32 v107, v80, v81
    ds_write_b32 v6, v105 offset:24288
    ds_write_b32 v6, v106 offset:2640
    v_pk_fma_f32 v[70:71], v[68:69], v[22:23], v[70:71] op_sel:[1,1,0] op_sel_hi:[1,0,1] neg_lo:[0,1,0]
    v_pk_fma_f32 v[90:91], v[88:89], v[30:31], v[90:91] op_sel:[1,1,0] op_sel_hi:[1,0,1] neg_lo:[0,1,0]
    v_pk_fma_f32 v[76:77], v[72:73], v[30:31], v[76:77] op_sel:[1,1,0] op_sel_hi:[1,0,1] neg_lo:[0,1,0]
    ds_write_b32 v6, v107 offset:14784
    v_pk_mul_f32 v[92:93], v[94:95], v[28:29] op_sel:[0,0] op_sel_hi:[0,1]
    v_pk_mul_f32 v[66:67], v[64:65], v[22:23] op_sel:[0,0] op_sel_hi:[0,1]
    v_cvt_pk_bf16_f32 v100, v70, v71
    v_cvt_pk_bf16_f32 v101, v90, v91
    v_cvt_pk_bf16_f32 v102, v76, v77
    v_cvt_pk_bf16_f32 v103, v82, v83
    v_pk_fma_f32 v[92:93], v[94:95], v[28:29], v[92:93] op_sel:[1,1,0] op_sel_hi:[1,0,1] neg_lo:[0,1,0]
    v_pk_fma_f32 v[66:67], v[64:65], v[22:23], v[66:67] op_sel:[1,1,0] op_sel_hi:[1,0,1] neg_lo:[0,1,0]
    ds_write_b32 v6, v100 offset:6864
    ds_write_b32 v6, v101 offset:19536
    ds_write_b32 v6, v102 offset:11616
    ds_write_b32 v6, v103 offset:15312
    v_cvt_pk_bf16_f32 v104, v92, -v93
    v_cvt_pk_bf16_f32 v105, v66, v67
    v_pk_mul_f32 v[68:69], v[70:71], v[22:23] op_sel:[0,0] op_sel_hi:[0,1]
    v_pk_mul_f32 v[88:89], v[90:91], v[30:31] op_sel:[0,0] op_sel_hi:[0,1]
    v_pk_mul_f32 v[74:75], v[72:73], v[24:25] op_sel:[0,0] op_sel_hi:[0,1]
    v_pk_mul_f32 v[84:85], v[80:81], v[30:31] op_sel:[0,0] op_sel_hi:[0,1]
    ds_write_b32 v6, v104 offset:24816
    ds_write_b32 v6, v105 offset:3168
    v_pk_fma_f32 v[68:69], v[70:71], v[22:23], v[68:69] op_sel:[1,1,0] op_sel_hi:[1,0,1] neg_lo:[0,1,0]
    v_pk_fma_f32 v[88:89], v[90:91], v[30:31], v[88:89] op_sel:[1,1,0] op_sel_hi:[1,0,1] neg_lo:[0,1,0]
    v_pk_fma_f32 v[74:75], v[72:73], v[24:25], v[74:75] op_sel:[1,1,0] op_sel_hi:[1,0,1] neg_lo:[0,1,0]
    v_pk_fma_f32 v[84:85], v[80:81], v[30:31], v[84:85] op_sel:[1,1,0] op_sel_hi:[1,0,1] neg_lo:[0,1,0]
    v_pk_mul_f32 v[94:95], v[92:93], v[28:29] op_sel:[0,0] op_sel_hi:[0,1]
    v_pk_mul_f32 v[64:65], v[66:67], v[22:23] op_sel:[0,0] op_sel_hi:[0,1]
    v_cvt_pk_bf16_f32 v106, v68, v69
    v_cvt_pk_bf16_f32 v107, v88, v89
    v_cvt_pk_bf16_f32 v100, v74, v75
    v_pk_mul_f32 v[86:87], v[82:83], v[30:31] op_sel:[0,0] op_sel_hi:[0,1]
    v_pk_fma_f32 v[94:95], v[92:93], v[28:29], v[94:95] op_sel:[1,1,0] op_sel_hi:[1,0,1] neg_lo:[0,1,0]
    v_pk_fma_f32 v[64:65], v[66:67], v[22:23], v[64:65] op_sel:[1,1,0] op_sel_hi:[1,0,1] neg_lo:[0,1,0]
    ds_write_b32 v6, v106 offset:7392
    ds_write_b32 v6, v107 offset:20064
    ds_write_b32 v6, v100 offset:10032
    v_pk_fma_f32 v[86:87], v[82:83], v[30:31], v[86:87] op_sel:[1,1,0] op_sel_hi:[1,0,1] neg_lo:[0,1,0]
    v_cvt_pk_bf16_f32 v101, v94, -v95
    v_cvt_pk_bf16_f32 v102, v64, v65
    v_pk_mul_f32 v[70:71], v[68:69], v[22:23] op_sel:[0,0] op_sel_hi:[0,1]
    v_pk_mul_f32 v[90:91], v[88:89], v[30:31] op_sel:[0,0] op_sel_hi:[0,1]
    v_pk_mul_f32 v[78:79], v[74:75], v[30:31] op_sel:[0,0] op_sel_hi:[0,1]
    v_cvt_pk_bf16_f32 v103, v84, v85
    ds_write_b32 v6, v101 offset:25344
    ds_write_b32 v6, v102 offset:3696
    v_pk_fma_f32 v[70:71], v[68:69], v[22:23], v[70:71] op_sel:[1,1,0] op_sel_hi:[1,0,1] neg_lo:[0,1,0]
    v_pk_fma_f32 v[90:91], v[88:89], v[30:31], v[90:91] op_sel:[1,1,0] op_sel_hi:[1,0,1] neg_lo:[0,1,0]
    v_pk_fma_f32 v[78:79], v[74:75], v[30:31], v[78:79] op_sel:[1,1,0] op_sel_hi:[1,0,1] neg_lo:[0,1,0]
    ds_write_b32 v6, v103 offset:15840
    v_pk_mul_f32 v[92:93], v[94:95], v[28:29] op_sel:[0,0] op_sel_hi:[0,1]
    v_cvt_pk_bf16_f32 v104, v70, v71
    v_cvt_pk_bf16_f32 v105, v90, v91
    v_cvt_pk_bf16_f32 v106, v78, v79
    v_cvt_pk_bf16_f32 v107, v86, v87
    v_pk_fma_f32 v[92:93], v[94:95], v[28:29], v[92:93] op_sel:[1,1,0] op_sel_hi:[1,0,1] neg_lo:[0,1,0]
    ds_write_b32 v6, v104 offset:7920
    ds_write_b32 v6, v105 offset:20592
    ds_write_b32 v6, v106 offset:12144
    ds_write_b32 v6, v107 offset:16368
    v_cvt_pk_bf16_f32 v100, v92, -v93
    v_pk_mul_f32 v[88:89], v[90:91], v[30:31] op_sel:[0,0] op_sel_hi:[0,1]
    ds_write_b32 v6, v100 offset:25872
    v_pk_fma_f32 v[88:89], v[90:91], v[30:31], v[88:89] op_sel:[1,1,0] op_sel_hi:[1,0,1] neg_lo:[0,1,0]
    v_pk_mul_f32 v[94:95], v[92:93], v[28:29] op_sel:[0,0] op_sel_hi:[0,1]
    v_cvt_pk_bf16_f32 v101, v88, v89
    v_pk_fma_f32 v[94:95], v[92:93], v[28:29], v[94:95] op_sel:[1,1,0] op_sel_hi:[1,0,1] neg_lo:[0,1,0]
    ds_write_b32 v6, v101 offset:21120
    v_cvt_pk_bf16_f32 v102, v94, -v95
    ds_write_b32 v6, v102 offset:26400
    v_pk_mul_f32 v[92:93], v[94:95], v[28:29] op_sel:[0,0] op_sel_hi:[0,1]
    v_pk_fma_f32 v[92:93], v[94:95], v[28:29], v[92:93] op_sel:[1,1,0] op_sel_hi:[1,0,1] neg_lo:[0,1,0]
    v_cvt_pk_bf16_f32 v103, v92, -v93
    ds_write_b32 v6, v103 offset:26928
    v_pk_mul_f32 v[94:95], v[92:93], v[28:29] op_sel:[0,0] op_sel_hi:[0,1]
    v_pk_fma_f32 v[94:95], v[92:93], v[28:29], v[94:95] op_sel:[1,1,0] op_sel_hi:[1,0,1] neg_lo:[0,1,0]
    v_cvt_pk_bf16_f32 v104, v94, -v95
    ds_write_b32 v6, v104 offset:27456
    v_pk_mul_f32 v[92:93], v[94:95], v[28:29] op_sel:[0,0] op_sel_hi:[0,1]
    v_pk_fma_f32 v[92:93], v[94:95], v[28:29], v[92:93] op_sel:[1,1,0] op_sel_hi:[1,0,1] neg_lo:[0,1,0]
    v_cvt_pk_bf16_f32 v105, v92, -v93
    ds_write_b32 v6, v105 offset:27984
    v_pk_mul_f32 v[94:95], v[92:93], v[28:29] op_sel:[0,0] op_sel_hi:[0,1]
    v_pk_fma_f32 v[94:95], v[92:93], v[28:29], v[94:95] op_sel:[1,1,0] op_sel_hi:[1,0,1] neg_lo:[0,1,0]
    v_cvt_pk_bf16_f32 v106, v94, -v95
    ds_write_b32 v6, v106 offset:28512
    v_pk_mul_f32 v[92:93], v[94:95], v[28:29] op_sel:[0,0] op_sel_hi:[0,1]
    v_pk_fma_f32 v[92:93], v[94:95], v[28:29], v[92:93] op_sel:[1,1,0] op_sel_hi:[1,0,1] neg_lo:[0,1,0]
    v_cvt_pk_bf16_f32 v107, v92, -v93
    ds_write_b32 v6, v107 offset:29040
    v_pk_mul_f32 v[94:95], v[92:93], v[28:29] op_sel:[0,0] op_sel_hi:[0,1]
    v_pk_fma_f32 v[94:95], v[92:93], v[28:29], v[94:95] op_sel:[1,1,0] op_sel_hi:[1,0,1] neg_lo:[0,1,0]
    v_cvt_pk_bf16_f32 v100, v94, -v95
    ds_write_b32 v6, v100 offset:29568
    v_and_b32 v7, 15, v0
    v_lshrrev_b32 v13, 4, v0
    s_cmp_eq_u32 s28, 0
    s_cbranch_scc1 ssm_mix_kernel_w06
    s_waitcnt vmcnt(12)
    s_branch ssm_mix_kernel_w17
ssm_mix_kernel_w06:
    s_waitcnt vmcnt(0)
ssm_mix_kernel_w17:
    s_waitcnt lgkmcnt(0)
    s_barrier
    s_cmp_eq_u32 s28, 1
    s_cbranch_scc1 ssm_mix_kernel_pw2
    v_mul_u32_u24 v22, 528, v7
    v_lshl_add_u32 v22, v13, 4, v22
    v_add_u32 v22, s30, v22
    ds_read_b128 v[64:67], v22 offset:21648
    ds_read_b128 v[68:71], v22 offset:21712
    ds_read_b128 v[72:75], v22 offset:21776
    ds_read_b128 v[76:79], v22 offset:21840
    ds_read_b128 v[80:83], v22 offset:21904
    ds_read_b128 v[84:87], v22 offset:21968
    ds_read_b128 v[88:91], v22 offset:22032
    ds_read_b128 v[92:95], v22 offset:22096
    ds_read_b128 v[128:131], v22 offset:0
    ds_read_b128 v[132:135], v22 offset:64
    ds_read_b128 v[136:139], v22 offset:128
    ds_read_b128 v[140:143], v22 offset:192
    ds_read_b128 v[144:147], v22 offset:256
    ds_read_b128 v[148:151], v22 offset:320
    ds_read_b128 v[152:155], v22 offset:384
    ds_read_b128 v[156:159], v22 offset:448
    ds_read_b128 v[160:163], v22 offset:8448
    ds_read_b128 v[164:167], v22 offset:8512
    ds_read_b128 v[168:171], v22 offset:8576
    ds_read_b128 v[172:175], v22 offset:8640
    ds_read_b128 v[176:179], v22 offset:8704
    ds_read_b128 v[180:183], v22 offset:8768
    ds_read_b128 v[184:187], v22 offset:8832
    ds_read_b128 v[188:191], v22 offset:8896
    ds_read_b128 v[192:195], v22 offset:16896
    ds_read_b128 v[196:199], v22 offset:16960
    ds_read_b128 v[200:203], v22 offset:17024
    ds_read_b128 v[204:207], v22 offset:17088
    ds_read_b128 v[208:211], v22 offset:17152
    ds_read_b128 v[212:215], v22 offset:17216
    ds_read_b128 v[216:219], v22 offset:17280
    ds_read_b128 v[220:223], v22 offset:17344
    v_lshrrev_b32 v40, 1, v13
    v_lshlrev_b32 v40, 8, v40
    v_lshl_add_u32 v40, v7, 4, v40
    v_and_b32 v41, 1, v13
    v_lshl_add_u32 v40, v41, 3, v40
    v_add_u32 v40, s30, v40
    v_lshlrev_b32 v44, 7, v13
    v_lshl_add_u32 v45, v7, 3, v44
    v_lshl_add_u32 v44, v7, 2, v44
    v_cmp_gt_u32 vcc, 2, v13
    s_nop 1
    v_cndmask_b32 v44, v44, v45, vcc
    v_mov_b32 v46, 64
    v_mov_b32 v47, 4
    v_cndmask_b32 v45, v46, v47, vcc
    v_add_u32 v44, s30, v44
    v_add_u32 v45, v44, v45
    v_lshlrev_b32 v48, 7, v13
    v_lshl_add_u32 v48, v7, 1, v48
    v_add_u32 v48, s30, v48
    v_min_u32 v49, 2, v13
    v_lshlrev_b32 v49, 7, v49
    v_lshl_add_u32 v49, v7, 1, v49
    v_add_u32 v49, s30, v49
    v_cmp_eq_u32 vcc, 3, v13
    v_add_u32 v50, 0x60, v49
    s_nop 0
    v_cndmask_b32 v50, v48, v50, vcc
    s_mov_b32 s41, 0x01000100
    s_mov_b32 s42, 0x05040100
    v_lshlrev_b32 v52, 2, v0
    v_add_u32 v52, s30, v52
    v_lshlrev_b32 v53, 3, v0
    v_add_u32 v53, s30, v53
    v_lshlrev_b32 v54, 4, v0
    v_add_u32 v54, s30, v54
    v_lshlrev_b32 v55, 5, v0
    v_add_u32 v55, s30, v55
    s_waitcnt lgkmcnt(0)
    v_mfma_f32_16x16x32_bf16 v[24:27], v[128:131], v[64:67], 0
    v_mfma_f32_16x16x32_bf16 v[28:31], v[160:163], v[64:67], 0
    v_mfma_f32_16x16x32_bf16 v[32:35], v[192:195], v[64:67], 0
    v_mfma_f32_16x16x32_bf16 v[24:27], v[132:135], v[68:71], v[24:27]
    v_mfma_f32_16x16x32_bf16 v[28:31], v[164:167], v[68:71], v[28:31]
    v_mfma_f32_16x16x32_bf16 v[32:35], v[196:199], v[68:71], v[32:35]
    v_mfma_f32_16x16x32_bf16 v[24:27], v[136:139], v[72:75], v[24:27]
    v_mfma_f32_16x16x32_bf16 v[28:31], v[168:171], v[72:75], v[28:31]
    v_mfma_f32_16x16x32_bf16 v[32:35], v[200:203], v[72:75], v[32:35]
    v_mfma_f32_16x16x32_bf16 v[24:27], v[140:143], v[76:79], v[24:27]
    v_mfma_f32_16x16x32_bf16 v[28:31], v[172:175], v[76:79], v[28:31]
    v_mfma_f32_16x16x32_bf16 v[32:35], v[204:207], v[76:79], v[32:35]
    v_mfma_f32_16x16x32_bf16 v[24:27], v[144:147], v[80:83], v[24:27]
    v_mfma_f32_16x16x32_bf16 v[28:31], v[176:179], v[80:83], v[28:31]
    v_mfma_f32_16x16x32_bf16 v[32:35], v[208:211], v[80:83], v[32:35]
    v_mfma_f32_16x16x32_bf16 v[24:27], v[148:151], v[84:87], v[24:27]
    v_mfma_f32_16x16x32_bf16 v[28:31], v[180:183], v[84:87], v[28:31]
    v_mfma_f32_16x16x32_bf16 v[32:35], v[212:215], v[84:87], v[32:35]
    v_mfma_f32_16x16x32_bf16 v[24:27], v[152:155], v[88:91], v[24:27]
    v_mfma_f32_16x16x32_bf16 v[28:31], v[184:187], v[88:91], v[28:31]
    v_mfma_f32_16x16x32_bf16 v[32:35], v[216:219], v[88:91], v[32:35]
    v_mfma_f32_16x16x32_bf16 v[24:27], v[156:159], v[92:95], v[24:27]
    v_mfma_f32_16x16x32_bf16 v[28:31], v[188:191], v[92:95], v[28:31]
    v_mfma_f32_16x16x32_bf16 v[32:35], v[220:223], v[92:95], v[32:35]
    v_mov_b32 v56, 0
    v_mov_b32 v57, 0
    v_min_u32 v58, 7, v0
    v_lshlrev_b32 v58, 3, v58
    v_add_u32 v58, s30, v58
    ds_write_b64 v58, v[56:57]
    v_cvt_pk_bf16_f32 v42, v24, v25
    v_cvt_pk_bf16_f32 v43, v26, v27
    ds_write_b64 v40, v[42:43] offset:64
    v_cvt_pk_bf16_f32 v46, v28, v29
    v_cvt_pk_bf16_f32 v47, v30, v31
    ds_write_b32 v44, v46 offset:30608
    ds_write_b32 v45, v47 offset:30608
    v_cvt_pk_bf16_f32 v60, v32, v33
    v_cvt_pk_bf16_f32 v61, v34, v35
    ds_write_b16 v50, v60 offset:31120
    ds_write_b16_d16_hi v49, v60 offset:31152
    ds_write_b16 v49, v61 offset:31184
    ds_write_b16_d16_hi v49, v61 offset:31216
    s_waitcnt lgkmcnt(0)
    ds_read_u16 v64, v52 offset:30608
    ds_read_u16 v65, v52 offset:30610
    ds_read_u16 v66, v52 offset:30612
    ds_read_u16 v68, v52 offset:30864
    ds_read_u16 v69, v52 offset:30866
    ds_read_u16 v70, v52 offset:30868
    ds_read_u16 v72, v52 offset:31120
    ds_read_u16 v73, v52 offset:31122
    ds_read_u16 v74, v52 offset:31124
    v_add_u32 v20, 0, v0
    v_lshlrev_b32 v20, 4, v20
    v_add_u32 v20, s30, v20
    v_subrev_u32 v26, 8, v20
    v_max_i32 v26, 0, v26
    v_add_u32 v21, 64, v0
    v_lshlrev_b32 v21, 4, v21
    v_add_u32 v21, s30, v21
    v_subrev_u32 v27, 8, v21
    v_max_i32 v27, 0, v27
    v_add_u32 v22, 128, v0
    v_lshlrev_b32 v22, 4, v22
    v_add_u32 v22, s30, v22
    v_subrev_u32 v28, 8, v22
    v_max_i32 v28, 0, v28
    v_add_u32 v23, 192, v0
    v_lshlrev_b32 v23, 4, v23
    v_add_u32 v23, s30, v23
    v_subrev_u32 v29, 8, v23
    v_max_i32 v29, 0, v29
    v_add_u32 v24, 256, v0
    v_min_u32 v24, 259, v24
    v_lshlrev_b32 v24, 4, v24
    v_add_u32 v24, s30, v24
    v_subrev_u32 v30, 8, v24
    v_max_i32 v30, 0, v30
    s_waitcnt lgkmcnt(0)
    v_perm_b32 v78, v64, v64, s41
    v_perm_b32 v79, v66, v65, s42
    ds_write_b64 v53, v[78:79] offset:576
    v_perm_b32 v80, v68, v68, s41
    v_perm_b32 v81, v69, v68, s42
    v_perm_b32 v82, v69, v69, s41
    v_perm_b32 v83, v70, v70, s41
    ds_write_b128 v54, v[80:83] offset:1088
    v_perm_b32 v84, v72, v72, s41
    v_mov_b32 v85, v84
    v_perm_b32 v86, v73, v72, s42
    v_perm_b32 v87, v73, v73, s41
    v_mov_b32 v88, v87
    v_mov_b32 v89, v87
    v_perm_b32 v90, v74, v74, s41
    v_mov_b32 v91, v90
    ds_write_b128 v55, v[84:87] offset:2112
    ds_write_b128 v55, v[88:91] offset:2128
    v_bfe_u32 v32, v0, 2, 2
    v_mul_u32_u24 v32, 4160, v32
    v_and_b32 v33, 3, v0
    v_lshl_add_u32 v32, v33, 3, v32
    v_lshlrev_b32 v33, 4, v13
    v_sub_u32 v32, v32, v33
    s_add_u32 s34, s30, 56
    v_add_u32 v32, s34, v32
    s_waitcnt lgkmcnt(0)
    ds_read_b128 v[68:71], v20
    ds_read_b64 v[66:67], v26
    ds_read_b128 v[76:79], v21
    ds_read_b64 v[74:75], v27
    ds_read_b128 v[84:87], v22
    ds_read_b64 v[82:83], v28
    ds_read_b128 v[92:95], v23
    ds_read_b64 v[90:91], v29
    ds_read_b128 v[100:103], v24
    ds_read_b64 v[98:99], v30
    v_add_u32 v34, 16, v7
    v_bfe_u32 v35, v34, 2, 1
    v_lshlrev_b32 v35, 1, v35
    v_xor_b32 v35, v35, v13
    v_lshlrev_b32 v34, 6, v34
    v_lshl_add_u32 v34, v35, 4, v34
    s_sub_u32 s34, s31, 512
    v_add_u32 v40, s34, v34
    v_add_u32 v34, 15, v7
    v_bfe_u32 v35, v34, 2, 1
    v_lshlrev_b32 v35, 1, v35
    v_xor_b32 v35, v35, v13
    v_lshlrev_b32 v34, 6, v34
    v_lshl_add_u32 v34, v35, 4, v34
    s_sub_u32 s34, s31, 512
    v_add_u32 v41, s34, v34
    v_add_u32 v34, 14, v7
    v_bfe_u32 v35, v34, 2, 1
    v_lshlrev_b32 v35, 1, v35
    v_xor_b32 v35, v35, v13
    v_lshlrev_b32 v34, 6, v34
    v_lshl_add_u32 v34, v35, 4, v34
    s_sub_u32 s34, s31, 512
    v_add_u32 v42, s34, v34
    v_add_u32 v34, 13, v7
    v_bfe_u32 v35, v34, 2, 1
    v_lshlrev_b32 v35, 1, v35
    v_xor_b32 v35, v35, v13
    v_lshlrev_b32 v34, 6, v34
    v_lshl_add_u32 v34, v35, 4, v34
    s_sub_u32 s34, s31, 512
    v_add_u32 v43, s34, v34
    v_add_u32 v34, 12, v7
    v_bfe_u32 v35, v34, 2, 1
    v_lshlrev_b32 v35, 1, v35
    v_xor_b32 v35, v35, v13
    v_lshlrev_b32 v34, 6, v34
    v_lshl_add_u32 v34, v35, 4, v34
    s_sub_u32 s34, s31, 512
    v_add_u32 v44, s34, v34
    v_add_u32 v34, 11, v7
    v_bfe_u32 v35, v34, 2, 1
    v_lshlrev_b32 v35, 1, v35
    v_xor_b32 v35, v35, v13
    v_lshlrev_b32 v34, 6, v34
    v_lshl_add_u32 v34, v35, 4, v34
    s_sub_u32 s34, s31, 512
    v_add_u32 v45, s34, v34
    v_add_u32 v34, 10, v7
    v_bfe_u32 v35, v34, 2, 1
    v_lshlrev_b32 v35, 1, v35
    v_xor_b32 v35, v35, v13
    v_lshlrev_b32 v34, 6, v34
    v_lshl_add_u32 v34, v35, 4, v34
    s_sub_u32 s34, s31, 512
    v_add_u32 v46, s34, v34
    v_add_u32 v34, 9, v7
    v_bfe_u32 v35, v34, 2, 1
    v_lshlrev_b32 v35, 1, v35
    v_xor_b32 v35, v35, v13
    v_lshlrev_b32 v34, 6, v34
    v_lshl_add_u32 v34, v35, 4, v34
    s_sub_u32 s34, s31, 512
    v_add_u32 v47, s34, v34
    s_waitcnt lgkmcnt(8)
    v_alignbit_b32 v128, v68, v67, 16
    v_alignbit_b32 v129, v69, v68, 16
    v_alignbit_b32 v130, v70, v69, 16
    v_alignbit_b32 v131, v71, v70, 16
    ds_write_b128 v20, v[128:131] offset:4160
    v_mov_b32 v132, v67
    v_mov_b32 v133, v68
    v_mov_b32 v134, v69
    v_mov_b32 v135, v70
    ds_write_b128 v20, v[132:135] offset:8320
    v_alignbit_b32 v136, v67, v66, 16
    v_mov_b32 v137, v128
    v_mov_b32 v138, v129
    v_mov_b32 v139, v130
    ds_write_b128 v20, v[136:139] offset:12480
    s_waitcnt lgkmcnt(9)
    v_alignbit_b32 v140, v76, v75, 16
    v_alignbit_b32 v141, v77, v76, 16
    v_alignbit_b32 v142, v78, v77, 16
    v_alignbit_b32 v143, v79, v78, 16
    ds_write_b128 v21, v[140:143] offset:4160
    v_mov_b32 v144, v75
    v_mov_b32 v145, v76
    v_mov_b32 v146, v77
    v_mov_b32 v147, v78
    ds_write_b128 v21, v[144:147] offset:8320
    v_alignbit_b32 v148, v75, v74, 16
    v_mov_b32 v149, v140
    v_mov_b32 v150, v141
    v_mov_b32 v151, v142
    ds_write_b128 v21, v[148:151] offset:12480
    s_waitcnt lgkmcnt(10)
    v_alignbit_b32 v152, v84, v83, 16
    v_alignbit_b32 v153, v85, v84, 16
    v_alignbit_b32 v154, v86, v85, 16
    v_alignbit_b32 v155, v87, v86, 16
    ds_write_b128 v22, v[152:155] offset:4160
    v_mov_b32 v156, v83
    v_mov_b32 v157, v84
    v_mov_b32 v158, v85
    v_mov_b32 v159, v86
    ds_write_b128 v22, v[156:159] offset:8320
    v_alignbit_b32 v160, v83, v82, 16
    v_mov_b32 v161, v152
    v_mov_b32 v162, v153
    v_mov_b32 v163, v154
    ds_write_b128 v22, v[160:163] offset:12480
    s_waitcnt lgkmcnt(11)
    v_alignbit_b32 v164, v92, v91, 16
    v_alignbit_b32 v165, v93, v92, 16
    v_alignbit_b32 v166, v94, v93, 16
    v_alignbit_b32 v167, v95, v94, 16
    ds_write_b128 v23, v[164:167] offset:4160
    v_mov_b32 v168, v91
    v_mov_b32 v169, v92
    v_mov_b32 v170, v93
    v_mov_b32 v171, v94
    ds_write_b128 v23, v[168:171] offset:8320
    v_alignbit_b32 v172, v91, v90, 16
    v_mov_b32 v173, v164
    v_mov_b32 v174, v165
    v_mov_b32 v175, v166
    ds_write_b128 v23, v[172:175] offset:12480
    s_waitcnt lgkmcnt(12)
    v_alignbit_b32 v176, v100, v99, 16
    v_alignbit_b32 v177, v101, v100, 16
    v_alignbit_b32 v178, v102, v101, 16
    v_alignbit_b32 v179, v103, v102, 16
    ds_write_b128 v24, v[176:179] offset:4160
    v_mov_b32 v180, v99
    v_mov_b32 v181, v100
    v_mov_b32 v182, v101
    v_mov_b32 v183, v102
    ds_write_b128 v24, v[180:183] offset:8320
    v_alignbit_b32 v184, v99, v98, 16
    v_mov_b32 v185, v176
    v_mov_b32 v186, v177
    v_mov_b32 v187, v178
    ds_write_b128 v24, v[184:187] offset:12480
    s_add_u32 s34, s30, 16640
    v_mul_u32_u24 v48, 144, v7
    v_lshl_add_u32 v48, v13, 4, v48
    v_add_u32 v48, s34, v48
    s_waitcnt lgkmcnt(0)
    s_setprio 2
    v_lshrrev_b32 v49, 1, v13
    v_and_b32 v50, 1, v13
    v_lshlrev_b32 v51, 5, v49
    v_lshl_add_u32 v51, v7, 1, v51
    v_add_u32 v51, v51, v50
    s_lshl_b32 s34, s27, 7
    v_add_u32 v51, s34, v51
    v_lshlrev_b32 v55, 3, v51
    s_mov_b32 s34, 45088768
    buffer_load_dword v236, v55, s[48:51], s34 offen
    s_mov_b32 s34, 45089280
    buffer_load_dword v237, v55, s[48:51], s34 offen
    s_mov_b32 s34, 45092864
    buffer_load_dword v238, v55, s[48:51], s34 offen
    s_mov_b32 s34, 45093376
    buffer_load_dword v239, v55, s[48:51], s34 offen
    s_mov_b32 s34, 45096960
    buffer_load_dword v240, v55, s[48:51], s34 offen
    s_mov_b32 s34, 45097472
    buffer_load_dword v241, v55, s[48:51], s34 offen
    s_mov_b32 s34, 45101056
    buffer_load_dword v242, v55, s[48:51], s34 offen
    s_mov_b32 s34, 45101568
    buffer_load_dword v243, v55, s[48:51], s34 offen
    s_movk_i32 s34, 1152
    v_mul_lo_u32 v51, v51, s34
    s_lshl_b32 s34, s27, 2
    v_add_u32 v49, s34, v49
    v_mul_u32_u24 v52, 144, v49
    v_lshl_add_u32 v52, v7, 3, v52
    v_lshl_add_u32 v52, v50, 2, v52
    v_add_u32 v52, 16640, v52
    v_add_u32 v53, 63232, v52
    s_lshl_b32 s34, s27, 12
    s_add_u32 s34, s34, 146944
    v_lshlrev_b32 v54, 4, v0
    v_add_u32 v54, s34, v54
    s_add_u32 s34, s30, 25856
    v_lshlrev_b32 v55, 4, v0
    v_add_u32 v55, s34, v55
    s_lshl_b32 s35, s25, 3
    s_mov_b32 s52, s20
    s_and_b32 s53, s21, 0xffff
    s_mov_b32 s54, 2359296
    s_mov_b32 s55, 0x00020000
    ds_read_b128 v[160:163], v40 offset:512
    ds_read_b64_tr_b16 v[128:129], v32 offset:8
    ds_read_b64_tr_b16 v[130:131], v32 offset:0
    ds_read_b64_tr_b16 v[132:133], v32 offset:40
    ds_read_b128 v[164:167], v40 offset:1536
    ds_read_b64_tr_b16 v[134:135], v32 offset:32
    ds_read_b64_tr_b16 v[136:137], v32 offset:1032
    ds_read_b128 v[168:171], v40 offset:2560
    ds_read_b64_tr_b16 v[138:139], v32 offset:1024
    ds_read_b64_tr_b16 v[140:141], v32 offset:1064
    ds_read_b128 v[172:175], v40 offset:3584
    ds_read_b64_tr_b16 v[142:143], v32 offset:1056
    s_waitcnt lgkmcnt(0)
    v_mfma_f32_16x16x32_bf16 v[64:67], v[128:131], v[160:163], 0
    ds_read_b128 v[176:179], v41 offset:512
    v_mfma_f32_16x16x32_bf16 v[68:71], v[132:135], v[160:163], 0
    ds_read_b64_tr_b16 v[144:145], v32 offset:72
    v_mfma_f32_16x16x32_bf16 v[72:75], v[128:131], v[164:167], 0
    ds_read_b64_tr_b16 v[146:147], v32 offset:64
    v_mfma_f32_16x16x32_bf16 v[76:79], v[132:135], v[164:167], 0
    ds_read_b64_tr_b16 v[148:149], v32 offset:104
    v_mfma_f32_16x16x32_bf16 v[80:83], v[128:131], v[168:171], 0
    ds_read_b128 v[180:183], v41 offset:1536
    v_mfma_f32_16x16x32_bf16 v[84:87], v[132:135], v[168:171], 0
    ds_read_b64_tr_b16 v[150:151], v32 offset:96
    v_mfma_f32_16x16x32_bf16 v[88:91], v[128:131], v[172:175], 0
    ds_read_b64_tr_b16 v[152:153], v32 offset:1096
    v_mfma_f32_16x16x32_bf16 v[92:95], v[132:135], v[172:175], 0
    ds_read_b128 v[184:187], v41 offset:2560
    v_mfma_f32_16x16x32_bf16 v[72:75], v[136:139], v[160:163], v[72:75]
    ds_read_b64_tr_b16 v[154:155], v32 offset:1088
    v_mfma_f32_16x16x32_bf16 v[76:79], v[140:143], v[160:163], v[76:79]
    ds_read_b64_tr_b16 v[156:157], v32 offset:1128
    v_mfma_f32_16x16x32_bf16 v[80:83], v[136:139], v[164:167], v[80:83]
    ds_read_b128 v[188:191], v41 offset:3584
    v_mfma_f32_16x16x32_bf16 v[84:87], v[140:143], v[164:167], v[84:87]
    ds_read_b64_tr_b16 v[158:159], v32 offset:1120
    v_mfma_f32_16x16x32_bf16 v[88:91], v[136:139], v[168:171], v[88:91]
    v_mfma_f32_16x16x32_bf16 v[92:95], v[140:143], v[168:171], v[92:95]
    s_waitcnt lgkmcnt(0)
    v_mfma_f32_16x16x32_bf16 v[64:67], v[144:147], v[176:179], v[64:67]
    ds_read_b128 v[160:163], v42 offset:512
    v_mfma_f32_16x16x32_bf16 v[68:71], v[148:151], v[176:179], v[68:71]
    ds_read_b64_tr_b16 v[128:129], v32 offset:136
    v_mfma_f32_16x16x32_bf16 v[72:75], v[144:147], v[180:183], v[72:75]
    ds_read_b64_tr_b16 v[130:131], v32 offset:128
    v_mfma_f32_16x16x32_bf16 v[76:79], v[148:151], v[180:183], v[76:79]
    ds_read_b64_tr_b16 v[132:133], v32 offset:168
    v_mfma_f32_16x16x32_bf16 v[80:83], v[144:147], v[184:187], v[80:83]
    ds_read_b128 v[164:167], v42 offset:1536
    v_mfma_f32_16x16x32_bf16 v[84:87], v[148:151], v[184:187], v[84:87]
    ds_read_b64_tr_b16 v[134:135], v32 offset:160
    v_mfma_f32_16x16x32_bf16 v[88:91], v[144:147], v[188:191], v[88:91]
    ds_read_b64_tr_b16 v[136:137], v32 offset:1160
    v_mfma_f32_16x16x32_bf16 v[92:95], v[148:151], v[188:191], v[92:95]
    ds_read_b128 v[168:171], v42 offset:2560
    v_mfma_f32_16x16x32_bf16 v[72:75], v[152:155], v[176:179], v[72:75]
    ds_read_b64_tr_b16 v[138:139], v32 offset:1152
    v_mfma_f32_16x16x32_bf16 v[76:79], v[156:159], v[176:179], v[76:79]
    ds_read_b64_tr_b16 v[140:141], v32 offset:1192
    v_mfma_f32_16x16x32_bf16 v[80:83], v[152:155], v[180:183], v[80:83]
    ds_read_b128 v[172:175], v42 offset:3584
    v_mfma_f32_16x16x32_bf16 v[84:87], v[156:159], v[180:183], v[84:87]
    ds_read_b64_tr_b16 v[142:143], v32 offset:1184
    v_mfma_f32_16x16x32_bf16 v[88:91], v[152:155], v[184:187], v[88:91]
    v_mfma_f32_16x16x32_bf16 v[92:95], v[156:159], v[184:187], v[92:95]
    s_waitcnt lgkmcnt(0)
    v_mfma_f32_16x16x32_bf16 v[64:67], v[128:131], v[160:163], v[64:67]
    ds_read_b128 v[176:179], v43 offset:512
    v_mfma_f32_16x16x32_bf16 v[68:71], v[132:135], v[160:163], v[68:71]
    ds_read_b64_tr_b16 v[144:145], v32 offset:200
    v_mfma_f32_16x16x32_bf16 v[72:75], v[128:131], v[164:167], v[72:75]
    ds_read_b64_tr_b16 v[146:147], v32 offset:192
    v_mfma_f32_16x16x32_bf16 v[76:79], v[132:135], v[164:167], v[76:79]
    ds_read_b64_tr_b16 v[148:149], v32 offset:232
    v_mfma_f32_16x16x32_bf16 v[80:83], v[128:131], v[168:171], v[80:83]
    ds_read_b128 v[180:183], v43 offset:1536
    v_mfma_f32_16x16x32_bf16 v[84:87], v[132:135], v[168:171], v[84:87]
    ds_read_b64_tr_b16 v[150:151], v32 offset:224
    v_mfma_f32_16x16x32_bf16 v[88:91], v[128:131], v[172:175], v[88:91]
    ds_read_b64_tr_b16 v[152:153], v32 offset:1224
    v_mfma_f32_16x16x32_bf16 v[92:95], v[132:135], v[172:175], v[92:95]
    ds_read_b128 v[184:187], v43 offset:2560
    v_mfma_f32_16x16x32_bf16 v[72:75], v[136:139], v[160:163], v[72:75]
    ds_read_b64_tr_b16 v[154:155], v32 offset:1216
    v_mfma_f32_16x16x32_bf16 v[76:79], v[140:143], v[160:163], v[76:79]
    ds_read_b64_tr_b16 v[156:157], v32 offset:1256
    v_mfma_f32_16x16x32_bf16 v[80:83], v[136:139], v[164:167], v[80:83]
    ds_read_b128 v[188:191], v43 offset:3584
    v_mfma_f32_16x16x32_bf16 v[84:87], v[140:143], v[164:167], v[84:87]
    ds_read_b64_tr_b16 v[158:159], v32 offset:1248
    v_mfma_f32_16x16x32_bf16 v[88:91], v[136:139], v[168:171], v[88:91]
    v_mfma_f32_16x16x32_bf16 v[92:95], v[140:143], v[168:171], v[92:95]
    s_waitcnt lgkmcnt(0)
    v_mfma_f32_16x16x32_bf16 v[64:67], v[144:147], v[176:179], v[64:67]
    ds_read_b128 v[160:163], v44 offset:512
    v_mfma_f32_16x16x32_bf16 v[68:71], v[148:151], v[176:179], v[68:71]
    ds_read_b64_tr_b16 v[128:129], v32 offset:264
    v_mfma_f32_16x16x32_bf16 v[72:75], v[144:147], v[180:183], v[72:75]
    ds_read_b64_tr_b16 v[130:131], v32 offset:256
    v_mfma_f32_16x16x32_bf16 v[76:79], v[148:151], v[180:183], v[76:79]
    ds_read_b64_tr_b16 v[132:133], v32 offset:296
    v_mfma_f32_16x16x32_bf16 v[80:83], v[144:147], v[184:187], v[80:83]
    ds_read_b128 v[164:167], v44 offset:1536
    v_mfma_f32_16x16x32_bf16 v[84:87], v[148:151], v[184:187], v[84:87]
    ds_read_b64_tr_b16 v[134:135], v32 offset:288
    v_mfma_f32_16x16x32_bf16 v[88:91], v[144:147], v[188:191], v[88:91]
    ds_read_b64_tr_b16 v[136:137], v32 offset:1288
    v_mfma_f32_16x16x32_bf16 v[92:95], v[148:151], v[188:191], v[92:95]
    ds_read_b128 v[168:171], v44 offset:2560
    v_mfma_f32_16x16x32_bf16 v[72:75], v[152:155], v[176:179], v[72:75]
    ds_read_b64_tr_b16 v[138:139], v32 offset:1280
    v_mfma_f32_16x16x32_bf16 v[76:79], v[156:159], v[176:179], v[76:79]
    ds_read_b64_tr_b16 v[140:141], v32 offset:1320
    v_mfma_f32_16x16x32_bf16 v[80:83], v[152:155], v[180:183], v[80:83]
    ds_read_b128 v[172:175], v44 offset:3584
    v_mfma_f32_16x16x32_bf16 v[84:87], v[156:159], v[180:183], v[84:87]
    ds_read_b64_tr_b16 v[142:143], v32 offset:1312
    v_mfma_f32_16x16x32_bf16 v[88:91], v[152:155], v[184:187], v[88:91]
    v_mfma_f32_16x16x32_bf16 v[92:95], v[156:159], v[184:187], v[92:95]
    s_waitcnt lgkmcnt(0)
    v_mfma_f32_16x16x32_bf16 v[64:67], v[128:131], v[160:163], v[64:67]
    ds_read_b128 v[176:179], v45 offset:512
    v_mfma_f32_16x16x32_bf16 v[68:71], v[132:135], v[160:163], v[68:71]
    ds_read_b64_tr_b16 v[144:145], v32 offset:328
    v_mfma_f32_16x16x32_bf16 v[72:75], v[128:131], v[164:167], v[72:75]
    ds_read_b64_tr_b16 v[146:147], v32 offset:320
    v_mfma_f32_16x16x32_bf16 v[76:79], v[132:135], v[164:167], v[76:79]
    ds_read_b64_tr_b16 v[148:149], v32 offset:360
    v_mfma_f32_16x16x32_bf16 v[80:83], v[128:131], v[168:171], v[80:83]
    ds_read_b128 v[180:183], v45 offset:1536
    v_mfma_f32_16x16x32_bf16 v[84:87], v[132:135], v[168:171], v[84:87]
    ds_read_b64_tr_b16 v[150:151], v32 offset:352
    v_mfma_f32_16x16x32_bf16 v[88:91], v[128:131], v[172:175], v[88:91]
    ds_read_b64_tr_b16 v[152:153], v32 offset:1352
    v_mfma_f32_16x16x32_bf16 v[92:95], v[132:135], v[172:175], v[92:95]
    ds_read_b128 v[184:187], v45 offset:2560
    v_mfma_f32_16x16x32_bf16 v[72:75], v[136:139], v[160:163], v[72:75]
    ds_read_b64_tr_b16 v[154:155], v32 offset:1344
    v_mfma_f32_16x16x32_bf16 v[76:79], v[140:143], v[160:163], v[76:79]
    ds_read_b64_tr_b16 v[156:157], v32 offset:1384
    v_mfma_f32_16x16x32_bf16 v[80:83], v[136:139], v[164:167], v[80:83]
    ds_read_b128 v[188:191], v45 offset:3584
    v_mfma_f32_16x16x32_bf16 v[84:87], v[140:143], v[164:167], v[84:87]
    ds_read_b64_tr_b16 v[158:159], v32 offset:1376
    v_mfma_f32_16x16x32_bf16 v[88:91], v[136:139], v[168:171], v[88:91]
    v_mfma_f32_16x16x32_bf16 v[92:95], v[140:143], v[168:171], v[92:95]
    s_waitcnt lgkmcnt(0)
    v_mfma_f32_16x16x32_bf16 v[64:67], v[144:147], v[176:179], v[64:67]
    ds_read_b128 v[160:163], v46 offset:512
    v_mfma_f32_16x16x32_bf16 v[68:71], v[148:151], v[176:179], v[68:71]
    ds_read_b64_tr_b16 v[128:129], v32 offset:392
    v_mfma_f32_16x16x32_bf16 v[72:75], v[144:147], v[180:183], v[72:75]
    ds_read_b64_tr_b16 v[130:131], v32 offset:384
    v_mfma_f32_16x16x32_bf16 v[76:79], v[148:151], v[180:183], v[76:79]
    ds_read_b64_tr_b16 v[132:133], v32 offset:424
    v_mfma_f32_16x16x32_bf16 v[80:83], v[144:147], v[184:187], v[80:83]
    ds_read_b128 v[164:167], v46 offset:1536
    v_mfma_f32_16x16x32_bf16 v[84:87], v[148:151], v[184:187], v[84:87]
    ds_read_b64_tr_b16 v[134:135], v32 offset:416
    v_mfma_f32_16x16x32_bf16 v[88:91], v[144:147], v[188:191], v[88:91]
    ds_read_b64_tr_b16 v[136:137], v32 offset:1416
    v_mfma_f32_16x16x32_bf16 v[92:95], v[148:151], v[188:191], v[92:95]
    ds_read_b128 v[168:171], v46 offset:2560
    v_mfma_f32_16x16x32_bf16 v[72:75], v[152:155], v[176:179], v[72:75]
    ds_read_b64_tr_b16 v[138:139], v32 offset:1408
    v_mfma_f32_16x16x32_bf16 v[76:79], v[156:159], v[176:179], v[76:79]
    ds_read_b64_tr_b16 v[140:141], v32 offset:1448
    v_mfma_f32_16x16x32_bf16 v[80:83], v[152:155], v[180:183], v[80:83]
    ds_read_b128 v[172:175], v46 offset:3584
    v_mfma_f32_16x16x32_bf16 v[84:87], v[156:159], v[180:183], v[84:87]
    ds_read_b64_tr_b16 v[142:143], v32 offset:1440
    v_mfma_f32_16x16x32_bf16 v[88:91], v[152:155], v[184:187], v[88:91]
    v_mfma_f32_16x16x32_bf16 v[92:95], v[156:159], v[184:187], v[92:95]
    s_waitcnt lgkmcnt(0)
    v_mfma_f32_16x16x32_bf16 v[64:67], v[128:131], v[160:163], v[64:67]
    ds_read_b128 v[176:179], v47 offset:512
    v_mfma_f32_16x16x32_bf16 v[68:71], v[132:135], v[160:163], v[68:71]
    ds_read_b64_tr_b16 v[144:145], v32 offset:456
    v_mfma_f32_16x16x32_bf16 v[72:75], v[128:131], v[164:167], v[72:75]
    ds_read_b64_tr_b16 v[146:147], v32 offset:448
    v_mfma_f32_16x16x32_bf16 v[76:79], v[132:135], v[164:167], v[76:79]
    ds_read_b64_tr_b16 v[148:149], v32 offset:488
    v_mfma_f32_16x16x32_bf16 v[80:83], v[128:131], v[168:171], v[80:83]
    ds_read_b128 v[180:183], v47 offset:1536
    v_mfma_f32_16x16x32_bf16 v[84:87], v[132:135], v[168:171], v[84:87]
    ds_read_b64_tr_b16 v[150:151], v32 offset:480
    v_mfma_f32_16x16x32_bf16 v[88:91], v[128:131], v[172:175], v[88:91]
    ds_read_b64_tr_b16 v[152:153], v32 offset:1480
    v_mfma_f32_16x16x32_bf16 v[92:95], v[132:135], v[172:175], v[92:95]
    ds_read_b128 v[184:187], v47 offset:2560
    v_mfma_f32_16x16x32_bf16 v[72:75], v[136:139], v[160:163], v[72:75]
    ds_read_b64_tr_b16 v[154:155], v32 offset:1472
    v_mfma_f32_16x16x32_bf16 v[76:79], v[140:143], v[160:163], v[76:79]
    ds_read_b64_tr_b16 v[156:157], v32 offset:1512
    v_mfma_f32_16x16x32_bf16 v[80:83], v[136:139], v[164:167], v[80:83]
    ds_read_b128 v[188:191], v47 offset:3584
    v_mfma_f32_16x16x32_bf16 v[84:87], v[140:143], v[164:167], v[84:87]
    ds_read_b64_tr_b16 v[158:159], v32 offset:1504
    v_mfma_f32_16x16x32_bf16 v[88:91], v[136:139], v[168:171], v[88:91]
    v_mfma_f32_16x16x32_bf16 v[92:95], v[140:143], v[168:171], v[92:95]
    s_waitcnt lgkmcnt(0)
    v_mfma_f32_16x16x32_bf16 v[64:67], v[144:147], v[176:179], v[64:67]
    ds_read_b128 v[160:163], v40 offset:0
    v_mfma_f32_16x16x32_bf16 v[68:71], v[148:151], v[176:179], v[68:71]
    ds_read_b64_tr_b16 v[128:129], v32 offset:520
    v_mfma_f32_16x16x32_bf16 v[72:75], v[144:147], v[180:183], v[72:75]
    ds_read_b64_tr_b16 v[130:131], v32 offset:512
    v_mfma_f32_16x16x32_bf16 v[76:79], v[148:151], v[180:183], v[76:79]
    ds_read_b64_tr_b16 v[132:133], v32 offset:552
    v_mfma_f32_16x16x32_bf16 v[80:83], v[144:147], v[184:187], v[80:83]
    ds_read_b128 v[164:167], v40 offset:1024
    v_mfma_f32_16x16x32_bf16 v[84:87], v[148:151], v[184:187], v[84:87]
    ds_read_b64_tr_b16 v[134:135], v32 offset:544
    v_mfma_f32_16x16x32_bf16 v[88:91], v[144:147], v[188:191], v[88:91]
    ds_read_b64_tr_b16 v[136:137], v32 offset:1544
    v_mfma_f32_16x16x32_bf16 v[92:95], v[148:151], v[188:191], v[92:95]
    ds_read_b128 v[168:171], v40 offset:2048
    v_mfma_f32_16x16x32_bf16 v[72:75], v[152:155], v[176:179], v[72:75]
    ds_read_b64_tr_b16 v[138:139], v32 offset:1536
    v_mfma_f32_16x16x32_bf16 v[76:79], v[156:159], v[176:179], v[76:79]
    ds_read_b64_tr_b16 v[140:141], v32 offset:1576
    v_mfma_f32_16x16x32_bf16 v[80:83], v[152:155], v[180:183], v[80:83]
    ds_read_b128 v[172:175], v40 offset:3072
    v_mfma_f32_16x16x32_bf16 v[84:87], v[156:159], v[180:183], v[84:87]
    ds_read_b64_tr_b16 v[142:143], v32 offset:1568
    v_mfma_f32_16x16x32_bf16 v[88:91], v[152:155], v[184:187], v[88:91]
    v_mfma_f32_16x16x32_bf16 v[92:95], v[156:159], v[184:187], v[92:95]
    s_waitcnt lgkmcnt(0)
    v_mfma_f32_16x16x32_bf16 v[64:67], v[128:131], v[160:163], v[64:67]
    ds_read_b128 v[176:179], v41 offset:0
    v_mfma_f32_16x16x32_bf16 v[68:71], v[132:135], v[160:163], v[68:71]
    ds_read_b64_tr_b16 v[144:145], v32 offset:584
    v_mfma_f32_16x16x32_bf16 v[72:75], v[128:131], v[164:167], v[72:75]
    ds_read_b64_tr_b16 v[146:147], v32 offset:576
    v_mfma_f32_16x16x32_bf16 v[76:79], v[132:135], v[164:167], v[76:79]
    ds_read_b64_tr_b16 v[148:149], v32 offset:616
    v_mfma_f32_16x16x32_bf16 v[80:83], v[128:131], v[168:171], v[80:83]
    ds_read_b128 v[180:183], v41 offset:1024
    v_mfma_f32_16x16x32_bf16 v[84:87], v[132:135], v[168:171], v[84:87]
    ds_read_b64_tr_b16 v[150:151], v32 offset:608
    v_mfma_f32_16x16x32_bf16 v[88:91], v[128:131], v[172:175], v[88:91]
    ds_read_b64_tr_b16 v[152:153], v32 offset:1608
    v_mfma_f32_16x16x32_bf16 v[92:95], v[132:135], v[172:175], v[92:95]
    ds_read_b128 v[184:187], v41 offset:2048
    v_mfma_f32_16x16x32_bf16 v[72:75], v[136:139], v[160:163], v[72:75]
    ds_read_b64_tr_b16 v[154:155], v32 offset:1600
    v_mfma_f32_16x16x32_bf16 v[76:79], v[140:143], v[160:163], v[76:79]
    ds_read_b64_tr_b16 v[156:157], v32 offset:1640
    v_mfma_f32_16x16x32_bf16 v[80:83], v[136:139], v[164:167], v[80:83]
    ds_read_b128 v[188:191], v41 offset:3072
    v_mfma_f32_16x16x32_bf16 v[84:87], v[140:143], v[164:167], v[84:87]
    ds_read_b64_tr_b16 v[158:159], v32 offset:1632
    v_mfma_f32_16x16x32_bf16 v[88:91], v[136:139], v[168:171], v[88:91]
    v_mfma_f32_16x16x32_bf16 v[92:95], v[140:143], v[168:171], v[92:95]
    s_waitcnt lgkmcnt(0)
    v_mfma_f32_16x16x32_bf16 v[64:67], v[144:147], v[176:179], v[64:67]
    ds_read_b128 v[160:163], v42 offset:0
    v_mfma_f32_16x16x32_bf16 v[68:71], v[148:151], v[176:179], v[68:71]
    ds_read_b64_tr_b16 v[128:129], v32 offset:648
    v_mfma_f32_16x16x32_bf16 v[72:75], v[144:147], v[180:183], v[72:75]
    ds_read_b64_tr_b16 v[130:131], v32 offset:640
    v_mfma_f32_16x16x32_bf16 v[76:79], v[148:151], v[180:183], v[76:79]
    ds_read_b64_tr_b16 v[132:133], v32 offset:680
    v_mfma_f32_16x16x32_bf16 v[80:83], v[144:147], v[184:187], v[80:83]
    ds_read_b128 v[164:167], v42 offset:1024
    v_mfma_f32_16x16x32_bf16 v[84:87], v[148:151], v[184:187], v[84:87]
    ds_read_b64_tr_b16 v[134:135], v32 offset:672
    v_mfma_f32_16x16x32_bf16 v[88:91], v[144:147], v[188:191], v[88:91]
    ds_read_b64_tr_b16 v[136:137], v32 offset:1672
    v_mfma_f32_16x16x32_bf16 v[92:95], v[148:151], v[188:191], v[92:95]
    ds_read_b128 v[168:171], v42 offset:2048
    v_mfma_f32_16x16x32_bf16 v[72:75], v[152:155], v[176:179], v[72:75]
    ds_read_b64_tr_b16 v[138:139], v32 offset:1664
    v_mfma_f32_16x16x32_bf16 v[76:79], v[156:159], v[176:179], v[76:79]
    ds_read_b64_tr_b16 v[140:141], v32 offset:1704
    v_mfma_f32_16x16x32_bf16 v[80:83], v[152:155], v[180:183], v[80:83]
    ds_read_b128 v[172:175], v42 offset:3072
    v_mfma_f32_16x16x32_bf16 v[84:87], v[156:159], v[180:183], v[84:87]
    ds_read_b64_tr_b16 v[142:143], v32 offset:1696
    v_mfma_f32_16x16x32_bf16 v[88:91], v[152:155], v[184:187], v[88:91]
    v_mfma_f32_16x16x32_bf16 v[92:95], v[156:159], v[184:187], v[92:95]
    s_waitcnt lgkmcnt(0)
    v_mfma_f32_16x16x32_bf16 v[64:67], v[128:131], v[160:163], v[64:67]
    ds_read_b128 v[176:179], v43 offset:0
    v_mfma_f32_16x16x32_bf16 v[68:71], v[132:135], v[160:163], v[68:71]
    ds_read_b64_tr_b16 v[144:145], v32 offset:712
    v_mfma_f32_16x16x32_bf16 v[72:75], v[128:131], v[164:167], v[72:75]
    ds_read_b64_tr_b16 v[146:147], v32 offset:704
    v_mfma_f32_16x16x32_bf16 v[76:79], v[132:135], v[164:167], v[76:79]
    ds_read_b64_tr_b16 v[148:149], v32 offset:744
    v_mfma_f32_16x16x32_bf16 v[80:83], v[128:131], v[168:171], v[80:83]
    ds_read_b128 v[180:183], v43 offset:1024
    v_mfma_f32_16x16x32_bf16 v[84:87], v[132:135], v[168:171], v[84:87]
    ds_read_b64_tr_b16 v[150:151], v32 offset:736
    v_mfma_f32_16x16x32_bf16 v[88:91], v[128:131], v[172:175], v[88:91]
    ds_read_b64_tr_b16 v[152:153], v32 offset:1736
    v_mfma_f32_16x16x32_bf16 v[92:95], v[132:135], v[172:175], v[92:95]
    ds_read_b128 v[184:187], v43 offset:2048
    v_mfma_f32_16x16x32_bf16 v[72:75], v[136:139], v[160:163], v[72:75]
    ds_read_b64_tr_b16 v[154:155], v32 offset:1728
    v_mfma_f32_16x16x32_bf16 v[76:79], v[140:143], v[160:163], v[76:79]
    ds_read_b64_tr_b16 v[156:157], v32 offset:1768
    v_mfma_f32_16x16x32_bf16 v[80:83], v[136:139], v[164:167], v[80:83]
    ds_read_b128 v[188:191], v43 offset:3072
    v_mfma_f32_16x16x32_bf16 v[84:87], v[140:143], v[164:167], v[84:87]
    ds_read_b64_tr_b16 v[158:159], v32 offset:1760
    v_mfma_f32_16x16x32_bf16 v[88:91], v[136:139], v[168:171], v[88:91]
    v_mfma_f32_16x16x32_bf16 v[92:95], v[140:143], v[168:171], v[92:95]
    s_waitcnt lgkmcnt(0)
    v_mfma_f32_16x16x32_bf16 v[64:67], v[144:147], v[176:179], v[64:67]
    ds_read_b128 v[160:163], v44 offset:0
    v_mfma_f32_16x16x32_bf16 v[68:71], v[148:151], v[176:179], v[68:71]
    ds_read_b64_tr_b16 v[128:129], v32 offset:776
    v_mfma_f32_16x16x32_bf16 v[72:75], v[144:147], v[180:183], v[72:75]
    ds_read_b64_tr_b16 v[130:131], v32 offset:768
    v_mfma_f32_16x16x32_bf16 v[76:79], v[148:151], v[180:183], v[76:79]
    ds_read_b64_tr_b16 v[132:133], v32 offset:808
    v_mfma_f32_16x16x32_bf16 v[80:83], v[144:147], v[184:187], v[80:83]
    ds_read_b128 v[164:167], v44 offset:1024
    v_mfma_f32_16x16x32_bf16 v[84:87], v[148:151], v[184:187], v[84:87]
    ds_read_b64_tr_b16 v[134:135], v32 offset:800
    v_mfma_f32_16x16x32_bf16 v[88:91], v[144:147], v[188:191], v[88:91]
    ds_read_b64_tr_b16 v[136:137], v32 offset:1800
    v_mfma_f32_16x16x32_bf16 v[92:95], v[148:151], v[188:191], v[92:95]
    ds_read_b128 v[168:171], v44 offset:2048
    v_mfma_f32_16x16x32_bf16 v[72:75], v[152:155], v[176:179], v[72:75]
    ds_read_b64_tr_b16 v[138:139], v32 offset:1792
    v_mfma_f32_16x16x32_bf16 v[76:79], v[156:159], v[176:179], v[76:79]
    ds_read_b64_tr_b16 v[140:141], v32 offset:1832
    v_mfma_f32_16x16x32_bf16 v[80:83], v[152:155], v[180:183], v[80:83]
    ds_read_b128 v[172:175], v44 offset:3072
    v_mfma_f32_16x16x32_bf16 v[84:87], v[156:159], v[180:183], v[84:87]
    ds_read_b64_tr_b16 v[142:143], v32 offset:1824
    v_mfma_f32_16x16x32_bf16 v[88:91], v[152:155], v[184:187], v[88:91]
    v_mfma_f32_16x16x32_bf16 v[92:95], v[156:159], v[184:187], v[92:95]
    s_waitcnt lgkmcnt(0)
    v_mfma_f32_16x16x32_bf16 v[64:67], v[128:131], v[160:163], v[64:67]
    ds_read_b128 v[176:179], v45 offset:0
    v_mfma_f32_16x16x32_bf16 v[68:71], v[132:135], v[160:163], v[68:71]
    ds_read_b64_tr_b16 v[144:145], v32 offset:840
    v_mfma_f32_16x16x32_bf16 v[72:75], v[128:131], v[164:167], v[72:75]
    ds_read_b64_tr_b16 v[146:147], v32 offset:832
    v_mfma_f32_16x16x32_bf16 v[76:79], v[132:135], v[164:167], v[76:79]
    ds_read_b64_tr_b16 v[148:149], v32 offset:872
    v_mfma_f32_16x16x32_bf16 v[80:83], v[128:131], v[168:171], v[80:83]
    ds_read_b128 v[180:183], v45 offset:1024
    v_mfma_f32_16x16x32_bf16 v[84:87], v[132:135], v[168:171], v[84:87]
    ds_read_b64_tr_b16 v[150:151], v32 offset:864
    v_mfma_f32_16x16x32_bf16 v[88:91], v[128:131], v[172:175], v[88:91]
    ds_read_b64_tr_b16 v[152:153], v32 offset:1864
    v_mfma_f32_16x16x32_bf16 v[92:95], v[132:135], v[172:175], v[92:95]
    ds_read_b128 v[184:187], v45 offset:2048
    v_mfma_f32_16x16x32_bf16 v[72:75], v[136:139], v[160:163], v[72:75]
    ds_read_b64_tr_b16 v[154:155], v32 offset:1856
    v_mfma_f32_16x16x32_bf16 v[76:79], v[140:143], v[160:163], v[76:79]
    ds_read_b64_tr_b16 v[156:157], v32 offset:1896
    v_mfma_f32_16x16x32_bf16 v[80:83], v[136:139], v[164:167], v[80:83]
    ds_read_b128 v[188:191], v45 offset:3072
    v_mfma_f32_16x16x32_bf16 v[84:87], v[140:143], v[164:167], v[84:87]
    ds_read_b64_tr_b16 v[158:159], v32 offset:1888
    v_mfma_f32_16x16x32_bf16 v[88:91], v[136:139], v[168:171], v[88:91]
    v_mfma_f32_16x16x32_bf16 v[92:95], v[140:143], v[168:171], v[92:95]
    s_waitcnt lgkmcnt(0)
    v_mfma_f32_16x16x32_bf16 v[64:67], v[144:147], v[176:179], v[64:67]
    ds_read_b128 v[160:163], v46 offset:0
    v_mfma_f32_16x16x32_bf16 v[68:71], v[148:151], v[176:179], v[68:71]
    ds_read_b64_tr_b16 v[128:129], v32 offset:904
    v_mfma_f32_16x16x32_bf16 v[72:75], v[144:147], v[180:183], v[72:75]
    ds_read_b64_tr_b16 v[130:131], v32 offset:896
    v_mfma_f32_16x16x32_bf16 v[76:79], v[148:151], v[180:183], v[76:79]
    ds_read_b64_tr_b16 v[132:133], v32 offset:936
    v_mfma_f32_16x16x32_bf16 v[80:83], v[144:147], v[184:187], v[80:83]
    ds_read_b128 v[164:167], v46 offset:1024
    v_mfma_f32_16x16x32_bf16 v[84:87], v[148:151], v[184:187], v[84:87]
    ds_read_b64_tr_b16 v[134:135], v32 offset:928
    v_mfma_f32_16x16x32_bf16 v[88:91], v[144:147], v[188:191], v[88:91]
    ds_read_b64_tr_b16 v[136:137], v32 offset:1928
    v_mfma_f32_16x16x32_bf16 v[92:95], v[148:151], v[188:191], v[92:95]
    ds_read_b128 v[168:171], v46 offset:2048
    v_mfma_f32_16x16x32_bf16 v[72:75], v[152:155], v[176:179], v[72:75]
    ds_read_b64_tr_b16 v[138:139], v32 offset:1920
    v_mfma_f32_16x16x32_bf16 v[76:79], v[156:159], v[176:179], v[76:79]
    ds_read_b64_tr_b16 v[140:141], v32 offset:1960
    v_mfma_f32_16x16x32_bf16 v[80:83], v[152:155], v[180:183], v[80:83]
    ds_read_b128 v[172:175], v46 offset:3072
    v_mfma_f32_16x16x32_bf16 v[84:87], v[156:159], v[180:183], v[84:87]
    ds_read_b64_tr_b16 v[142:143], v32 offset:1952
    v_mfma_f32_16x16x32_bf16 v[88:91], v[152:155], v[184:187], v[88:91]
    v_mfma_f32_16x16x32_bf16 v[92:95], v[156:159], v[184:187], v[92:95]
    s_waitcnt lgkmcnt(0)
    v_mfma_f32_16x16x32_bf16 v[64:67], v[128:131], v[160:163], v[64:67]
    ds_read_b128 v[176:179], v47 offset:0
    v_mfma_f32_16x16x32_bf16 v[68:71], v[132:135], v[160:163], v[68:71]
    ds_read_b64_tr_b16 v[144:145], v32 offset:968
    v_mfma_f32_16x16x32_bf16 v[72:75], v[128:131], v[164:167], v[72:75]
    ds_read_b64_tr_b16 v[146:147], v32 offset:960
    v_mfma_f32_16x16x32_bf16 v[76:79], v[132:135], v[164:167], v[76:79]
    ds_read_b64_tr_b16 v[148:149], v32 offset:1000
    v_mfma_f32_16x16x32_bf16 v[80:83], v[128:131], v[168:171], v[80:83]
    ds_read_b128 v[180:183], v47 offset:1024
    v_mfma_f32_16x16x32_bf16 v[84:87], v[132:135], v[168:171], v[84:87]
    ds_read_b64_tr_b16 v[150:151], v32 offset:992
    v_mfma_f32_16x16x32_bf16 v[88:91], v[128:131], v[172:175], v[88:91]
    ds_read_b64_tr_b16 v[152:153], v32 offset:1992
    v_mfma_f32_16x16x32_bf16 v[92:95], v[132:135], v[172:175], v[92:95]
    ds_read_b128 v[184:187], v47 offset:2048
    v_mfma_f32_16x16x32_bf16 v[72:75], v[136:139], v[160:163], v[72:75]
    ds_read_b64_tr_b16 v[154:155], v32 offset:1984
    v_mfma_f32_16x16x32_bf16 v[76:79], v[140:143], v[160:163], v[76:79]
    ds_read_b64_tr_b16 v[156:157], v32 offset:2024
    v_mfma_f32_16x16x32_bf16 v[80:83], v[136:139], v[164:167], v[80:83]
    ds_read_b128 v[188:191], v47 offset:3072
    v_mfma_f32_16x16x32_bf16 v[84:87], v[140:143], v[164:167], v[84:87]
    ds_read_b64_tr_b16 v[158:159], v32 offset:2016
    v_mfma_f32_16x16x32_bf16 v[88:91], v[136:139], v[168:171], v[88:91]
    v_mfma_f32_16x16x32_bf16 v[92:95], v[140:143], v[168:171], v[92:95]
    s_waitcnt lgkmcnt(0)
    v_mfma_f32_16x16x32_bf16 v[64:67], v[144:147], v[176:179], v[64:67]
    ds_read_b128 v[160:163], v40 offset:512
    v_mfma_f32_16x16x32_bf16 v[68:71], v[148:151], v[176:179], v[68:71]
    ds_read_b64_tr_b16 v[128:129], v32 offset:2056
    v_mfma_f32_16x16x32_bf16 v[72:75], v[144:147], v[180:183], v[72:75]
    ds_read_b64_tr_b16 v[130:131], v32 offset:2048
    v_mfma_f32_16x16x32_bf16 v[76:79], v[148:151], v[180:183], v[76:79]
    ds_read_b64_tr_b16 v[132:133], v32 offset:2088
    v_mfma_f32_16x16x32_bf16 v[80:83], v[144:147], v[184:187], v[80:83]
    ds_read_b128 v[164:167], v40 offset:1536
    v_mfma_f32_16x16x32_bf16 v[84:87], v[148:151], v[184:187], v[84:87]
    ds_read_b64_tr_b16 v[134:135], v32 offset:2080
    v_mfma_f32_16x16x32_bf16 v[88:91], v[144:147], v[188:191], v[88:91]
    ds_read_b64_tr_b16 v[136:137], v32 offset:3080
    v_mfma_f32_16x16x32_bf16 v[92:95], v[148:151], v[188:191], v[92:95]
    ds_read_b64_tr_b16 v[138:139], v32 offset:3072
    v_mfma_f32_16x16x32_bf16 v[72:75], v[152:155], v[176:179], v[72:75]
    ds_read_b64_tr_b16 v[140:141], v32 offset:3112
    v_mfma_f32_16x16x32_bf16 v[76:79], v[156:159], v[176:179], v[76:79]
    ds_read_b64_tr_b16 v[142:143], v32 offset:3104
    v_mfma_f32_16x16x32_bf16 v[80:83], v[152:155], v[180:183], v[80:83]
    v_mfma_f32_16x16x32_bf16 v[84:87], v[156:159], v[180:183], v[84:87]
    v_mfma_f32_16x16x32_bf16 v[88:91], v[152:155], v[184:187], v[88:91]
    v_mfma_f32_16x16x32_bf16 v[92:95], v[156:159], v[184:187], v[92:95]
    ds_write_b128 v48, v[64:67] offset:0
    ds_write_b128 v48, v[68:71] offset:64
    ds_write_b128 v48, v[72:75] offset:2304
    ds_write_b128 v48, v[76:79] offset:2368
    s_waitcnt lgkmcnt(0)
    s_barrier
    v_mfma_f32_16x16x32_bf16 v[80:83], v[128:131], v[160:163], v[80:83]
    ds_read_b128 v[176:179], v41 offset:512
    ds_read_b64_tr_b16 v[144:145], v32 offset:2120
    v_mfma_f32_16x16x32_bf16 v[84:87], v[132:135], v[160:163], v[84:87]
    ds_read_b64_tr_b16 v[146:147], v32 offset:2112
    ds_read_b64_tr_b16 v[148:149], v32 offset:2152
    v_mfma_f32_16x16x32_bf16 v[88:91], v[128:131], v[164:167], v[88:91]
    ds_read_b128 v[180:183], v41 offset:1536
    ds_read_b64_tr_b16 v[150:151], v32 offset:2144
    v_mfma_f32_16x16x32_bf16 v[92:95], v[132:135], v[164:167], v[92:95]
    ds_read_b64_tr_b16 v[152:153], v32 offset:3144
    ds_read_b64_tr_b16 v[154:155], v32 offset:3136
    v_mfma_f32_16x16x32_bf16 v[88:91], v[136:139], v[160:163], v[88:91]
    ds_read_b64_tr_b16 v[156:157], v32 offset:3176
    ds_read_b64_tr_b16 v[158:159], v32 offset:3168
    v_mfma_f32_16x16x32_bf16 v[92:95], v[140:143], v[160:163], v[92:95]
    s_waitcnt lgkmcnt(0)
    v_mfma_f32_16x16x32_bf16 v[80:83], v[144:147], v[176:179], v[80:83]
    ds_read_b128 v[160:163], v42 offset:512
    ds_read_b64_tr_b16 v[128:129], v32 offset:2184
    v_mfma_f32_16x16x32_bf16 v[84:87], v[148:151], v[176:179], v[84:87]
    ds_read_b64_tr_b16 v[130:131], v32 offset:2176
    ds_read_b64_tr_b16 v[132:133], v32 offset:2216
    v_mfma_f32_16x16x32_bf16 v[88:91], v[144:147], v[180:183], v[88:91]
    ds_read_b128 v[164:167], v42 offset:1536
    ds_read_b64_tr_b16 v[134:135], v32 offset:2208
    v_mfma_f32_16x16x32_bf16 v[92:95], v[148:151], v[180:183], v[92:95]
    ds_read_b64_tr_b16 v[136:137], v32 offset:3208
    ds_read_b64_tr_b16 v[138:139], v32 offset:3200
    v_mfma_f32_16x16x32_bf16 v[88:91], v[152:155], v[176:179], v[88:91]
    ds_read_b64_tr_b16 v[140:141], v32 offset:3240
    ds_read_b64_tr_b16 v[142:143], v32 offset:3232
    ds_read_b128 v[208:211], v54 offset:0
    v_mfma_f32_16x16x32_bf16 v[92:95], v[156:159], v[176:179], v[92:95]
    ds_read_b32 v220, v52 offset:0
    s_waitcnt lgkmcnt(2)
    v_mfma_f32_16x16x32_bf16 v[80:83], v[128:131], v[160:163], v[80:83]
    ds_read_b128 v[176:179], v43 offset:512
    ds_read_b64_tr_b16 v[144:145], v32 offset:2248
    v_mfma_f32_16x16x32_bf16 v[84:87], v[132:135], v[160:163], v[84:87]
    ds_read_b64_tr_b16 v[146:147], v32 offset:2240
    ds_read_b64_tr_b16 v[148:149], v32 offset:2280
    v_mfma_f32_16x16x32_bf16 v[88:91], v[128:131], v[164:167], v[88:91]
    ds_read_b128 v[180:183], v43 offset:1536
    ds_read_b64_tr_b16 v[150:151], v32 offset:2272
    v_mfma_f32_16x16x32_bf16 v[92:95], v[132:135], v[164:167], v[92:95]
    ds_read_b64_tr_b16 v[152:153], v32 offset:3272
    ds_read_b64_tr_b16 v[154:155], v32 offset:3264
    v_mfma_f32_16x16x32_bf16 v[88:91], v[136:139], v[160:163], v[88:91]
    ds_read_b64_tr_b16 v[156:157], v32 offset:3304
    ds_read_b64_tr_b16 v[158:159], v32 offset:3296
    ds_read_b32 v221, v52 offset:31616
    v_mfma_f32_16x16x32_bf16 v[92:95], v[140:143], v[160:163], v[92:95]
    ds_read_b32 v222, v53 offset:0
    s_waitcnt lgkmcnt(2)
    v_mfma_f32_16x16x32_bf16 v[80:83], v[144:147], v[176:179], v[80:83]
    ds_read_b128 v[160:163], v44 offset:512
    ds_read_b64_tr_b16 v[128:129], v32 offset:2312
    v_mfma_f32_16x16x32_bf16 v[84:87], v[148:151], v[176:179], v[84:87]
    ds_read_b64_tr_b16 v[130:131], v32 offset:2304
    ds_read_b64_tr_b16 v[132:133], v32 offset:2344
    v_mfma_f32_16x16x32_bf16 v[88:91], v[144:147], v[180:183], v[88:91]
    ds_read_b128 v[164:167], v44 offset:1536
    ds_read_b64_tr_b16 v[134:135], v32 offset:2336
    v_mfma_f32_16x16x32_bf16 v[92:95], v[148:151], v[180:183], v[92:95]
    ds_read_b64_tr_b16 v[136:137], v32 offset:3336
    ds_read_b64_tr_b16 v[138:139], v32 offset:3328
    v_mfma_f32_16x16x32_bf16 v[88:91], v[152:155], v[176:179], v[88:91]
    ds_read_b64_tr_b16 v[140:141], v32 offset:3368
    ds_read_b64_tr_b16 v[142:143], v32 offset:3360
    ds_read_b32 v223, v53 offset:31616
    v_mfma_f32_16x16x32_bf16 v[92:95], v[156:159], v[176:179], v[92:95]
    ds_read_b128 v[212:215], v54 offset:1024
    s_waitcnt lgkmcnt(2)
    v_mfma_f32_16x16x32_bf16 v[80:83], v[128:131], v[160:163], v[80:83]
    ds_read_b128 v[176:179], v45 offset:512
    ds_read_b64_tr_b16 v[144:145], v32 offset:2376
    v_mfma_f32_16x16x32_bf16 v[84:87], v[132:135], v[160:163], v[84:87]
    ds_read_b64_tr_b16 v[146:147], v32 offset:2368
    ds_read_b64_tr_b16 v[148:149], v32 offset:2408
    v_mfma_f32_16x16x32_bf16 v[88:91], v[128:131], v[164:167], v[88:91]
    ds_read_b128 v[180:183], v45 offset:1536
    ds_read_b64_tr_b16 v[150:151], v32 offset:2400
    v_mfma_f32_16x16x32_bf16 v[92:95], v[132:135], v[164:167], v[92:95]
    ds_read_b64_tr_b16 v[152:153], v32 offset:3400
    ds_read_b64_tr_b16 v[154:155], v32 offset:3392
    v_mfma_f32_16x16x32_bf16 v[88:91], v[136:139], v[160:163], v[88:91]
    ds_read_b64_tr_b16 v[156:157], v32 offset:3432
    ds_read_b64_tr_b16 v[158:159], v32 offset:3424
    ds_read_b32 v224, v52 offset:288
    v_mfma_f32_16x16x32_bf16 v[92:95], v[140:143], v[160:163], v[92:95]
    ds_read_b32 v225, v52 offset:31904
    s_waitcnt lgkmcnt(2)
    v_mfma_f32_16x16x32_bf16 v[80:83], v[144:147], v[176:179], v[80:83]
    ds_read_b128 v[160:163], v46 offset:512
    ds_read_b64_tr_b16 v[128:129], v32 offset:2440
    v_mfma_f32_16x16x32_bf16 v[84:87], v[148:151], v[176:179], v[84:87]
    ds_read_b64_tr_b16 v[130:131], v32 offset:2432
    ds_read_b64_tr_b16 v[132:133], v32 offset:2472
    v_mfma_f32_16x16x32_bf16 v[88:91], v[144:147], v[180:183], v[88:91]
    ds_read_b128 v[164:167], v46 offset:1536
    ds_read_b64_tr_b16 v[134:135], v32 offset:2464
    v_mfma_f32_16x16x32_bf16 v[92:95], v[148:151], v[180:183], v[92:95]
    ds_read_b64_tr_b16 v[136:137], v32 offset:3464
    ds_read_b64_tr_b16 v[138:139], v32 offset:3456
    v_mfma_f32_16x16x32_bf16 v[88:91], v[152:155], v[176:179], v[88:91]
    ds_read_b64_tr_b16 v[140:141], v32 offset:3496
    ds_read_b64_tr_b16 v[142:143], v32 offset:3488
    ds_read_b32 v226, v53 offset:288
    v_mfma_f32_16x16x32_bf16 v[92:95], v[156:159], v[176:179], v[92:95]
    ds_read_b32 v227, v53 offset:31904
    s_waitcnt lgkmcnt(2)
    v_mfma_f32_16x16x32_bf16 v[80:83], v[128:131], v[160:163], v[80:83]
    ds_read_b128 v[176:179], v47 offset:512
    ds_read_b64_tr_b16 v[144:145], v32 offset:2504
    v_mfma_f32_16x16x32_bf16 v[84:87], v[132:135], v[160:163], v[84:87]
    ds_read_b64_tr_b16 v[146:147], v32 offset:2496
    ds_read_b64_tr_b16 v[148:149], v32 offset:2536
    v_mfma_f32_16x16x32_bf16 v[88:91], v[128:131], v[164:167], v[88:91]
    ds_read_b128 v[180:183], v47 offset:1536
    ds_read_b64_tr_b16 v[150:151], v32 offset:2528
    v_mfma_f32_16x16x32_bf16 v[92:95], v[132:135], v[164:167], v[92:95]
    ds_read_b64_tr_b16 v[152:153], v32 offset:3528
    ds_read_b64_tr_b16 v[154:155], v32 offset:3520
    v_mfma_f32_16x16x32_bf16 v[88:91], v[136:139], v[160:163], v[88:91]
    ds_read_b64_tr_b16 v[156:157], v32 offset:3560
    ds_read_b64_tr_b16 v[158:159], v32 offset:3552
    s_waitcnt lgkmcnt(10)
    v_mfma_f32_16x16x32_bf16 v[92:95], v[140:143], v[160:163], v[92:95]
    s_waitcnt vmcnt(0)
    s_waitcnt lgkmcnt(0)
    v_mfma_f32_16x16x32_bf16 v[80:83], v[144:147], v[176:179], v[80:83]
    ds_read_b128 v[160:163], v40 offset:0
    ds_read_b64_tr_b16 v[128:129], v32 offset:2568
    v_mfma_f32_16x16x32_bf16 v[84:87], v[148:151], v[176:179], v[84:87]
    ds_read_b64_tr_b16 v[130:131], v32 offset:2560
    ds_read_b64_tr_b16 v[132:133], v32 offset:2600
    v_mfma_f32_16x16x32_bf16 v[88:91], v[144:147], v[180:183], v[88:91]
    ds_read_b128 v[164:167], v40 offset:1024
    ds_read_b64_tr_b16 v[134:135], v32 offset:2592
    v_mfma_f32_16x16x32_bf16 v[92:95], v[148:151], v[180:183], v[92:95]
    ds_read_b64_tr_b16 v[136:137], v32 offset:3592
    ds_read_b64_tr_b16 v[138:139], v32 offset:3584
    v_mfma_f32_16x16x32_bf16 v[88:91], v[152:155], v[176:179], v[88:91]
    ds_read_b64_tr_b16 v[140:141], v32 offset:3624
    ds_read_b64_tr_b16 v[142:143], v32 offset:3616
    v_fma_f32 v208, v236, v220, v208
    v_mfma_f32_16x16x32_bf16 v[92:95], v[156:159], v[176:179], v[92:95]
    v_fma_f32 v209, v236, v221, v209
    s_waitcnt lgkmcnt(0)
    v_mfma_f32_16x16x32_bf16 v[80:83], v[128:131], v[160:163], v[80:83]
    ds_read_b128 v[176:179], v41 offset:0
    ds_read_b64_tr_b16 v[144:145], v32 offset:2632
    v_mfma_f32_16x16x32_bf16 v[84:87], v[132:135], v[160:163], v[84:87]
    ds_read_b64_tr_b16 v[146:147], v32 offset:2624
    ds_read_b64_tr_b16 v[148:149], v32 offset:2664
    v_mfma_f32_16x16x32_bf16 v[88:91], v[128:131], v[164:167], v[88:91]
    ds_read_b128 v[180:183], v41 offset:1024
    ds_read_b64_tr_b16 v[150:151], v32 offset:2656
    v_mfma_f32_16x16x32_bf16 v[92:95], v[132:135], v[164:167], v[92:95]
    ds_read_b64_tr_b16 v[152:153], v32 offset:3656
    ds_read_b64_tr_b16 v[154:155], v32 offset:3648
    v_mfma_f32_16x16x32_bf16 v[88:91], v[136:139], v[160:163], v[88:91]
    ds_read_b64_tr_b16 v[156:157], v32 offset:3688
    ds_read_b64_tr_b16 v[158:159], v32 offset:3680
    v_fma_f32 v210, v236, v222, v210
    v_mfma_f32_16x16x32_bf16 v[92:95], v[140:143], v[160:163], v[92:95]
    v_fma_f32 v211, v236, v223, v211
    s_waitcnt lgkmcnt(0)
    v_mfma_f32_16x16x32_bf16 v[80:83], v[144:147], v[176:179], v[80:83]
    ds_read_b128 v[160:163], v42 offset:0
    ds_read_b64_tr_b16 v[128:129], v32 offset:2696
    v_mfma_f32_16x16x32_bf16 v[84:87], v[148:151], v[176:179], v[84:87]
    ds_read_b64_tr_b16 v[130:131], v32 offset:2688
    ds_read_b64_tr_b16 v[132:133], v32 offset:2728
    v_mfma_f32_16x16x32_bf16 v[88:91], v[144:147], v[180:183], v[88:91]
    ds_read_b128 v[164:167], v42 offset:1024
    ds_read_b64_tr_b16 v[134:135], v32 offset:2720
    v_mfma_f32_16x16x32_bf16 v[92:95], v[148:151], v[180:183], v[92:95]
    ds_read_b64_tr_b16 v[136:137], v32 offset:3720
    ds_read_b64_tr_b16 v[138:139], v32 offset:3712
    v_mfma_f32_16x16x32_bf16 v[88:91], v[152:155], v[176:179], v[88:91]
    ds_read_b64_tr_b16 v[140:141], v32 offset:3752
    ds_read_b64_tr_b16 v[142:143], v32 offset:3744
    v_cvt_pk_bf16_f32 v228, v208, v209
    v_mfma_f32_16x16x32_bf16 v[92:95], v[156:159], v[176:179], v[92:95]
    v_cvt_pk_bf16_f32 v229, v210, v211
    s_waitcnt lgkmcnt(0)
    v_mfma_f32_16x16x32_bf16 v[80:83], v[128:131], v[160:163], v[80:83]
    ds_read_b128 v[176:179], v43 offset:0
    ds_read_b64_tr_b16 v[144:145], v32 offset:2760
    v_mfma_f32_16x16x32_bf16 v[84:87], v[132:135], v[160:163], v[84:87]
    ds_read_b64_tr_b16 v[146:147], v32 offset:2752
    ds_read_b64_tr_b16 v[148:149], v32 offset:2792
    v_mfma_f32_16x16x32_bf16 v[88:91], v[128:131], v[164:167], v[88:91]
    ds_read_b128 v[180:183], v43 offset:1024
    ds_read_b64_tr_b16 v[150:151], v32 offset:2784
    v_mfma_f32_16x16x32_bf16 v[92:95], v[132:135], v[164:167], v[92:95]
    ds_read_b64_tr_b16 v[152:153], v32 offset:3784
    ds_read_b64_tr_b16 v[154:155], v32 offset:3776
    v_mfma_f32_16x16x32_bf16 v[88:91], v[136:139], v[160:163], v[88:91]
    ds_read_b64_tr_b16 v[156:157], v32 offset:3816
    ds_read_b64_tr_b16 v[158:159], v32 offset:3808
    s_add_u32 s36, s35, 0
    v_mfma_f32_16x16x32_bf16 v[92:95], v[140:143], v[160:163], v[92:95]
    buffer_store_dwordx2 v[228:229], v51, s[52:55], s36 offen
    s_waitcnt lgkmcnt(0)
    v_mfma_f32_16x16x32_bf16 v[80:83], v[144:147], v[176:179], v[80:83]
    ds_read_b128 v[160:163], v44 offset:0
    ds_read_b64_tr_b16 v[128:129], v32 offset:2824
    v_mfma_f32_16x16x32_bf16 v[84:87], v[148:151], v[176:179], v[84:87]
    ds_read_b64_tr_b16 v[130:131], v32 offset:2816
    ds_read_b64_tr_b16 v[132:133], v32 offset:2856
    v_mfma_f32_16x16x32_bf16 v[88:91], v[144:147], v[180:183], v[88:91]
    ds_read_b128 v[164:167], v44 offset:1024
    ds_read_b64_tr_b16 v[134:135], v32 offset:2848
    v_mfma_f32_16x16x32_bf16 v[92:95], v[148:151], v[180:183], v[92:95]
    ds_read_b64_tr_b16 v[136:137], v32 offset:3848
    ds_read_b64_tr_b16 v[138:139], v32 offset:3840
    v_mfma_f32_16x16x32_bf16 v[88:91], v[152:155], v[176:179], v[88:91]
    ds_read_b64_tr_b16 v[140:141], v32 offset:3880
    ds_read_b64_tr_b16 v[142:143], v32 offset:3872
    v_fma_f32 v212, v237, v224, v212
    v_mfma_f32_16x16x32_bf16 v[92:95], v[156:159], v[176:179], v[92:95]
    v_fma_f32 v213, v237, v225, v213
    s_waitcnt lgkmcnt(0)
    v_mfma_f32_16x16x32_bf16 v[80:83], v[128:131], v[160:163], v[80:83]
    ds_read_b128 v[176:179], v45 offset:0
    ds_read_b64_tr_b16 v[144:145], v32 offset:2888
    v_mfma_f32_16x16x32_bf16 v[84:87], v[132:135], v[160:163], v[84:87]
    ds_read_b64_tr_b16 v[146:147], v32 offset:2880
    ds_read_b64_tr_b16 v[148:149], v32 offset:2920
    v_mfma_f32_16x16x32_bf16 v[88:91], v[128:131], v[164:167], v[88:91]
    ds_read_b128 v[180:183], v45 offset:1024
    ds_read_b64_tr_b16 v[150:151], v32 offset:2912
    v_mfma_f32_16x16x32_bf16 v[92:95], v[132:135], v[164:167], v[92:95]
    ds_read_b64_tr_b16 v[152:153], v32 offset:3912
    ds_read_b64_tr_b16 v[154:155], v32 offset:3904
    v_mfma_f32_16x16x32_bf16 v[88:91], v[136:139], v[160:163], v[88:91]
    ds_read_b64_tr_b16 v[156:157], v32 offset:3944
    ds_read_b64_tr_b16 v[158:159], v32 offset:3936
    v_fma_f32 v214, v237, v226, v214
    v_mfma_f32_16x16x32_bf16 v[92:95], v[140:143], v[160:163], v[92:95]
    v_fma_f32 v215, v237, v227, v215
    s_waitcnt lgkmcnt(0)
    v_mfma_f32_16x16x32_bf16 v[80:83], v[144:147], v[176:179], v[80:83]
    ds_read_b128 v[160:163], v46 offset:0
    ds_read_b64_tr_b16 v[128:129], v32 offset:2952
    v_mfma_f32_16x16x32_bf16 v[84:87], v[148:151], v[176:179], v[84:87]
    ds_read_b64_tr_b16 v[130:131], v32 offset:2944
    ds_read_b64_tr_b16 v[132:133], v32 offset:2984
    v_mfma_f32_16x16x32_bf16 v[88:91], v[144:147], v[180:183], v[88:91]
    ds_read_b128 v[164:167], v46 offset:1024
    ds_read_b64_tr_b16 v[134:135], v32 offset:2976
    v_mfma_f32_16x16x32_bf16 v[92:95], v[148:151], v[180:183], v[92:95]
    ds_read_b64_tr_b16 v[136:137], v32 offset:3976
    ds_read_b64_tr_b16 v[138:139], v32 offset:3968
    v_mfma_f32_16x16x32_bf16 v[88:91], v[152:155], v[176:179], v[88:91]
    ds_read_b64_tr_b16 v[140:141], v32 offset:4008
    ds_read_b64_tr_b16 v[142:143], v32 offset:4000
    v_cvt_pk_bf16_f32 v230, v212, v213
    v_mfma_f32_16x16x32_bf16 v[92:95], v[156:159], v[176:179], v[92:95]
    v_cvt_pk_bf16_f32 v231, v214, v215
    s_waitcnt lgkmcnt(0)
    v_mfma_f32_16x16x32_bf16 v[80:83], v[128:131], v[160:163], v[80:83]
    ds_read_b128 v[176:179], v47 offset:0
    ds_read_b64_tr_b16 v[144:145], v32 offset:3016
    v_mfma_f32_16x16x32_bf16 v[84:87], v[132:135], v[160:163], v[84:87]
    ds_read_b64_tr_b16 v[146:147], v32 offset:3008
    ds_read_b64_tr_b16 v[148:149], v32 offset:3048
    v_mfma_f32_16x16x32_bf16 v[88:91], v[128:131], v[164:167], v[88:91]
    ds_read_b128 v[180:183], v47 offset:1024
    ds_read_b64_tr_b16 v[150:151], v32 offset:3040
    v_mfma_f32_16x16x32_bf16 v[92:95], v[132:135], v[164:167], v[92:95]
    ds_read_b64_tr_b16 v[152:153], v32 offset:4040
    ds_read_b64_tr_b16 v[154:155], v32 offset:4032
    v_mfma_f32_16x16x32_bf16 v[88:91], v[136:139], v[160:163], v[88:91]
    ds_read_b64_tr_b16 v[156:157], v32 offset:4072
    ds_read_b64_tr_b16 v[158:159], v32 offset:4064
    s_add_u32 s36, s35, 73728
    v_mfma_f32_16x16x32_bf16 v[92:95], v[140:143], v[160:163], v[92:95]
    buffer_store_dwordx2 v[230:231], v51, s[52:55], s36 offen
    s_waitcnt lgkmcnt(0)
    v_mfma_f32_16x16x32_bf16 v[80:83], v[144:147], v[176:179], v[80:83]
    ds_read_b128 v[208:211], v54 offset:2048
    v_mfma_f32_16x16x32_bf16 v[84:87], v[148:151], v[176:179], v[84:87]
    ds_read_b32 v220, v52 offset:2304
    v_mfma_f32_16x16x32_bf16 v[88:91], v[144:147], v[180:183], v[88:91]
    ds_read_b32 v221, v52 offset:33920
    v_mfma_f32_16x16x32_bf16 v[92:95], v[148:151], v[180:183], v[92:95]
    ds_read_b32 v222, v53 offset:2304
    v_mfma_f32_16x16x32_bf16 v[88:91], v[152:155], v[176:179], v[88:91]
    ds_read_b32 v223, v53 offset:33920
    v_mfma_f32_16x16x32_bf16 v[92:95], v[156:159], v[176:179], v[92:95]
    ds_read_b128 v[212:215], v54 offset:3072
    ds_read_b32 v224, v52 offset:2592
    ds_read_b32 v225, v52 offset:34208
    ds_read_b32 v226, v53 offset:2592
    ds_read_b32 v227, v53 offset:34208
    s_waitcnt lgkmcnt(0)
    v_fma_f32 v208, v238, v220, v208
    v_fma_f32 v209, v238, v221, v209
    v_fma_f32 v210, v238, v222, v210
    v_fma_f32 v211, v238, v223, v211
    v_cvt_pk_bf16_f32 v232, v208, v209
    v_cvt_pk_bf16_f32 v233, v210, v211
    s_add_u32 s36, s35, 589824
    buffer_store_dwordx2 v[232:233], v51, s[52:55], s36 offen
    v_fma_f32 v212, v239, v224, v212
    v_fma_f32 v213, v239, v225, v213
    v_fma_f32 v214, v239, v226, v214
    v_fma_f32 v215, v239, v227, v215
    v_cvt_pk_bf16_f32 v234, v212, v213
    v_cvt_pk_bf16_f32 v235, v214, v215
    s_add_u32 s36, s35, 663552
    buffer_store_dwordx2 v[234:235], v51, s[52:55], s36 offen
    ds_write_b128 v48, v[80:83] offset:4608
    ds_write_b128 v48, v[84:87] offset:4672
    ds_write_b128 v48, v[88:91] offset:6912
    ds_write_b128 v48, v[92:95] offset:6976
    s_waitcnt lgkmcnt(0)
    s_barrier
    ds_read_b128 v[208:211], v55 offset:0
    ds_read_b32 v220, v52 offset:4608
    ds_read_b32 v221, v52 offset:36224
    ds_read_b32 v222, v53 offset:4608
    ds_read_b32 v223, v53 offset:36224
    ds_read_b128 v[212:215], v55 offset:1024
    ds_read_b32 v224, v52 offset:4896
    ds_read_b32 v225, v52 offset:36512
    ds_read_b32 v226, v53 offset:4896
    ds_read_b32 v227, v53 offset:36512
    s_waitcnt lgkmcnt(0)
    v_fma_f32 v208, v240, v220, v208
    v_fma_f32 v209, v240, v221, v209
    v_fma_f32 v210, v240, v222, v210
    v_fma_f32 v211, v240, v223, v211
    v_cvt_pk_bf16_f32 v228, v208, v209
    v_cvt_pk_bf16_f32 v229, v210, v211
    s_add_u32 s36, s35, 1179648
    buffer_store_dwordx2 v[228:229], v51, s[52:55], s36 offen
    v_fma_f32 v212, v241, v224, v212
    v_fma_f32 v213, v241, v225, v213
    v_fma_f32 v214, v241, v226, v214
    v_fma_f32 v215, v241, v227, v215
    v_cvt_pk_bf16_f32 v230, v212, v213
    v_cvt_pk_bf16_f32 v231, v214, v215
    s_add_u32 s36, s35, 1253376
    buffer_store_dwordx2 v[230:231], v51, s[52:55], s36 offen
    ds_read_b128 v[208:211], v55 offset:2048
    ds_read_b32 v220, v52 offset:6912
    ds_read_b32 v221, v52 offset:38528
    ds_read_b32 v222, v53 offset:6912
    ds_read_b32 v223, v53 offset:38528
    ds_read_b128 v[212:215], v55 offset:3072
    ds_read_b32 v224, v52 offset:7200
    ds_read_b32 v225, v52 offset:38816
    ds_read_b32 v226, v53 offset:7200
    ds_read_b32 v227, v53 offset:38816
    s_waitcnt lgkmcnt(0)
    v_fma_f32 v208, v242, v220, v208
    v_fma_f32 v209, v242, v221, v209
    v_fma_f32 v210, v242, v222, v210
    v_fma_f32 v211, v242, v223, v211
    v_cvt_pk_bf16_f32 v232, v208, v209
    v_cvt_pk_bf16_f32 v233, v210, v211
    s_add_u32 s36, s35, 1769472
    buffer_store_dwordx2 v[232:233], v51, s[52:55], s36 offen
    v_fma_f32 v212, v243, v224, v212
    v_fma_f32 v213, v243, v225, v213
    v_fma_f32 v214, v243, v226, v214
    v_fma_f32 v215, v243, v227, v215
    v_cvt_pk_bf16_f32 v234, v212, v213
    v_cvt_pk_bf16_f32 v235, v214, v215
    s_add_u32 s36, s35, 1843200
    buffer_store_dwordx2 v[234:235], v51, s[52:55], s36 offen
    s_branch ssm_mix_kernel_fin3
ssm_mix_kernel_pw2:
    s_add_u32 s38, s37, 196608
    buffer_load_dwordx4 v[208:211], v18, s[48:51], s38 offen
    s_add_u32 s38, s37, 212992
    buffer_load_dwordx4 v[212:215], v18, s[48:51], s38 offen
    s_add_u32 s38, s37, 229376
    buffer_load_dwordx4 v[216:219], v18, s[48:51], s38 offen
    s_add_u32 s38, s37, 245760
    buffer_load_dwordx4 v[220:223], v18, s[48:51], s38 offen
    s_add_u32 s38, s37, 4096
    buffer_load_dwordx4 v[224:227], v18, s[48:51], s38 offen
    s_add_u32 s38, s37, 20480
    buffer_load_dwordx4 v[228:231], v18, s[48:51], s38 offen
    s_add_u32 s38, s37, 36864
    buffer_load_dwordx4 v[232:235], v18, s[48:51], s38 offen
    s_add_u32 s38, s37, 53248
    buffer_load_dwordx4 v[236:239], v18, s[48:51], s38 offen
    s_add_u32 s38, s37, 69632
    buffer_load_dwordx4 v[240:243], v18, s[48:51], s38 offen
    s_add_u32 s38, s37, 86016
    buffer_load_dwordx4 v[244:247], v18, s[48:51], s38 offen
    s_add_u32 s38, s37, 102400
    buffer_load_dwordx4 v[248:251], v18, s[48:51], s38 offen
    s_add_u32 s38, s37, 118784
    buffer_load_dwordx4 v[252:255], v18, s[48:51], s38 offen
    v_and_b32 v14, 15, v0
    v_lshrrev_b32 v15, 4, v0
    v_lshrrev_b32 v16, 1, v15
    v_lshlrev_b32 v16, 5, v16
    v_lshl_add_u32 v16, v14, 1, v16
    v_and_b32 v17, 1, v15
    v_add_u32 v16, v16, v17
    s_lshl_b32 s38, s27, 7
    v_add_u32 v44, s38, v16
    v_lshlrev_b32 v17, 3, v44
    v_mov_b32 v45, v17
    s_mov_b32 s38, 45088768
    buffer_load_dwordx2 v[24:25], v17, s[48:51], s38 offen
    s_mov_b32 s38, 45089280
    buffer_load_dwordx2 v[26:27], v17, s[48:51], s38 offen
    s_mov_b32 s38, 45092864
    buffer_load_dwordx2 v[28:29], v17, s[48:51], s38 offen
    s_mov_b32 s38, 45093376
    buffer_load_dwordx2 v[30:31], v17, s[48:51], s38 offen
    s_mov_b32 s38, 45096960
    buffer_load_dwordx2 v[32:33], v17, s[48:51], s38 offen
    s_mov_b32 s38, 45097472
    buffer_load_dwordx2 v[34:35], v17, s[48:51], s38 offen
    s_mov_b32 s38, 45101056
    buffer_load_dwordx2 v[36:37], v17, s[48:51], s38 offen
    s_mov_b32 s38, 45101568
    buffer_load_dwordx2 v[38:39], v17, s[48:51], s38 offen
    s_lshl_b32 s38, s25, 3
    v_mov_b32 v19, s38
    buffer_load_dwordx2 v[48:49], v19, s[56:59], 0 offen
    v_and_b32 v5, 15, v0
    v_lshrrev_b32 v6, 4, v0
    v_lshlrev_b32 v7, 3, v6
    v_sub_u32 v7, v5, v7
    v_add_u32 v8, 16, v7
    v_mov_b32 v104, 0
    v_cmp_eq_u32 vcc, 0, v7
    v_mov_b32 v9, 0x3f80
    s_nop 0
    v_cndmask_b32 v104, v104, v9, vcc
    v_cmp_eq_u32 vcc, 1, v7
    v_mov_b32 v9, 0x3f800000
    s_nop 0
    v_cndmask_b32 v104, v104, v9, vcc
    v_mov_b32 v105, 0
    v_cmp_eq_u32 vcc, 2, v7
    v_mov_b32 v9, 0x3f80
    s_nop 0
    v_cndmask_b32 v105, v105, v9, vcc
    v_cmp_eq_u32 vcc, 3, v7
    v_mov_b32 v9, 0x3f800000
    s_nop 0
    v_cndmask_b32 v105, v105, v9, vcc
    v_mov_b32 v106, 0
    v_cmp_eq_u32 vcc, 4, v7
    v_mov_b32 v9, 0x3f80
    s_nop 0
    v_cndmask_b32 v106, v106, v9, vcc
    v_cmp_eq_u32 vcc, 5, v7
    v_mov_b32 v9, 0x3f800000
    s_nop 0
    v_cndmask_b32 v106, v106, v9, vcc
    v_mov_b32 v107, 0
    v_cmp_eq_u32 vcc, 6, v7
    v_mov_b32 v9, 0x3f80
    s_nop 0
    v_cndmask_b32 v107, v107, v9, vcc
    v_cmp_eq_u32 vcc, 7, v7
    v_mov_b32 v9, 0x3f800000
    s_nop 0
    v_cndmask_b32 v107, v107, v9, vcc
    v_mov_b32 v108, 0
    v_cmp_eq_u32 vcc, 0, v8
    v_mov_b32 v9, 0x3f80
    s_nop 0
    v_cndmask_b32 v108, v108, v9, vcc
    v_cmp_eq_u32 vcc, 1, v8
    v_mov_b32 v9, 0x3f800000
    s_nop 0
    v_cndmask_b32 v108, v108, v9, vcc
    v_mov_b32 v109, 0
    v_cmp_eq_u32 vcc, 2, v8
    v_mov_b32 v9, 0x3f80
    s_nop 0
    v_cndmask_b32 v109, v109, v9, vcc
    v_cmp_eq_u32 vcc, 3, v8
    v_mov_b32 v9, 0x3f800000
    s_nop 0
    v_cndmask_b32 v109, v109, v9, vcc
    v_mov_b32 v110, 0
    v_cmp_eq_u32 vcc, 4, v8
    v_mov_b32 v9, 0x3f80
    s_nop 0
    v_cndmask_b32 v110, v110, v9, vcc
    v_cmp_eq_u32 vcc, 5, v8
    v_mov_b32 v9, 0x3f800000
    s_nop 0
    v_cndmask_b32 v110, v110, v9, vcc
    v_mov_b32 v111, 0
    v_cmp_eq_u32 vcc, 6, v8
    v_mov_b32 v9, 0x3f80
    s_nop 0
    v_cndmask_b32 v111, v111, v9, vcc
    v_cmp_eq_u32 vcc, 7, v8
    v_mov_b32 v9, 0x3f800000
    s_nop 0
    v_cndmask_b32 v111, v111, v9, vcc
    v_lshrrev_b32 v9, 1, v6
    s_lshl_b32 s34, s27, 2
    v_add_u32 v9, s34, v9
    v_lshrrev_b32 v10, 2, v5
    s_and_b32 s34, s27, 1
    s_lshl_b32 s34, s34, 1
    v_xor_b32 v10, s34, v10
    v_lshlrev_b32 v11, 6, v9
    v_lshl_add_u32 v11, v10, 4, v11
    v_and_b32 v10, 3, v5
    v_lshl_add_u32 v11, v10, 2, v11
    v_and_b32 v10, 1, v6
    v_lshl_add_u32 v11, v10, 1, v11
    v_add_u32 v11, 127488, v11
    s_lshl_b32 s34, s27, 12
    s_add_u32 s34, s34, 146944
    v_lshlrev_b32 v12, 4, v0
    v_add_u32 v12, s34, v12
    s_add_u32 s34, s30, 25856
    v_lshlrev_b32 v13, 4, v0
    v_add_u32 v13, s34, v13
    v_mov_b32 v64, 0
    v_mov_b32 v65, 0
    v_mov_b32 v66, 0
    v_mov_b32 v67, 0
    v_mov_b32 v68, 0
    v_mov_b32 v69, 0
    v_mov_b32 v70, 0
    v_mov_b32 v71, 0
    v_mov_b32 v72, 0
    v_mov_b32 v73, 0
    v_mov_b32 v74, 0
    v_mov_b32 v75, 0
    v_mov_b32 v76, 0
    v_mov_b32 v77, 0
    v_mov_b32 v78, 0
    v_mov_b32 v79, 0
    v_mov_b32 v80, 0
    v_mov_b32 v81, 0
    v_mov_b32 v82, 0
    v_mov_b32 v83, 0
    v_mov_b32 v84, 0
    v_mov_b32 v85, 0
    v_mov_b32 v86, 0
    v_mov_b32 v87, 0
    v_mov_b32 v88, 0
    v_mov_b32 v89, 0
    v_mov_b32 v90, 0
    v_mov_b32 v91, 0
    v_mov_b32 v92, 0
    v_mov_b32 v93, 0
    v_mov_b32 v94, 0
    v_mov_b32 v95, 0
    ds_read_u16_d16_hi v64, v11 offset:0
    ds_read_u16_d16_hi v65, v11 offset:5120
    ds_read_u16_d16_hi v66, v11 offset:10240
    ds_read_u16_d16_hi v67, v11 offset:15360
    ds_read_u16_d16_hi v68, v11 offset:128
    ds_read_u16_d16_hi v69, v11 offset:5248
    ds_read_u16_d16_hi v70, v11 offset:10368
    ds_read_u16_d16_hi v71, v11 offset:15488
    ds_read_u16_d16_hi v72, v11 offset:1024
    ds_read_u16_d16_hi v73, v11 offset:6144
    ds_read_u16_d16_hi v74, v11 offset:11264
    ds_read_u16_d16_hi v75, v11 offset:16384
    ds_read_u16_d16_hi v76, v11 offset:1152
    ds_read_u16_d16_hi v77, v11 offset:6272
    ds_read_u16_d16_hi v78, v11 offset:11392
    ds_read_u16_d16_hi v79, v11 offset:16512
    ds_read_u16_d16_hi v80, v11 offset:2048
    ds_read_u16_d16_hi v81, v11 offset:7168
    ds_read_u16_d16_hi v82, v11 offset:12288
    ds_read_u16_d16_hi v83, v11 offset:17408
    ds_read_u16_d16_hi v84, v11 offset:2176
    ds_read_u16_d16_hi v85, v11 offset:7296
    ds_read_u16_d16_hi v86, v11 offset:12416
    ds_read_u16_d16_hi v87, v11 offset:17536
    ds_read_u16_d16_hi v88, v11 offset:3072
    ds_read_u16_d16_hi v89, v11 offset:8192
    ds_read_u16_d16_hi v90, v11 offset:13312
    ds_read_u16_d16_hi v91, v11 offset:18432
    ds_read_u16_d16_hi v92, v11 offset:3200
    ds_read_u16_d16_hi v93, v11 offset:8320
    ds_read_u16_d16_hi v94, v11 offset:13440
    ds_read_u16_d16_hi v95, v11 offset:18560
    s_mov_b32 s39, 0x00003f80
    s_mov_b32 s40, 0x3f800000
    s_waitcnt vmcnt(32)
    v_mfma_f32_16x16x32_bf16 v[128:131], v[104:107], v[160:163], 0
    v_mfma_f32_16x16x32_bf16 v[132:135], v[108:111], v[160:163], 0
    s_add_u32 s38, s37, 135168
    buffer_load_dwordx4 v[160:163], v18, s[48:51], s38 offen
    s_waitcnt vmcnt(32)
    v_mfma_f32_16x16x32_bf16 v[128:131], v[104:107], v[164:167], v[128:131]
    v_mfma_f32_16x16x32_bf16 v[132:135], v[108:111], v[164:167], v[132:135]
    s_add_u32 s38, s37, 151552
    buffer_load_dwordx4 v[164:167], v18, s[48:51], s38 offen
    s_waitcnt vmcnt(32)
    v_mfma_f32_16x16x32_bf16 v[128:131], v[104:107], v[168:171], v[128:131]
    v_mfma_f32_16x16x32_bf16 v[132:135], v[108:111], v[168:171], v[132:135]
    s_add_u32 s38, s37, 167936
    buffer_load_dwordx4 v[168:171], v18, s[48:51], s38 offen
    s_waitcnt vmcnt(32)
    v_mfma_f32_16x16x32_bf16 v[128:131], v[104:107], v[172:175], v[128:131]
    v_mfma_f32_16x16x32_bf16 v[132:135], v[108:111], v[172:175], v[132:135]
    s_add_u32 s38, s37, 184320
    buffer_load_dwordx4 v[172:175], v18, s[48:51], s38 offen
    s_waitcnt vmcnt(32)
    v_mfma_f32_16x16x32_bf16 v[128:131], v[104:107], v[176:179], v[128:131]
    v_mfma_f32_16x16x32_bf16 v[132:135], v[108:111], v[176:179], v[132:135]
    s_add_u32 s38, s37, 200704
    buffer_load_dwordx4 v[176:179], v18, s[48:51], s38 offen
    s_waitcnt vmcnt(32)
    v_mfma_f32_16x16x32_bf16 v[128:131], v[104:107], v[180:183], v[128:131]
    v_mfma_f32_16x16x32_bf16 v[132:135], v[108:111], v[180:183], v[132:135]
    s_add_u32 s38, s37, 217088
    buffer_load_dwordx4 v[180:183], v18, s[48:51], s38 offen
    s_waitcnt vmcnt(32)
    v_mfma_f32_16x16x32_bf16 v[128:131], v[104:107], v[184:187], v[128:131]
    v_mfma_f32_16x16x32_bf16 v[132:135], v[108:111], v[184:187], v[132:135]
    s_add_u32 s38, s37, 233472
    buffer_load_dwordx4 v[184:187], v18, s[48:51], s38 offen
    s_waitcnt vmcnt(32)
    v_mfma_f32_16x16x32_bf16 v[128:131], v[104:107], v[188:191], v[128:131]
    v_mfma_f32_16x16x32_bf16 v[132:135], v[108:111], v[188:191], v[132:135]
    s_add_u32 s38, s37, 249856
    buffer_load_dwordx4 v[188:191], v18, s[48:51], s38 offen
    s_waitcnt vmcnt(32)
    v_mfma_f32_16x16x32_bf16 v[128:131], v[104:107], v[192:195], v[128:131]
    v_mfma_f32_16x16x32_bf16 v[132:135], v[108:111], v[192:195], v[132:135]
    s_add_u32 s38, s37, 8192
    buffer_load_dwordx4 v[192:195], v18, s[48:51], s38 offen
    s_waitcnt vmcnt(32)
    v_mfma_f32_16x16x32_bf16 v[128:131], v[104:107], v[196:199], v[128:131]
    v_mfma_f32_16x16x32_bf16 v[132:135], v[108:111], v[196:199], v[132:135]
    s_add_u32 s38, s37, 24576
    buffer_load_dwordx4 v[196:199], v18, s[48:51], s38 offen
    s_waitcnt vmcnt(32)
    v_mfma_f32_16x16x32_bf16 v[128:131], v[104:107], v[200:203], v[128:131]
    v_mfma_f32_16x16x32_bf16 v[132:135], v[108:111], v[200:203], v[132:135]
    s_add_u32 s38, s37, 40960
    buffer_load_dwordx4 v[200:203], v18, s[48:51], s38 offen
    s_waitcnt vmcnt(32)
    v_mfma_f32_16x16x32_bf16 v[128:131], v[104:107], v[204:207], v[128:131]
    v_mfma_f32_16x16x32_bf16 v[132:135], v[108:111], v[204:207], v[132:135]
    s_add_u32 s38, s37, 57344
    buffer_load_dwordx4 v[204:207], v18, s[48:51], s38 offen
    s_waitcnt vmcnt(32)
    v_mfma_f32_16x16x32_bf16 v[128:131], v[104:107], v[208:211], v[128:131]
    v_mfma_f32_16x16x32_bf16 v[132:135], v[108:111], v[208:211], v[132:135]
    s_add_u32 s38, s37, 73728
    buffer_load_dwordx4 v[208:211], v18, s[48:51], s38 offen
    s_waitcnt vmcnt(32)
    v_mfma_f32_16x16x32_bf16 v[128:131], v[104:107], v[212:215], v[128:131]
    v_mfma_f32_16x16x32_bf16 v[132:135], v[108:111], v[212:215], v[132:135]
    s_add_u32 s38, s37, 90112
    buffer_load_dwordx4 v[212:215], v18, s[48:51], s38 offen
    s_waitcnt vmcnt(32)
    v_mfma_f32_16x16x32_bf16 v[128:131], v[104:107], v[216:219], v[128:131]
    v_mfma_f32_16x16x32_bf16 v[132:135], v[108:111], v[216:219], v[132:135]
    s_add_u32 s38, s37, 106496
    buffer_load_dwordx4 v[216:219], v18, s[48:51], s38 offen
    s_waitcnt vmcnt(32)
    v_mfma_f32_16x16x32_bf16 v[128:131], v[104:107], v[220:223], v[128:131]
    v_mfma_f32_16x16x32_bf16 v[132:135], v[108:111], v[220:223], v[132:135]
    s_add_u32 s38, s37, 122880
    buffer_load_dwordx4 v[220:223], v18, s[48:51], s38 offen
    s_waitcnt lgkmcnt(0)
    s_waitcnt vmcnt(16)
    v_lshlrev_b32 v40, 16, v48
    v_and_b32 v41, 0xffff0000, v48
    v_lshlrev_b32 v42, 16, v49
    v_and_b32 v43, 0xffff0000, v49
    v_mul_f32 v64, v64, v40
    v_mul_f32 v65, v65, v41
    v_mul_f32 v66, v66, v42
    v_mul_f32 v67, v67, v43
    v_mul_f32 v128, v25, v128
    v_mul_f32 v129, v25, v129
    v_mul_f32 v130, v25, v130
    v_mul_f32 v131, v25, v131
    v_fma_f32 v128, v24, v64, v128
    v_fma_f32 v129, v24, v65, v129
    v_fma_f32 v130, v24, v66, v130
    v_fma_f32 v131, v24, v67, v131
    v_mul_f32 v68, v68, v40
    v_mul_f32 v69, v69, v41
    v_mul_f32 v70, v70, v42
    v_mul_f32 v71, v71, v43
    v_mul_f32 v132, v27, v132
    v_mul_f32 v133, v27, v133
    v_mul_f32 v134, v27, v134
    v_mul_f32 v135, v27, v135
    v_fma_f32 v132, v26, v68, v132
    v_fma_f32 v133, v26, v69, v133
    v_fma_f32 v134, v26, v70, v134
    v_fma_f32 v135, v26, v71, v135
    ds_write_b128 v12, v[128:131] offset:0
    ds_write_b128 v12, v[132:135] offset:1024
    v_mfma_f32_16x16x32_bf16 v[136:139], v[104:107], v[224:227], 0
    v_mfma_f32_16x16x32_bf16 v[140:143], v[108:111], v[224:227], 0
    s_add_u32 s38, s37, 139264
    buffer_load_dwordx4 v[224:227], v18, s[48:51], s38 offen
    v_mfma_f32_16x16x32_bf16 v[136:139], v[104:107], v[228:231], v[136:139]
    v_mfma_f32_16x16x32_bf16 v[140:143], v[108:111], v[228:231], v[140:143]
    s_add_u32 s38, s37, 155648
    buffer_load_dwordx4 v[228:231], v18, s[48:51], s38 offen
    v_mfma_f32_16x16x32_bf16 v[136:139], v[104:107], v[232:235], v[136:139]
    v_mfma_f32_16x16x32_bf16 v[140:143], v[108:111], v[232:235], v[140:143]
    s_add_u32 s38, s37, 172032
    buffer_load_dwordx4 v[232:235], v18, s[48:51], s38 offen
    v_mfma_f32_16x16x32_bf16 v[136:139], v[104:107], v[236:239], v[136:139]
    v_mfma_f32_16x16x32_bf16 v[140:143], v[108:111], v[236:239], v[140:143]
    s_add_u32 s38, s37, 188416
    buffer_load_dwordx4 v[236:239], v18, s[48:51], s38 offen
    v_mfma_f32_16x16x32_bf16 v[136:139], v[104:107], v[240:243], v[136:139]
    v_mfma_f32_16x16x32_bf16 v[140:143], v[108:111], v[240:243], v[140:143]
    s_add_u32 s38, s37, 204800
    buffer_load_dwordx4 v[240:243], v18, s[48:51], s38 offen
    v_mfma_f32_16x16x32_bf16 v[136:139], v[104:107], v[244:247], v[136:139]
    v_mfma_f32_16x16x32_bf16 v[140:143], v[108:111], v[244:247], v[140:143]
    s_add_u32 s38, s37, 221184
    buffer_load_dwordx4 v[244:247], v18, s[48:51], s38 offen
    v_mfma_f32_16x16x32_bf16 v[136:139], v[104:107], v[248:251], v[136:139]
    v_mfma_f32_16x16x32_bf16 v[140:143], v[108:111], v[248:251], v[140:143]
    s_add_u32 s38, s37, 237568
    buffer_load_dwordx4 v[248:251], v18, s[48:51], s38 offen
    v_mfma_f32_16x16x32_bf16 v[136:139], v[104:107], v[252:255], v[136:139]
    v_mfma_f32_16x16x32_bf16 v[140:143], v[108:111], v[252:255], v[140:143]
    s_add_u32 s38, s37, 253952
    buffer_load_dwordx4 v[252:255], v18, s[48:51], s38 offen
    s_waitcnt vmcnt(23)
    v_mfma_f32_16x16x32_bf16 v[136:139], v[104:107], v[160:163], v[136:139]
    v_mfma_f32_16x16x32_bf16 v[140:143], v[108:111], v[160:163], v[140:143]
    s_add_u32 s38, s37, 12288
    buffer_load_dwordx4 v[160:163], v18, s[48:51], s38 offen
    s_waitcnt vmcnt(23)
    v_mfma_f32_16x16x32_bf16 v[136:139], v[104:107], v[164:167], v[136:139]
    v_mfma_f32_16x16x32_bf16 v[140:143], v[108:111], v[164:167], v[140:143]
    s_add_u32 s38, s37, 28672
    buffer_load_dwordx4 v[164:167], v18, s[48:51], s38 offen
    s_waitcnt vmcnt(23)
    v_mfma_f32_16x16x32_bf16 v[136:139], v[104:107], v[168:171], v[136:139]
    v_mfma_f32_16x16x32_bf16 v[140:143], v[108:111], v[168:171], v[140:143]
    s_add_u32 s38, s37, 45056
    buffer_load_dwordx4 v[168:171], v18, s[48:51], s38 offen
    s_waitcnt vmcnt(23)
    v_mfma_f32_16x16x32_bf16 v[136:139], v[104:107], v[172:175], v[136:139]
    v_mfma_f32_16x16x32_bf16 v[140:143], v[108:111], v[172:175], v[140:143]
    s_add_u32 s38, s37, 61440
    buffer_load_dwordx4 v[172:175], v18, s[48:51], s38 offen
    s_waitcnt vmcnt(23)
    v_mfma_f32_16x16x32_bf16 v[136:139], v[104:107], v[176:179], v[136:139]
    v_mfma_f32_16x16x32_bf16 v[140:143], v[108:111], v[176:179], v[140:143]
    s_add_u32 s38, s37, 77824
    buffer_load_dwordx4 v[176:179], v18, s[48:51], s38 offen
    s_waitcnt vmcnt(23)
    v_mfma_f32_16x16x32_bf16 v[136:139], v[104:107], v[180:183], v[136:139]
    v_mfma_f32_16x16x32_bf16 v[140:143], v[108:111], v[180:183], v[140:143]
    s_add_u32 s38, s37, 94208
    buffer_load_dwordx4 v[180:183], v18, s[48:51], s38 offen
    s_waitcnt vmcnt(23)
    v_mfma_f32_16x16x32_bf16 v[136:139], v[104:107], v[184:187], v[136:139]
    v_mfma_f32_16x16x32_bf16 v[140:143], v[108:111], v[184:187], v[140:143]
    s_add_u32 s38, s37, 110592
    buffer_load_dwordx4 v[184:187], v18, s[48:51], s38 offen
    s_waitcnt vmcnt(23)
    v_mfma_f32_16x16x32_bf16 v[136:139], v[104:107], v[188:191], v[136:139]
    v_mfma_f32_16x16x32_bf16 v[140:143], v[108:111], v[188:191], v[140:143]
    s_add_u32 s38, s37, 126976
    buffer_load_dwordx4 v[188:191], v18, s[48:51], s38 offen
    v_mul_f32 v72, v72, v40
    v_mul_f32 v73, v73, v41
    v_mul_f32 v74, v74, v42
    v_mul_f32 v75, v75, v43
    s_nop 0
    v_mul_f32 v136, v29, v136
    v_mul_f32 v137, v29, v137
    v_mul_f32 v138, v29, v138
    v_mul_f32 v139, v29, v139
    v_fma_f32 v136, v28, v72, v136
    v_fma_f32 v137, v28, v73, v137
    v_fma_f32 v138, v28, v74, v138
    v_fma_f32 v139, v28, v75, v139
    v_mul_f32 v76, v76, v40
    v_mul_f32 v77, v77, v41
    v_mul_f32 v78, v78, v42
    v_mul_f32 v79, v79, v43
    v_mul_f32 v140, v31, v140
    v_mul_f32 v141, v31, v141
    v_mul_f32 v142, v31, v142
    v_mul_f32 v143, v31, v143
    v_fma_f32 v140, v30, v76, v140
    v_fma_f32 v141, v30, v77, v141
    v_fma_f32 v142, v30, v78, v142
    v_fma_f32 v143, v30, v79, v143
    ds_write_b128 v12, v[136:139] offset:2048
    ds_write_b128 v12, v[140:143] offset:3072
    s_waitcnt lgkmcnt(0)
    s_barrier
    s_waitcnt vmcnt(23)
    v_mfma_f32_16x16x32_bf16 v[144:147], v[104:107], v[192:195], 0
    v_mfma_f32_16x16x32_bf16 v[148:151], v[108:111], v[192:195], 0
    s_add_u32 s38, s37, 143360
    buffer_load_dwordx4 v[192:195], v18, s[48:51], s38 offen
    s_waitcnt vmcnt(23)
    v_mfma_f32_16x16x32_bf16 v[144:147], v[104:107], v[196:199], v[144:147]
    v_mfma_f32_16x16x32_bf16 v[148:151], v[108:111], v[196:199], v[148:151]
    s_add_u32 s38, s37, 159744
    buffer_load_dwordx4 v[196:199], v18, s[48:51], s38 offen
    s_waitcnt vmcnt(23)
    v_mfma_f32_16x16x32_bf16 v[144:147], v[104:107], v[200:203], v[144:147]
    v_mfma_f32_16x16x32_bf16 v[148:151], v[108:111], v[200:203], v[148:151]
    s_add_u32 s38, s37, 176128
    buffer_load_dwordx4 v[200:203], v18, s[48:51], s38 offen
    s_waitcnt vmcnt(23)
    v_mfma_f32_16x16x32_bf16 v[144:147], v[104:107], v[204:207], v[144:147]
    v_mfma_f32_16x16x32_bf16 v[148:151], v[108:111], v[204:207], v[148:151]
    s_add_u32 s38, s37, 192512
    buffer_load_dwordx4 v[204:207], v18, s[48:51], s38 offen
    s_waitcnt vmcnt(23)
    v_mfma_f32_16x16x32_bf16 v[144:147], v[104:107], v[208:211], v[144:147]
    v_mfma_f32_16x16x32_bf16 v[148:151], v[108:111], v[208:211], v[148:151]
    s_add_u32 s38, s37, 208896
    buffer_load_dwordx4 v[208:211], v18, s[48:51], s38 offen
    s_waitcnt vmcnt(23)
    v_mfma_f32_16x16x32_bf16 v[144:147], v[104:107], v[212:215], v[144:147]
    v_mfma_f32_16x16x32_bf16 v[148:151], v[108:111], v[212:215], v[148:151]
    s_add_u32 s38, s37, 225280
    buffer_load_dwordx4 v[212:215], v18, s[48:51], s38 offen
    s_waitcnt vmcnt(23)
    v_mfma_f32_16x16x32_bf16 v[144:147], v[104:107], v[216:219], v[144:147]
    v_mfma_f32_16x16x32_bf16 v[148:151], v[108:111], v[216:219], v[148:151]
    s_add_u32 s38, s37, 241664
    buffer_load_dwordx4 v[216:219], v18, s[48:51], s38 offen
    s_waitcnt vmcnt(23)
    v_mfma_f32_16x16x32_bf16 v[144:147], v[104:107], v[220:223], v[144:147]
    v_mfma_f32_16x16x32_bf16 v[148:151], v[108:111], v[220:223], v[148:151]
    s_add_u32 s38, s37, 258048
    buffer_load_dwordx4 v[220:223], v18, s[48:51], s38 offen
    s_waitcnt vmcnt(23)
    v_mfma_f32_16x16x32_bf16 v[144:147], v[104:107], v[224:227], v[144:147]
    v_mfma_f32_16x16x32_bf16 v[148:151], v[108:111], v[224:227], v[148:151]
    s_waitcnt vmcnt(22)
    v_mfma_f32_16x16x32_bf16 v[144:147], v[104:107], v[228:231], v[144:147]
    v_mfma_f32_16x16x32_bf16 v[148:151], v[108:111], v[228:231], v[148:151]
    s_waitcnt vmcnt(21)
    v_mfma_f32_16x16x32_bf16 v[144:147], v[104:107], v[232:235], v[144:147]
    v_mfma_f32_16x16x32_bf16 v[148:151], v[108:111], v[232:235], v[148:151]
    s_waitcnt vmcnt(20)
    v_mfma_f32_16x16x32_bf16 v[144:147], v[104:107], v[236:239], v[144:147]
    v_mfma_f32_16x16x32_bf16 v[148:151], v[108:111], v[236:239], v[148:151]
    s_waitcnt vmcnt(19)
    v_mfma_f32_16x16x32_bf16 v[144:147], v[104:107], v[240:243], v[144:147]
    v_mfma_f32_16x16x32_bf16 v[148:151], v[108:111], v[240:243], v[148:151]
    s_waitcnt vmcnt(18)
    v_mfma_f32_16x16x32_bf16 v[144:147], v[104:107], v[244:247], v[144:147]
    v_mfma_f32_16x16x32_bf16 v[148:151], v[108:111], v[244:247], v[148:151]
    s_waitcnt vmcnt(17)
    v_mfma_f32_16x16x32_bf16 v[144:147], v[104:107], v[248:251], v[144:147]
    v_mfma_f32_16x16x32_bf16 v[148:151], v[108:111], v[248:251], v[148:151]
    s_waitcnt vmcnt(16)
    v_mfma_f32_16x16x32_bf16 v[144:147], v[104:107], v[252:255], v[144:147]
    v_mfma_f32_16x16x32_bf16 v[148:151], v[108:111], v[252:255], v[148:151]
    v_mul_f32 v80, v80, v40
    v_mul_f32 v81, v81, v41
    v_mul_f32 v82, v82, v42
    v_mul_f32 v83, v83, v43
    s_nop 2
    v_mul_f32 v144, v33, v144
    v_mul_f32 v145, v33, v145
    v_mul_f32 v146, v33, v146
    v_mul_f32 v147, v33, v147
    v_fma_f32 v144, v32, v80, v144
    v_fma_f32 v145, v32, v81, v145
    v_fma_f32 v146, v32, v82, v146
    v_fma_f32 v147, v32, v83, v147
    v_mul_f32 v84, v84, v40
    v_mul_f32 v85, v85, v41
    v_mul_f32 v86, v86, v42
    v_mul_f32 v87, v87, v43
    v_mul_f32 v148, v35, v148
    v_mul_f32 v149, v35, v149
    v_mul_f32 v150, v35, v150
    v_mul_f32 v151, v35, v151
    v_fma_f32 v148, v34, v84, v148
    v_fma_f32 v149, v34, v85, v149
    v_fma_f32 v150, v34, v86, v150
    v_fma_f32 v151, v34, v87, v151
    ds_write_b128 v13, v[144:147] offset:0
    ds_write_b128 v13, v[148:151] offset:1024
    s_waitcnt vmcnt(15)
    v_mfma_f32_16x16x32_bf16 v[152:155], v[104:107], v[160:163], 0
    v_mfma_f32_16x16x32_bf16 v[156:159], v[108:111], v[160:163], 0
    s_waitcnt vmcnt(14)
    v_mfma_f32_16x16x32_bf16 v[152:155], v[104:107], v[164:167], v[152:155]
    v_mfma_f32_16x16x32_bf16 v[156:159], v[108:111], v[164:167], v[156:159]
    s_waitcnt vmcnt(13)
    v_mfma_f32_16x16x32_bf16 v[152:155], v[104:107], v[168:171], v[152:155]
    v_mfma_f32_16x16x32_bf16 v[156:159], v[108:111], v[168:171], v[156:159]
    s_waitcnt vmcnt(12)
    v_mfma_f32_16x16x32_bf16 v[152:155], v[104:107], v[172:175], v[152:155]
    v_mfma_f32_16x16x32_bf16 v[156:159], v[108:111], v[172:175], v[156:159]
    s_waitcnt vmcnt(11)
    v_mfma_f32_16x16x32_bf16 v[152:155], v[104:107], v[176:179], v[152:155]
    v_mfma_f32_16x16x32_bf16 v[156:159], v[108:111], v[176:179], v[156:159]
    s_waitcnt vmcnt(10)
    v_mfma_f32_16x16x32_bf16 v[152:155], v[104:107], v[180:183], v[152:155]
    v_mfma_f32_16x16x32_bf16 v[156:159], v[108:111], v[180:183], v[156:159]
    s_waitcnt vmcnt(9)
    v_mfma_f32_16x16x32_bf16 v[152:155], v[104:107], v[184:187], v[152:155]
    v_mfma_f32_16x16x32_bf16 v[156:159], v[108:111], v[184:187], v[156:159]
    s_waitcnt vmcnt(8)
    v_mfma_f32_16x16x32_bf16 v[152:155], v[104:107], v[188:191], v[152:155]
    v_mfma_f32_16x16x32_bf16 v[156:159], v[108:111], v[188:191], v[156:159]
    s_waitcnt vmcnt(7)
    v_mfma_f32_16x16x32_bf16 v[152:155], v[104:107], v[192:195], v[152:155]
    v_mfma_f32_16x16x32_bf16 v[156:159], v[108:111], v[192:195], v[156:159]
    s_waitcnt vmcnt(6)
    v_mfma_f32_16x16x32_bf16 v[152:155], v[104:107], v[196:199], v[152:155]
    v_mfma_f32_16x16x32_bf16 v[156:159], v[108:111], v[196:199], v[156:159]
    s_waitcnt vmcnt(5)
    v_mfma_f32_16x16x32_bf16 v[152:155], v[104:107], v[200:203], v[152:155]
    v_mfma_f32_16x16x32_bf16 v[156:159], v[108:111], v[200:203], v[156:159]
    s_waitcnt vmcnt(4)
    v_mfma_f32_16x16x32_bf16 v[152:155], v[104:107], v[204:207], v[152:155]
    v_mfma_f32_16x16x32_bf16 v[156:159], v[108:111], v[204:207], v[156:159]
    s_waitcnt vmcnt(3)
    v_mfma_f32_16x16x32_bf16 v[152:155], v[104:107], v[208:211], v[152:155]
    v_mfma_f32_16x16x32_bf16 v[156:159], v[108:111], v[208:211], v[156:159]
    s_waitcnt vmcnt(2)
    v_mfma_f32_16x16x32_bf16 v[152:155], v[104:107], v[212:215], v[152:155]
    v_mfma_f32_16x16x32_bf16 v[156:159], v[108:111], v[212:215], v[156:159]
    s_waitcnt vmcnt(1)
    v_mfma_f32_16x16x32_bf16 v[152:155], v[104:107], v[216:219], v[152:155]
    v_mfma_f32_16x16x32_bf16 v[156:159], v[108:111], v[216:219], v[156:159]
    s_waitcnt vmcnt(0)
    v_mfma_f32_16x16x32_bf16 v[152:155], v[104:107], v[220:223], v[152:155]
    v_mfma_f32_16x16x32_bf16 v[156:159], v[108:111], v[220:223], v[156:159]
    v_mul_f32 v88, v88, v40
    v_mul_f32 v89, v89, v41
    v_mul_f32 v90, v90, v42
    v_mul_f32 v91, v91, v43
    s_nop 2
    v_mul_f32 v152, v37, v152
    v_mul_f32 v153, v37, v153
    v_mul_f32 v154, v37, v154
    v_mul_f32 v155, v37, v155
    v_fma_f32 v152, v36, v88, v152
    v_fma_f32 v153, v36, v89, v153
    v_fma_f32 v154, v36, v90, v154
    v_fma_f32 v155, v36, v91, v155
    v_mul_f32 v92, v92, v40
    v_mul_f32 v93, v93, v41
    v_mul_f32 v94, v94, v42
    v_mul_f32 v95, v95, v43
    v_mul_f32 v156, v39, v156
    v_mul_f32 v157, v39, v157
    v_mul_f32 v158, v39, v158
    v_mul_f32 v159, v39, v159
    v_fma_f32 v156, v38, v92, v156
    v_fma_f32 v157, v38, v93, v157
    v_fma_f32 v158, v38, v94, v158
    v_fma_f32 v159, v38, v95, v159
    ds_write_b128 v13, v[152:155] offset:2048
    ds_write_b128 v13, v[156:159] offset:3072
    s_waitcnt lgkmcnt(0)
    s_barrier
ssm_mix_kernel_fin3:
ssm_mix_kernel_end1:
    s_endpgm
.section .rodata,"a"
.p2align 6
.amdhsa_kernel ffn_fused_kernel
  .amdhsa_next_free_vgpr 512
  .amdhsa_next_free_sgpr 102
  .amdhsa_accum_offset 256
  .amdhsa_group_segment_fixed_size 0
  .amdhsa_kernarg_size 120
  .amdhsa_user_sgpr_count 2
  .amdhsa_user_sgpr_kernarg_segment_ptr 1
  .amdhsa_system_sgpr_workgroup_id_x 1
  .amdhsa_float_denorm_mode_32 3
  .amdhsa_float_denorm_mode_16_64 3
.end_amdhsa_kernel
.p2align 6
.amdhsa_kernel ssm_mix_kernel
  .amdhsa_next_free_vgpr 256
  .amdhsa_next_free_sgpr 102
  .amdhsa_accum_offset 256
  .amdhsa_group_segment_fixed_size 0
  .amdhsa_kernarg_size 120
  .amdhsa_user_sgpr_count 2
  .amdhsa_user_sgpr_kernarg_segment_ptr 1
  .amdhsa_system_sgpr_workgroup_id_x 1
  .amdhsa_float_denorm_mode_32 3
  .amdhsa_float_denorm_mode_16_64 3
.end_amdhsa_kernel
```
